```python
import torch

def _softmax(x, axis=-1):
    return torch.softmax(x, dim=axis)
def _gelu(x):
    return torch.nn.functional.gelu(x, approximate="tanh")
def _silu(x):
    return torch.nn.functional.silu(x)
def _sigmoid(x):
    return torch.sigmoid(x)
def _layernorm(x, axis=-1, eps=1e-5):
    m = x.mean(dim=axis, keepdim=True)
    v = x.var(dim=axis, keepdim=True, unbiased=False)
    return (x - m) / torch.sqrt(v + eps)
def _scatter_add(tgt, idx, src, axis=0):
    return tgt.clone().index_add_(axis, idx, src)
def _segment_sum(src, seg, n):
    out = torch.zeros((n,) + src.shape[1:], dtype=src.dtype)
    return out.index_add_(0, seg, src)
def _pad(x, pw):
    flat = tuple(v for pair in reversed(pw) for v in pair)
    return torch.nn.functional.pad(x, flat)

kernel_name = 'sequential_preLN__grouped_kv_mqa__moe_arch_mod__prompt'

def setup_inputs():

    _w = (lambda a: (lambda t: t.to(torch.bfloat16) if t.is_floating_point() else t)(torch.as_tensor(a)))
    def _A_setup():
        B, S, D, H = 1, 2048, 576, 32
        Dh = D // H
        return {
            "x": _w((lambda *s: torch.randn(*s, dtype=torch.bfloat16) * 0.05)(B, S, D)),
            "wq": _w((lambda *s: torch.randn(*s, dtype=torch.bfloat16) * 0.05)(D, H * Dh)),
            "wk": _w((lambda *s: torch.randn(*s, dtype=torch.bfloat16) * 0.05)(D, Dh)),
            "wv": _w((lambda *s: torch.randn(*s, dtype=torch.bfloat16) * 0.05)(D, Dh)),
            "wo": _w((lambda *s: torch.randn(*s, dtype=torch.bfloat16) * 0.05)(H * Dh, D)),
        }
    _A_in = _A_setup()

    def _B_setup():
        B, S, D, F, C = 1, 2048, 576, 4608, 8
        return {
            "x": _w((lambda *s: torch.randn(*s, dtype=torch.bfloat16) * 0.05)(B, S, D)),
            "w_r": _w((lambda *s: torch.randn(*s, dtype=torch.bfloat16) * 0.05)(D)),
            "w_gate": _w((lambda *s: torch.randn(*s, dtype=torch.bfloat16) * 0.05)(D, F)),
            "w_up": _w((lambda *s: torch.randn(*s, dtype=torch.bfloat16) * 0.05)(D, F)),
            "w_down": _w((lambda *s: torch.randn(*s, dtype=torch.bfloat16) * 0.05)(F, D)),
        }
    _B_in = _B_setup()

    return {
        "A_x": _A_in["x"],
        "A_wq": _A_in["wq"],
        "A_wk": _A_in["wk"],
        "A_wv": _A_in["wv"],
        "A_wo": _A_in["wo"],
        "B_x": _B_in["x"],
        "B_w_r": _B_in["w_r"],
        "B_w_gate": _B_in["w_gate"],
        "B_w_up": _B_in["w_up"],
        "B_w_down": _B_in["w_down"],
    }

def reference(A_x, A_wq, A_wk, A_wv, A_wo, B_x, B_w_r, B_w_gate, B_w_up, B_w_down):
    def _A_ref(x, wq, wk, wv, wo):
        B, S, D = x.shape
        H = 32
        Dh = D // H
        q = (lambda x, *d: x.permute(*d))((x @ wq).reshape(B, S, H, Dh), 0, 2, 1, 3)
        k = x @ wk
        v = x @ wv
        scores = torch.einsum("bhqd,bkd->bhqk", q, k) * (Dh ** -0.5)
        p = _softmax(scores, axis=-1)
        o = torch.einsum("bhqk,bkd->bhqd", p, v)
        return (lambda x, *d: x.permute(*d))(o, 0, 2, 1, 3).reshape(B, S, H * Dh) @ wo

    def _B_ref(x, w_r, w_gate, w_up, w_down):
        B, S, D = x.shape
        C = 8
        r = x @ w_r
        idx = torch.argsort(-r, axis=-1)[:, :C]
        idx_e = (lambda x, n, axis: torch.repeat_interleave(x, n, dim=axis))(idx.reshape(B, C, 1), D, axis=2)
        x_sel = (lambda x, i, axis: torch.take_along_dim(x, i, dim=axis))(x, idx_e, axis=1)
        g = _silu(x_sel @ w_gate)
        u = x_sel @ w_up
        y = (g * u) @ w_down
        r_sel = _sigmoid((lambda x, i, axis: torch.take_along_dim(x, i, dim=axis))(r, idx, axis=1))
        y = y * r_sel.reshape(B, C, 1)
        b_off = (torch.arange(B) * S).reshape(B, 1)
        flat_idx = (idx + b_off).reshape(B * C)
        zero = (x * 0.0).reshape(B * S, D)
        upd = _scatter_add(zero, flat_idx, y.reshape(B * C, D), axis=0)
        return x + upd.reshape(B, S, D)

    x = A_x
    h = x + _A_ref(_layernorm(x, axis=-1), A_wq, A_wk, A_wv, A_wo)
    h2 = h + _B_ref(_layernorm(h, axis=-1), B_w_r, B_w_gate, B_w_up, B_w_down)
    return h2
```

```asm
; @launch grid=(256,1,1) block=(512,1,1) lds=163392
.amdgcn_target "amdgcn-amd-amdhsa--gfx950"
.text
.globl sequential_preLN__grouped_kv_mqa__moe_arch_mod__prompt_kernel
.p2align 8
.type sequential_preLN__grouped_kv_mqa__moe_arch_mod__prompt_kernel,@function
sequential_preLN__grouped_kv_mqa__moe_arch_mod__prompt_kernel:
  s_cmp_ge_u32 s2, 240
  s_cbranch_scc1 K1_SP0
  s_load_dwordx2 s[12:13], s[0:1], 0
  s_load_dwordx8 s[36:43], s[0:1], 0
  s_load_dwordx2 s[44:45], s[0:1], 32
  s_load_dwordx2 s[46:47], s[0:1], 96
  s_load_dwordx8 s[48:55], s[0:1], 48
  s_load_dwordx4 s[64:67], s[0:1], 80
  v_lshrrev_b32 v1, 6, v0
  v_and_b32 v0, 63, v0
  v_readfirstlane_b32 s3, v1
  s_xor_b32 s3, s3, 4
  s_and_b32 s4, s2, 7
  s_lshr_b32 s5, s2, 3
  s_mul_i32 s34, s5, 52
  s_lshr_b32 s34, s34, 8
  s_mul_i32 s6, s34, 5
  s_sub_u32 s5, s5, s6
  s_mul_i32 s6, s34, 48
  s_min_u32 s6, s6, 224
  s_lshl_b32 s35, s4, 8
  s_add_u32 s35, s35, s6
  s_cmp_lt_u32 s3, 4
  s_cbranch_scc1 K1_COMP
  s_setprio 2
  s_and_b32 s6, s3, 3
  v_lshrrev_b32 v9, 3, v0
  v_mul_u32_u24 v12, 1152, v9
  v_lshrrev_b32 v1, 4, v0
  v_xor_b32 v3, v1, v0
  v_and_b32 v3, 7, v3
  v_lshl_add_u32 v10, v3, 4, v12
  v_xor_b32 v11, 64, v10
  v_add_u32 v11, 8192, v11
  s_lshl_b32 s21, s6, 11
  s_lshr_b32 s23, s34, 1
  s_add_u32 s23, s23, s34
  s_add_u32 s23, s23, s4
  s_lshl1_add_u32 s23, s5, s23
  s_sub_u32 s24, s23, 9
  s_min_u32 s23, s23, s24
  s_sub_u32 s24, s23, 9
  s_min_u32 s23, s23, s24
  s_lshl4_add_u32 s63, s6, s35
  s_mul_i32 s24, s63, 1152
  s_cmp_lt_u32 s34, 4
  s_cselect_b32 s14, 48, 32
  s_add_u32 s59, s14, s35
  s_mul_i32 s14, s59, 1152
  s_mov_b32 s15, 0x20000
  v_lshrrev_b32 v17, 2, v0
  v_and_b32 v3, 2, v1
  v_and_b32 v18, 3, v0
  v_xor_b32 v3, v3, v18
  v_lshlrev_b32 v19, 4, v3
  s_lshl_b32 s25, s5, 7
  s_mov_b32 s18, 663552
  s_cmp_eq_u32 s5, 0
  s_cselect_b32 s7, 36, 1152
  s_cselect_b32 s20, 20, 48
  s_cselect_b32 s25, 128, s25
  s_cselect_b32 s27, 0, 64
  s_cselect_b32 s18, 20736, s18
  v_min_u32 v3, s20, v19
  v_mad_u32_u24 v13, v17, s7, v3
  s_lshl_b32 s22, s6, 10
  s_mul_i32 s20, s7, s6
  s_lshl4_add_u32 s25, s20, s25
  s_sub_u32 s25, s25, 128
  s_lshl_b32 s7, s7, 6
  s_mov_b32 s30, s18
  s_mov_b32 s19, 0x20000
  s_mov_b32 s31, 0x20000
  s_cmp_eq_u32 s5, 0
  s_waitcnt lgkmcnt(0)
  s_cselect_b64 s[16:17], s[40:41], s[38:39]
  s_cselect_b64 s[28:29], s[42:43], s[38:39]
  s_mul_i32 s9, s23, s7
  s_add_u32 m0, s22, 6144
  s_add_u32 s9, s9, s25
  buffer_load_dwordx4 v13, s[16:19], s9 offen lds
  s_add_u32 m0, s22, 10240
  s_add_u32 s9, s9, s27
  buffer_load_dwordx4 v13, s[28:31], s9 offen lds
  s_cmp_eq_u32 s3, 7
  s_cbranch_scc1 K1_L3
  s_lshl_b32 s8, s23, 7
  s_add_u32 m0, s21, 0
  s_add_u32 s8, s8, s24
  buffer_load_dwordx4 v10, s[12:15], s8 offen lds
  buffer_load_dwordx4 v11, s[12:15], s8 offen offset:1024 lds
  s_add_u32 s23, s23, 1
  s_cmp_eq_u32 s23, 9
  s_cselect_b32 s23, 0, s23
  s_mul_i32 s9, s23, s7
  s_add_u32 m0, s22, 20480
  s_add_u32 s9, s9, s25
  buffer_load_dwordx4 v13, s[16:19], s9 offen lds
  s_add_u32 m0, s22, 24576
  s_add_u32 s9, s9, s27
  buffer_load_dwordx4 v13, s[28:31], s9 offen lds
  s_lshl_b32 s8, s23, 7
  s_add_u32 m0, s21, 14336
  s_add_u32 s8, s8, s24
  buffer_load_dwordx4 v10, s[12:15], s8 offen lds
  buffer_load_dwordx4 v11, s[12:15], s8 offen offset:1024 lds
  s_add_u32 s23, s23, 1
  s_cmp_eq_u32 s23, 9
  s_cselect_b32 s23, 0, s23
  v_bfe_u32 v6, v0, 2, 2
  v_and_b32 v7, 1, v0
  v_lshl_add_u32 v6, v6, 1, v7
  v_mul_u32_u24 v6, 1152, v6
  v_bfe_u32 v7, v0, 4, 1
  v_bfe_u32 v8, v0, 1, 1
  v_lshl_add_u32 v7, v7, 1, v8
  v_mad_u32_u24 v245, v7, 36, v6
  v_lshrrev_b32 v7, 5, v0
  v_lshl_add_u32 v244, v7, 4, v245
  v_lshrrev_b32 v1, 5, v0
  v_and_b32 v2, 31, v0
  v_lshlrev_b32 v3, 5, v2
  v_lshl_add_u32 v223, v1, 4, v3
  v_lshlrev_b32 v4, 1, v2
  s_mov_b32 s26, 0xfffff9f8
  v_bfe_u32 v4, s26, v4, 2
  v_cmp_gt_u32 vcc, 16, v2
  v_add_u32 v4, 16, v4
  v_lshlrev_b32 v242, 2, v0
  v_cndmask_b32 v4, v4, v2, vcc
  v_lshlrev_b32 v4, 5, v4
  v_lshl_add_u32 v225, v1, 4, v4
  v_mov_b32 v217, 0xdddddddd
  v_lshlrev_b32 v239, 4, v0
  s_mul_i32 s26, s6, 2560
  v_add_u32 v219, s26, v239
  v_lshl_add_u32 v221, v0, 3, s26
  v_add_u32 v254, 151680, v239
  v_add_u32 v255, 151680, v242
  v_mov_b32 v235, 0
  v_mov_b32 v237, 0
  v_mov_b64 v[64:65], 0
  v_mov_b64 v[66:67], 0
  v_mov_b64 v[68:69], 0
  v_mov_b64 v[70:71], 0
  v_mov_b64 v[72:73], 0
  v_mov_b64 v[74:75], 0
  v_mov_b64 v[76:77], 0
  v_mov_b64 v[78:79], 0
  v_mov_b64 v[90:91], 0
  v_mov_b64 v[92:93], 0
  v_mov_b64 v[94:95], 0
  v_lshrrev_b32 v1, 4, v0
  v_and_b32 v2, 15, v0
  v_bfe_u32 v3, v0, 1, 1
  v_and_b32 v7, 7, v0
  v_lshrrev_b32 v5, 1, v1
  v_mul_u32_u24 v5, 9216, v5
  v_and_b32 v6, 1, v1
  v_mul_u32_u24 v6, 576, v6
  v_add_u32 v5, v5, v6
  v_lshl_add_u32 v5, v2, 2, v5
  v_add_u32 v240, 114816, v5
  v_lshrrev_b32 v5, 1, v1
  v_lshlrev_b32 v5, 4, v5
  v_and_b32 v6, 1, v1
  v_bfe_u32 v8, v0, 3, 1
  v_lshl_add_u32 v6, v8, 1, v6
  v_lshl_add_u32 v5, v6, 2, v5
  v_bfe_u32 v8, v0, 2, 1
  v_add_u32 v5, v5, v8
  v_lshlrev_b32 v5, 6, v5
  v_xor_b32 v6, s6, v6
  v_lshl_add_u32 v5, v6, 4, v5
  v_mul_u32_u24 v6, 36992, v3
  v_add_u32 v5, v5, v6
  v_and_b32 v6, 1, v0
  v_lshl_add_u32 v5, v6, 3, v5
  v_add_u32 v241, 40960, v5
  v_mul_u32_u24 v243, 84, v0
  v_and_b32 v2, 15, v0
  v_lshrrev_b32 v1, 4, v0
  v_lshrrev_b32 v3, 1, v2
  v_xor_b32 v3, v3, v1
  v_lshlrev_b32 v3, 4, v3
  v_lshl_add_u32 v3, v2, 7, v3
  v_add_u32 v4, s21, v3
  v_xor_b32 v5, 64, v4
  s_lshl_b32 s26, s6, 7
  s_add_u32 s26, s26, 129024
  v_lshl_add_u32 v8, v2, 3, s26
  v_mov_b32 v40, 0
  v_mov_b32 v41, 0
  v_mov_b32 v42, 0
  v_mov_b32 v43, 0
  v_mov_b32 v44, 0
  v_mov_b32 v45, 0
  v_mov_b32 v46, 0
  v_mov_b32 v47, 0
  v_mov_b32 v48, 0x3f803f80
  v_mov_b32 v49, 0x3f803f80
  v_mov_b32 v50, 0x3f803f80
  v_mov_b32 v51, 0x3f803f80
  v_bfe_u32 v3, v0, 1, 1
  v_mul_u32_u24 v3, 0xaaaa, v3
  v_add_u32 v52, 0x4444, v3
  s_mul_i32 s26, s6, 2304
  s_add_u32 s26, s26, 129536
  v_and_b32 v3, 7, v0
  v_lshl_add_u32 v24, v3, 4, v12
  v_mul_u32_u24 v25, 144, v9
  v_lshl_add_u32 v25, v3, 4, v25
  v_add_u32 v25, s26, v25
  v_mul_u32_u24 v26, 144, v17
  v_lshl_add_u32 v26, v18, 4, v26
  v_add_u32 v26, s26, v26
  v_lshlrev_b32 v27, 5, v17
  v_lshl_add_u32 v27, v18, 4, v27
  v_lshlrev_b32 v28, 2, v17
  v_and_b32 v3, 1, v1
  v_lshlrev_b32 v30, 4, v3
  v_lshlrev_b32 v3, 3, v3
  v_and_or_b32 v3, v17, 3, v3
  v_mul_u32_u24 v3, 144, v3
  v_lshl_add_u32 v3, v18, 3, v3
  v_and_b32 v6, 32, v0
  v_add3_u32 v29, v3, v6, s26
  v_lshl_add_u32 v30, v2, 5, v30
  v_mad_u32_u24 v30, v6, 10, v30
  s_mul_i32 s44, s4, 6
  s_add_u32 s44, s44, s34
  s_mul_i32 s60, s44, 9
  s_add_u32 s60, s60, s5
  s_add_u32 s60, s60, 511
  s_cmp_eq_u32 s5, 0
  s_cselect_b32 s44, s44, s60
  s_cselect_b32 s45, 0xff, 1
  s_lshl_b32 s44, s44, 7
  s_add_u32 s44, s44, 3219456
  s_lshl_b32 s60, s60, 7
  s_add_u32 s60, s60, 3220096
  v_mov_b32 v20, 163072
  v_mov_b32 v21, 1
  v_lshlrev_b32 v31, 13, v0
  v_lshrrev_b32 v14, 4, v0
  v_lshrrev_b32 v16, 2, v0
  v_mul_u32_u24 v16, 9216, v16
  v_and_b32 v15, 3, v0
  v_xor_b32 v15, v15, v14
  v_lshl_add_u32 v238, v15, 4, v16
  s_and_b32 s56, s2, 7
  s_mul_i32 s56, s56, 18
  s_lshr_b32 s57, s2, 3
  s_add_u32 s56, s56, s57
  s_mov_b32 s32, s50
  s_and_b32 s33, s51, 0xffff
  s_mov_b32 s35, 0x20000
  s_mov_b32 s40, s52
  s_and_b32 s41, s53, 0xffff
  s_mov_b32 s43, 0x20000
  s_cmp_lt_u32 s2, 144
  s_cselect_b32 s34, 5308416, 0
  s_mov_b32 s42, s34
  s_and_b32 s57, s3, 3
  s_lshl_b32 s58, s57, 10
  s_mul_i32 s62, s57, 147456
  s_lshl_b32 s57, s56, 6
  s_add_u32 s62, s62, s57
  s_mul_i32 s9, s23, s7
  s_add_u32 m0, s22, 34816
  s_add_u32 s9, s9, s25
  buffer_load_dwordx4 v13, s[16:19], s9 offen lds
  s_add_u32 m0, s22, 38912
  s_add_u32 s9, s9, s27
  buffer_load_dwordx4 v13, s[28:31], s9 offen lds
  s_lshl_b32 s8, s23, 7
  s_add_u32 m0, s21, 28672
  s_add_u32 s8, s8, s24
  buffer_load_dwordx4 v10, s[12:15], s8 offen lds
  buffer_load_dwordx4 v11, s[12:15], s8 offen offset:1024 lds
  s_add_u32 s23, s23, 1
  s_cmp_eq_u32 s23, 9
  s_cselect_b32 s23, 0, s23
  s_waitcnt vmcnt(8)
  s_barrier
  s_mul_i32 s9, s23, s7
  s_add_u32 m0, s22, 49152
  s_add_u32 s9, s9, s25
  buffer_load_dwordx4 v13, s[16:19], s9 offen lds
  s_add_u32 m0, s22, 53248
  s_add_u32 s9, s9, s27
  buffer_load_dwordx4 v13, s[28:31], s9 offen lds
  s_lshl_b32 s8, s23, 7
  s_add_u32 m0, s21, 43008
  s_add_u32 s8, s8, s24
  buffer_load_dwordx4 v10, s[12:15], s8 offen lds
  ds_read_b128 v[32:35], v4 offset:0
  ds_read_b128 v[36:39], v5 offset:0
  buffer_load_dwordx4 v11, s[12:15], s8 offen offset:1024 lds
  s_add_u32 s23, s23, 1
  s_cmp_eq_u32 s23, 9
  s_cselect_b32 s23, 0, s23
  s_waitcnt vmcnt(8)
  s_barrier
  s_mul_i32 s9, s23, s7
  s_add_u32 m0, s22, 63488
  s_add_u32 s9, s9, s25
  buffer_load_dwordx4 v13, s[16:19], s9 offen lds
  s_add_u32 m0, s22, 67584
  s_add_u32 s9, s9, s27
  buffer_load_dwordx4 v13, s[28:31], s9 offen lds
  s_waitcnt lgkmcnt(0)
  v_mfma_f32_16x16x32_bf16 v[44:47], v[32:35], v[32:35], v[44:47]
  v_mfma_f32_16x16x32_bf16 v[44:47], v[36:39], v[36:39], v[44:47]
  v_smfmac_f32_16x16x64_bf16 v[40:43], v[48:51], v[32:39], v52
  s_lshl_b32 s8, s23, 7
  s_add_u32 m0, s21, 57344
  s_add_u32 s8, s8, s24
  buffer_load_dwordx4 v10, s[12:15], s8 offen lds
  ds_read_b128 v[32:35], v4 offset:14336
  ds_read_b128 v[36:39], v5 offset:14336
  buffer_load_dwordx4 v11, s[12:15], s8 offen offset:1024 lds
  s_add_u32 s23, s23, 1
  s_cmp_eq_u32 s23, 9
  s_cselect_b32 s23, 0, s23
  s_waitcnt vmcnt(8)
  s_barrier
  s_mul_i32 s9, s23, s7
  s_add_u32 m0, s22, 77824
  s_add_u32 s9, s9, s25
  buffer_load_dwordx4 v13, s[16:19], s9 offen lds
  s_add_u32 m0, s22, 81920
  s_add_u32 s9, s9, s27
  buffer_load_dwordx4 v13, s[28:31], s9 offen lds
  s_waitcnt lgkmcnt(0)
  v_mfma_f32_16x16x32_bf16 v[44:47], v[32:35], v[32:35], v[44:47]
  v_mfma_f32_16x16x32_bf16 v[44:47], v[36:39], v[36:39], v[44:47]
  v_smfmac_f32_16x16x64_bf16 v[40:43], v[48:51], v[32:39], v52
  s_lshl_b32 s8, s23, 7
  s_add_u32 m0, s21, 71680
  s_add_u32 s8, s8, s24
  buffer_load_dwordx4 v10, s[12:15], s8 offen lds
  ds_read_b128 v[32:35], v4 offset:28672
  ds_read_b128 v[36:39], v5 offset:28672
  buffer_load_dwordx4 v11, s[12:15], s8 offen offset:1024 lds
  s_add_u32 s23, s23, 1
  s_cmp_eq_u32 s23, 9
  s_cselect_b32 s23, 0, s23
  s_waitcnt vmcnt(8)
  s_barrier
  s_mul_i32 s9, s23, s7
  s_add_u32 m0, s22, 92160
  s_add_u32 s9, s9, s25
  buffer_load_dwordx4 v13, s[16:19], s9 offen lds
  s_add_u32 m0, s22, 96256
  s_add_u32 s9, s9, s27
  buffer_load_dwordx4 v13, s[28:31], s9 offen lds
  s_waitcnt lgkmcnt(0)
  v_mfma_f32_16x16x32_bf16 v[44:47], v[32:35], v[32:35], v[44:47]
  v_mfma_f32_16x16x32_bf16 v[44:47], v[36:39], v[36:39], v[44:47]
  v_smfmac_f32_16x16x64_bf16 v[40:43], v[48:51], v[32:39], v52
  s_lshl_b32 s8, s23, 7
  s_add_u32 m0, s21, 86016
  s_add_u32 s8, s8, s24
  buffer_load_dwordx4 v10, s[12:15], s8 offen lds
  ds_read_b128 v[32:35], v4 offset:43008
  ds_read_b128 v[36:39], v5 offset:43008
  buffer_load_dwordx4 v11, s[12:15], s8 offen offset:1024 lds
  s_add_u32 s23, s23, 1
  s_cmp_eq_u32 s23, 9
  s_cselect_b32 s23, 0, s23
  s_waitcnt vmcnt(8)
  s_barrier
  v_add_u32 v4, 57344, v4
  v_add_u32 v5, 57344, v5
  s_mul_i32 s9, s23, s7
  s_add_u32 m0, s22, 106496
  s_add_u32 s9, s9, s25
  buffer_load_dwordx4 v13, s[16:19], s9 offen lds
  s_add_u32 m0, s22, 110592
  s_add_u32 s9, s9, s27
  buffer_load_dwordx4 v13, s[28:31], s9 offen lds
  s_waitcnt lgkmcnt(0)
  v_mfma_f32_16x16x32_bf16 v[44:47], v[32:35], v[32:35], v[44:47]
  v_mfma_f32_16x16x32_bf16 v[44:47], v[36:39], v[36:39], v[44:47]
  v_smfmac_f32_16x16x64_bf16 v[40:43], v[48:51], v[32:39], v52
  s_lshl_b32 s8, s23, 7
  s_add_u32 m0, s21, 100352
  s_add_u32 s8, s8, s24
  buffer_load_dwordx4 v10, s[12:15], s8 offen lds
  ds_read_b128 v[32:35], v4 offset:0
  ds_read_b128 v[36:39], v5 offset:0
  buffer_load_dwordx4 v11, s[12:15], s8 offen offset:1024 lds
  s_add_u32 s23, s23, 1
  s_cmp_eq_u32 s23, 9
  s_cselect_b32 s23, 0, s23
  s_waitcnt vmcnt(8)
  s_barrier
  s_mul_i32 s9, s23, s7
  s_add_u32 m0, s22, 120832
  s_add_u32 s9, s9, s25
  buffer_load_dwordx4 v13, s[16:19], s9 offen lds
  s_add_u32 m0, s22, 124928
  s_add_u32 s9, s9, s27
  buffer_load_dwordx4 v13, s[28:31], s9 offen lds
  s_waitcnt lgkmcnt(0)
  v_mfma_f32_16x16x32_bf16 v[44:47], v[32:35], v[32:35], v[44:47]
  v_mfma_f32_16x16x32_bf16 v[44:47], v[36:39], v[36:39], v[44:47]
  v_smfmac_f32_16x16x64_bf16 v[40:43], v[48:51], v[32:39], v52
  s_lshl_b32 s8, s23, 7
  s_add_u32 m0, s21, 114688
  s_add_u32 s8, s8, s24
  buffer_load_dwordx4 v10, s[12:15], s8 offen lds
  ds_read_b128 v[32:35], v4 offset:14336
  ds_read_b128 v[36:39], v5 offset:14336
  buffer_load_dwordx4 v11, s[12:15], s8 offen offset:1024 lds
  s_add_u32 s23, s23, 1
  s_cmp_eq_u32 s23, 9
  s_cselect_b32 s23, 0, s23
  s_waitcnt vmcnt(8)
  s_barrier
  s_mov_b64 s[16:17], s[38:39]
  s_mov_b32 s18, 663552
  s_mul_i32 s25, s6, 144
  s_add_u32 s25, s25, s5
  s_add_u32 s25, s25, 4
  s_lshl_b32 s25, s25, 7
  s_lshl_b32 s21, s6, 11
  v_and_b32 v13, 2, v9
  v_xor_b32 v13, v13, v0
  v_and_b32 v13, 7, v13
  v_lshl_add_u32 v13, v13, 4, v12
  v_xor_b32 v19, 64, v13
  v_add_u32 v19, 8192, v19
  s_mul_i32 s9, s23, 73728
  s_add_u32 m0, s21, 0
  s_add_u32 s9, s9, s25
  buffer_load_dwordx4 v13, s[16:19], s9 offen lds
  buffer_load_dwordx4 v19, s[16:19], s9 offen offset:1024 lds
  s_add_u32 s23, s23, 1
  s_cmp_eq_u32 s23, 9
  s_cselect_b32 s23, 0, s23
  s_waitcnt lgkmcnt(0)
  v_mfma_f32_16x16x32_bf16 v[44:47], v[32:35], v[32:35], v[44:47]
  v_mfma_f32_16x16x32_bf16 v[44:47], v[36:39], v[36:39], v[44:47]
  v_smfmac_f32_16x16x64_bf16 v[40:43], v[48:51], v[32:39], v52
  s_mul_i32 s9, s23, 73728
  s_add_u32 m0, s21, 8192
  s_add_u32 s9, s9, s25
  buffer_load_dwordx4 v13, s[16:19], s9 offen lds
  ds_read_b128 v[32:35], v4 offset:28672
  ds_read_b128 v[36:39], v5 offset:28672
  buffer_load_dwordx4 v19, s[16:19], s9 offen offset:1024 lds
  s_add_u32 s23, s23, 1
  s_cmp_eq_u32 s23, 9
  s_cselect_b32 s23, 0, s23
  s_waitcnt vmcnt(4)
  s_barrier
  s_waitcnt lgkmcnt(0)
  v_mfma_f32_16x16x32_bf16 v[44:47], v[32:35], v[32:35], v[44:47]
  v_mfma_f32_16x16x32_bf16 v[44:47], v[36:39], v[36:39], v[44:47]
  v_smfmac_f32_16x16x64_bf16 v[40:43], v[48:51], v[32:39], v52
  ds_read_b128 v[32:35], v4 offset:43008
  ds_read_b128 v[36:39], v5 offset:43008
  ds_read_b128 v[56:59], v4 offset:57344
  ds_read_b128 v[60:63], v5 offset:57344
  s_mov_b32 vcc_lo, 0xaaaaaaaa
  s_mov_b32 vcc_hi, 0xaaaaaaaa
  s_mov_b32 s10, 0xcccccccc
  s_mov_b32 s11, 0xcccccccc
  s_waitcnt lgkmcnt(0)
  v_mfma_f32_16x16x32_bf16 v[44:47], v[32:35], v[32:35], v[44:47]
  v_mfma_f32_16x16x32_bf16 v[44:47], v[36:39], v[36:39], v[44:47]
  v_smfmac_f32_16x16x64_bf16 v[40:43], v[48:51], v[32:39], v52
  v_mfma_f32_16x16x32_bf16 v[44:47], v[56:59], v[56:59], v[44:47]
  v_mfma_f32_16x16x32_bf16 v[44:47], v[60:63], v[60:63], v[44:47]
  v_smfmac_f32_16x16x64_bf16 v[40:43], v[48:51], v[56:63], v52
  s_nop 6
  v_cndmask_b32 v44, v44, v45, vcc
  v_cndmask_b32 v46, v46, v47, vcc
  v_add_f32 v40, v40, v42
  v_cndmask_b32 v44, v44, v46, s[10:11]
  v_mul_f32 v40, 0xbae38e39, v40
  v_mul_f32 v44, 0x3ae38e39, v44
  v_fma_f32 v44, -v40, v40, v44
  v_max_f32 v44, 0, v44
  v_add_f32 v44, 0x3727c5ac, v44
  v_rsq_f32 v41, v44
  s_mov_b32 exec_lo, 0x00f0000f
  s_mov_b32 exec_hi, 0xf0000f00
  ds_write_b64 v8, v[40:41]
  s_mov_b64 exec, -1
  s_waitcnt lgkmcnt(0)
  s_barrier
  s_mov_b32 s8, s46
  s_and_b32 s9, s47, 0xffff
  s_mov_b32 s10, 4761600
  s_mov_b32 s11, 0x20000
  s_lshl_b32 s20, s5, 7
  s_add_u32 s20, s20, s24
  s_sub_u32 s20, s20, 128
  s_add_u32 s22, s20, 9216
  s_lshl_b32 s68, s63, 5
  s_add_u32 s68, s68, 2359296
  s_lshl_b32 s69, s63, 2
  s_add_u32 s69, s69, 2424832
  s_mul_i32 s24, s63, 40
  s_add_u32 s24, s24, 2433024
  s_cmp_lt_u32 s63, s59
  s_cselect_b32 s10, s10, 0
  s_cmp_eq_u32 s5, 0
  s_barrier
  s_cbranch_scc1 K1_KV
  ds_read_b128 v[32:35], v25
  ds_read_b128 v[36:39], v25 offset:1152
  s_waitcnt lgkmcnt(1)
  buffer_store_dwordx4 v[32:35], v24, s[8:11], s20 offen sc1
  s_waitcnt lgkmcnt(0)
  buffer_store_dwordx4 v[36:39], v24, s[8:11], s22 offen sc1
  s_waitcnt vmcnt(2)
  s_branch K1_CB
K1_KV:
  ds_read_b128 v[32:35], v26
  ds_read_b64_tr_b16 v[36:37], v29 offset:64
  ds_read_b64_tr_b16 v[38:39], v29 offset:640
  s_mov_b32 exec_lo, 0x33333333
  s_mov_b32 exec_hi, 0x33333333
  s_waitcnt lgkmcnt(2)
  buffer_store_dwordx4 v[32:35], v27, s[8:11], s68 offen sc1
  s_mov_b32 exec_lo, 0x44444444
  s_mov_b32 exec_hi, 0x44444444
  buffer_store_dword v35, v28, s[8:11], s69 offen sc1
  s_mov_b32 exec_lo, -1
  s_mov_b32 exec_hi, 0x03c003c0
  s_waitcnt lgkmcnt(0)
  buffer_store_dwordx4 v[36:39], v30, s[8:11], s24 offen sc1
  s_mov_b64 exec, -1
  s_waitcnt vmcnt(3)
K1_CB:
  s_barrier
  s_mov_b32 s10, 4761600
  s_waitcnt vmcnt(0)
  s_mov_b64 exec, 1
  ds_add_rtn_u32 v20, v20, v21
  s_waitcnt lgkmcnt(0)
  v_cmp_eq_u32 vcc, 3, v20
  s_cbranch_vccz K1_NOFLa
  s_mov_b32 exec_lo, s45
  buffer_store_dword v21, v31, s[8:11], s44 offen sc1
K1_NOFLa:
  s_mov_b64 exec, -1
  s_mov_b32 s45, 1
  s_barrier
  s_barrier
  s_barrier
  s_branch K2_B
K1_L3:
  s_add_u32 s23, s23, 1
  s_cmp_eq_u32 s23, 9
  s_cselect_b32 s23, 0, s23
  s_mul_i32 s9, s23, s7
  s_add_u32 m0, s22, 20480
  s_add_u32 s9, s9, s25
  buffer_load_dwordx4 v13, s[16:19], s9 offen lds
  s_add_u32 m0, s22, 24576
  s_add_u32 s9, s9, s27
  buffer_load_dwordx4 v13, s[28:31], s9 offen lds
  s_add_u32 s23, s23, 1
  s_cmp_eq_u32 s23, 9
  s_cselect_b32 s23, 0, s23
  v_bfe_u32 v6, v0, 2, 2
  v_and_b32 v7, 1, v0
  v_lshl_add_u32 v6, v6, 1, v7
  v_mul_u32_u24 v6, 1152, v6
  v_bfe_u32 v7, v0, 4, 1
  v_bfe_u32 v8, v0, 1, 1
  v_lshl_add_u32 v7, v7, 1, v8
  v_mad_u32_u24 v245, v7, 36, v6
  v_lshrrev_b32 v7, 5, v0
  v_lshl_add_u32 v244, v7, 4, v245
  v_lshrrev_b32 v1, 5, v0
  v_and_b32 v2, 31, v0
  v_lshlrev_b32 v3, 5, v2
  v_lshl_add_u32 v223, v1, 4, v3
  v_lshlrev_b32 v4, 1, v2
  s_mov_b32 s26, 0xfffff9f8
  v_bfe_u32 v4, s26, v4, 2
  v_cmp_gt_u32 vcc, 16, v2
  v_add_u32 v4, 16, v4
  v_lshlrev_b32 v242, 2, v0
  v_cndmask_b32 v4, v4, v2, vcc
  v_lshlrev_b32 v4, 5, v4
  v_lshl_add_u32 v225, v1, 4, v4
  v_mov_b32 v217, 0xdddddddd
  v_lshlrev_b32 v239, 4, v0
  s_mul_i32 s26, s6, 2560
  v_add_u32 v219, s26, v239
  v_lshl_add_u32 v221, v0, 3, s26
  v_add_u32 v254, 151680, v239
  v_add_u32 v255, 151680, v242
  v_mov_b32 v235, 0
  v_mov_b32 v237, 0
  v_mov_b64 v[64:65], 0
  v_mov_b64 v[66:67], 0
  v_mov_b64 v[68:69], 0
  v_mov_b64 v[70:71], 0
  v_mov_b64 v[72:73], 0
  v_mov_b64 v[74:75], 0
  v_mov_b64 v[76:77], 0
  v_mov_b64 v[78:79], 0
  v_mov_b64 v[90:91], 0
  v_mov_b64 v[92:93], 0
  v_mov_b64 v[94:95], 0
  v_lshrrev_b32 v1, 4, v0
  v_and_b32 v2, 15, v0
  v_bfe_u32 v3, v0, 1, 1
  v_and_b32 v7, 7, v0
  v_lshrrev_b32 v5, 1, v1
  v_mul_u32_u24 v5, 9216, v5
  v_and_b32 v6, 1, v1
  v_mul_u32_u24 v6, 576, v6
  v_add_u32 v5, v5, v6
  v_lshl_add_u32 v5, v2, 2, v5
  v_add_u32 v240, 114816, v5
  v_lshrrev_b32 v5, 1, v1
  v_lshlrev_b32 v5, 4, v5
  v_and_b32 v6, 1, v1
  v_bfe_u32 v8, v0, 3, 1
  v_lshl_add_u32 v6, v8, 1, v6
  v_lshl_add_u32 v5, v6, 2, v5
  v_bfe_u32 v8, v0, 2, 1
  v_add_u32 v5, v5, v8
  v_lshlrev_b32 v5, 6, v5
  v_xor_b32 v6, s6, v6
  v_lshl_add_u32 v5, v6, 4, v5
  v_mul_u32_u24 v6, 36992, v3
  v_add_u32 v5, v5, v6
  v_and_b32 v6, 1, v0
  v_lshl_add_u32 v5, v6, 3, v5
  v_add_u32 v241, 40960, v5
  v_mul_u32_u24 v243, 84, v0
  s_and_b32 s24, s2, 7
  s_lshl_b32 s24, s24, 5
  s_lshr_b32 s21, s2, 3
  s_add_u32 s24, s24, s21
  s_mul_i32 s24, s24, 9216
  s_mov_b32 s14, 2359296
  s_mov_b32 s15, 0x20000
  v_bfe_u32 v22, v239, 2, 6
  s_mul_i32 s44, s4, 6
  s_add_u32 s44, s44, s34
  s_mul_i32 s60, s44, 9
  s_add_u32 s60, s60, s5
  s_add_u32 s60, s60, 511
  s_cmp_eq_u32 s5, 0
  s_cselect_b32 s44, s44, s60
  s_cselect_b32 s45, 0xff, 1
  s_lshl_b32 s44, s44, 7
  s_add_u32 s44, s44, 3219456
  s_lshl_b32 s60, s60, 7
  s_add_u32 s60, s60, 3220096
  v_mov_b32 v20, 163072
  v_mov_b32 v21, 1
  v_lshlrev_b32 v31, 13, v0
  v_lshrrev_b32 v14, 4, v0
  v_lshrrev_b32 v16, 2, v0
  v_mul_u32_u24 v16, 9216, v16
  v_and_b32 v15, 3, v0
  v_xor_b32 v15, v15, v14
  v_lshl_add_u32 v238, v15, 4, v16
  s_and_b32 s56, s2, 7
  s_mul_i32 s56, s56, 18
  s_lshr_b32 s57, s2, 3
  s_add_u32 s56, s56, s57
  s_mov_b32 s32, s50
  s_and_b32 s33, s51, 0xffff
  s_mov_b32 s35, 0x20000
  s_mov_b32 s40, s52
  s_and_b32 s41, s53, 0xffff
  s_mov_b32 s43, 0x20000
  s_cmp_lt_u32 s2, 144
  s_cselect_b32 s34, 5308416, 0
  s_mov_b32 s42, s34
  s_and_b32 s57, s3, 3
  s_lshl_b32 s58, s57, 10
  s_mul_i32 s62, s57, 147456
  s_lshl_b32 s57, s56, 6
  s_add_u32 s62, s62, s57
  s_mul_i32 s9, s23, s7
  s_add_u32 m0, s22, 34816
  s_add_u32 s9, s9, s25
  buffer_load_dwordx4 v13, s[16:19], s9 offen lds
  s_add_u32 m0, s22, 38912
  s_add_u32 s9, s9, s27
  buffer_load_dwordx4 v13, s[28:31], s9 offen lds
  s_add_u32 s23, s23, 1
  s_cmp_eq_u32 s23, 9
  s_cselect_b32 s23, 0, s23
  s_waitcnt vmcnt(4)
  s_barrier
  s_mul_i32 s9, s23, s7
  s_add_u32 m0, s22, 49152
  s_add_u32 s9, s9, s25
  buffer_load_dwordx4 v13, s[16:19], s9 offen lds
  s_add_u32 m0, s22, 53248
  s_add_u32 s9, s9, s27
  buffer_load_dwordx4 v13, s[28:31], s9 offen lds
  s_add_u32 s23, s23, 1
  s_cmp_eq_u32 s23, 9
  s_cselect_b32 s23, 0, s23
  s_waitcnt vmcnt(4)
  s_barrier
  s_mul_i32 s9, s23, s7
  s_add_u32 m0, s22, 63488
  s_add_u32 s9, s9, s25
  buffer_load_dwordx4 v13, s[16:19], s9 offen lds
  s_add_u32 m0, s22, 67584
  s_add_u32 s9, s9, s27
  buffer_load_dwordx4 v13, s[28:31], s9 offen lds
  s_add_u32 s23, s23, 1
  s_cmp_eq_u32 s23, 9
  s_cselect_b32 s23, 0, s23
  s_waitcnt vmcnt(4)
  s_barrier
  s_mul_i32 s9, s23, s7
  s_add_u32 m0, s22, 77824
  s_add_u32 s9, s9, s25
  buffer_load_dwordx4 v13, s[16:19], s9 offen lds
  s_add_u32 m0, s22, 81920
  s_add_u32 s9, s9, s27
  buffer_load_dwordx4 v13, s[28:31], s9 offen lds
  s_add_u32 s23, s23, 1
  s_cmp_eq_u32 s23, 9
  s_cselect_b32 s23, 0, s23
  s_mov_b32 m0, 136576
  s_nop 0
  buffer_load_dwordx4 v239, s[12:15], s24 offen offset:0 lds
  s_mov_b32 m0, 136576
  s_nop 0
  buffer_load_dwordx4 v239, s[12:15], s24 offen offset:1024 lds
  s_mov_b32 m0, 136576
  s_nop 0
  buffer_load_dwordx4 v239, s[12:15], s24 offen offset:2048 lds
  s_waitcnt vmcnt(7)
  s_barrier
  s_mul_i32 s9, s23, s7
  s_add_u32 m0, s22, 92160
  s_add_u32 s9, s9, s25
  buffer_load_dwordx4 v13, s[16:19], s9 offen lds
  s_add_u32 m0, s22, 96256
  s_add_u32 s9, s9, s27
  buffer_load_dwordx4 v13, s[28:31], s9 offen lds
  s_add_u32 s23, s23, 1
  s_cmp_eq_u32 s23, 9
  s_cselect_b32 s23, 0, s23
  s_add_u32 s24, s24, 3072
  s_mov_b32 m0, 139648
  s_nop 0
  buffer_load_dwordx4 v239, s[12:15], s24 offen offset:0 lds
  s_mov_b32 m0, 139648
  s_nop 0
  buffer_load_dwordx4 v239, s[12:15], s24 offen offset:1024 lds
  s_mov_b32 m0, 139648
  s_nop 0
  buffer_load_dwordx4 v239, s[12:15], s24 offen offset:2048 lds
  s_waitcnt vmcnt(10)
  s_barrier
  s_mul_i32 s9, s23, s7
  s_add_u32 m0, s22, 106496
  s_add_u32 s9, s9, s25
  buffer_load_dwordx4 v13, s[16:19], s9 offen lds
  s_add_u32 m0, s22, 110592
  s_add_u32 s9, s9, s27
  buffer_load_dwordx4 v13, s[28:31], s9 offen lds
  s_add_u32 s23, s23, 1
  s_cmp_eq_u32 s23, 9
  s_cselect_b32 s23, 0, s23
  s_add_u32 s24, s24, 3072
  s_mov_b32 m0, 142720
  s_nop 0
  buffer_load_dwordx4 v239, s[12:15], s24 offen offset:0 lds
  s_mov_b32 m0, 142720
  s_nop 0
  buffer_load_dwordx4 v239, s[12:15], s24 offen offset:1024 lds
  s_mov_b32 m0, 142720
  s_nop 0
  buffer_load_dwordx4 v239, s[12:15], s24 offen offset:2048 lds
  s_waitcnt vmcnt(13)
  s_barrier
  s_mul_i32 s9, s23, s7
  s_add_u32 m0, s22, 120832
  s_add_u32 s9, s9, s25
  buffer_load_dwordx4 v13, s[16:19], s9 offen lds
  s_add_u32 m0, s22, 124928
  s_add_u32 s9, s9, s27
  buffer_load_dwordx4 v13, s[28:31], s9 offen lds
  s_add_u32 s23, s23, 1
  s_cmp_eq_u32 s23, 9
  s_cselect_b32 s23, 0, s23
  s_waitcnt vmcnt(10)
  s_barrier
  s_mov_b64 s[16:17], s[38:39]
  s_mov_b32 s18, 663552
  s_mul_i32 s25, s6, 144
  s_add_u32 s25, s25, s5
  s_add_u32 s25, s25, 4
  s_lshl_b32 s25, s25, 7
  s_lshl_b32 s21, s6, 11
  v_and_b32 v13, 2, v9
  v_xor_b32 v13, v13, v0
  v_and_b32 v13, 7, v13
  v_lshl_add_u32 v13, v13, 4, v12
  v_xor_b32 v19, 64, v13
  v_add_u32 v19, 8192, v19
  s_mul_i32 s9, s23, 73728
  s_add_u32 m0, s21, 0
  s_add_u32 s9, s9, s25
  buffer_load_dwordx4 v13, s[16:19], s9 offen lds
  buffer_load_dwordx4 v19, s[16:19], s9 offen offset:1024 lds
  s_add_u32 s23, s23, 1
  s_cmp_eq_u32 s23, 9
  s_cselect_b32 s23, 0, s23
  s_mul_i32 s9, s23, 73728
  s_add_u32 m0, s21, 8192
  s_add_u32 s9, s9, s25
  buffer_load_dwordx4 v13, s[16:19], s9 offen lds
  buffer_load_dwordx4 v19, s[16:19], s9 offen offset:1024 lds
  s_add_u32 s23, s23, 1
  s_cmp_eq_u32 s23, 9
  s_cselect_b32 s23, 0, s23
  s_waitcnt vmcnt(4)
  s_barrier
  s_waitcnt lgkmcnt(0)
  s_barrier
  global_load_dword v23, v22, s[66:67] sc1
  s_mov_b32 s8, s46
  s_and_b32 s9, s47, 0xffff
  s_mov_b32 s10, 4761600
  s_mov_b32 s11, 0x20000
  s_barrier
  s_waitcnt vmcnt(0)
  s_mov_b32 s61, 0
K1_WCa:
  v_cmp_eq_u32 vcc, 0, v23
  s_add_u32 s61, s61, 1
  s_cmp_lt_u32 s61, 262144
  s_cselect_b64 vcc, vcc, 0
  s_cbranch_vccz K1_WDa
  global_load_dword v23, v22, s[66:67] sc1
  s_waitcnt vmcnt(0)
  s_branch K1_WCa
K1_WDa:
  s_mov_b64 exec, 1
  ds_add_rtn_u32 v20, v20, v21
  s_waitcnt lgkmcnt(0)
  v_cmp_eq_u32 vcc, 3, v20
  s_cbranch_vccz K1_NOFLb
  s_mov_b32 exec_lo, s45
  buffer_store_dword v21, v31, s[8:11], s44 offen sc1
K1_NOFLb:
  s_mov_b64 exec, -1
  s_mov_b32 s45, 1
  s_barrier
  s_sub_u32 s25, s25, 55296
  s_mul_i32 s26, s23, 73728
  s_add_u32 s26, s26, s25
  s_mov_b32 m0, 16384
  s_nop 0
  buffer_load_dwordx4 v13, s[16:19], s26 offen lds
  buffer_load_dwordx4 v19, s[16:19], s26 offen offset:1024 lds
  s_mov_b32 m0, 18432
  s_add_u32 s26, s26, 18432
  buffer_load_dwordx4 v13, s[16:19], s26 offen lds
  buffer_load_dwordx4 v19, s[16:19], s26 offen offset:1024 lds
  s_mov_b32 m0, 20480
  s_add_u32 s26, s26, 18432
  buffer_load_dwordx4 v13, s[16:19], s26 offen lds
  buffer_load_dwordx4 v19, s[16:19], s26 offen offset:1024 lds
  s_mov_b32 m0, 22528
  s_add_u32 s26, s26, 18432
  buffer_load_dwordx4 v13, s[16:19], s26 offen lds
  buffer_load_dwordx4 v19, s[16:19], s26 offen offset:1024 lds
  s_add_u32 s23, s23, 1
  s_cmp_eq_u32 s23, 9
  s_cselect_b32 s23, 0, s23
  s_mul_i32 s26, s23, 73728
  s_add_u32 s26, s26, s25
  s_mov_b32 m0, 24576
  s_nop 0
  buffer_load_dwordx4 v13, s[16:19], s26 offen lds
  buffer_load_dwordx4 v19, s[16:19], s26 offen offset:1024 lds
  s_mov_b32 m0, 26624
  s_add_u32 s26, s26, 18432
  buffer_load_dwordx4 v13, s[16:19], s26 offen lds
  buffer_load_dwordx4 v19, s[16:19], s26 offen offset:1024 lds
  s_mov_b32 m0, 28672
  s_add_u32 s26, s26, 18432
  buffer_load_dwordx4 v13, s[16:19], s26 offen lds
  buffer_load_dwordx4 v19, s[16:19], s26 offen offset:1024 lds
  s_mov_b32 m0, 30720
  s_add_u32 s26, s26, 18432
  buffer_load_dwordx4 v13, s[16:19], s26 offen lds
  buffer_load_dwordx4 v19, s[16:19], s26 offen offset:1024 lds
  s_add_u32 s23, s23, 1
  s_cmp_eq_u32 s23, 9
  s_cselect_b32 s23, 0, s23
  s_mul_i32 s26, s23, 73728
  s_add_u32 s26, s26, s25
  s_mov_b32 m0, 32768
  s_nop 0
  buffer_load_dwordx4 v13, s[16:19], s26 offen lds
  buffer_load_dwordx4 v19, s[16:19], s26 offen offset:1024 lds
  s_mov_b32 m0, 34816
  s_add_u32 s26, s26, 18432
  buffer_load_dwordx4 v13, s[16:19], s26 offen lds
  buffer_load_dwordx4 v19, s[16:19], s26 offen offset:1024 lds
  s_mov_b32 m0, 36864
  s_add_u32 s26, s26, 18432
  buffer_load_dwordx4 v13, s[16:19], s26 offen lds
  buffer_load_dwordx4 v19, s[16:19], s26 offen offset:1024 lds
  s_mov_b32 m0, 38912
  s_add_u32 s26, s26, 18432
  buffer_load_dwordx4 v13, s[16:19], s26 offen lds
  buffer_load_dwordx4 v19, s[16:19], s26 offen offset:1024 lds
  s_add_u32 s23, s23, 1
  s_cmp_eq_u32 s23, 9
  s_cselect_b32 s23, 0, s23
  s_mul_i32 s26, s23, 73728
  s_add_u32 s26, s26, s25
  s_mov_b32 m0, 40960
  s_nop 0
  buffer_load_dwordx4 v13, s[16:19], s26 offen lds
  buffer_load_dwordx4 v19, s[16:19], s26 offen offset:1024 lds
  s_mov_b32 m0, 43008
  s_add_u32 s26, s26, 18432
  buffer_load_dwordx4 v13, s[16:19], s26 offen lds
  buffer_load_dwordx4 v19, s[16:19], s26 offen offset:1024 lds
  s_mov_b32 m0, 45056
  s_add_u32 s26, s26, 18432
  buffer_load_dwordx4 v13, s[16:19], s26 offen lds
  buffer_load_dwordx4 v19, s[16:19], s26 offen offset:1024 lds
  s_mov_b32 m0, 47104
  s_add_u32 s26, s26, 18432
  buffer_load_dwordx4 v13, s[16:19], s26 offen lds
  buffer_load_dwordx4 v19, s[16:19], s26 offen offset:1024 lds
  s_add_u32 s23, s23, 1
  s_cmp_eq_u32 s23, 9
  s_cselect_b32 s23, 0, s23
  s_mul_i32 s26, s23, 73728
  s_add_u32 s26, s26, s25
  s_mov_b32 m0, 49152
  s_nop 0
  buffer_load_dwordx4 v13, s[16:19], s26 offen lds
  buffer_load_dwordx4 v19, s[16:19], s26 offen offset:1024 lds
  s_mov_b32 m0, 51200
  s_add_u32 s26, s26, 18432
  buffer_load_dwordx4 v13, s[16:19], s26 offen lds
  buffer_load_dwordx4 v19, s[16:19], s26 offen offset:1024 lds
  s_mov_b32 m0, 53248
  s_add_u32 s26, s26, 18432
  buffer_load_dwordx4 v13, s[16:19], s26 offen lds
  buffer_load_dwordx4 v19, s[16:19], s26 offen offset:1024 lds
  s_mov_b32 m0, 55296
  s_add_u32 s26, s26, 18432
  buffer_load_dwordx4 v13, s[16:19], s26 offen lds
  buffer_load_dwordx4 v19, s[16:19], s26 offen offset:1024 lds
  s_add_u32 s23, s23, 1
  s_cmp_eq_u32 s23, 9
  s_cselect_b32 s23, 0, s23
  s_waitcnt vmcnt(24)
  s_barrier
  s_mul_i32 s26, s23, 73728
  s_add_u32 s26, s26, s25
  s_mov_b32 m0, 57344
  s_nop 0
  buffer_load_dwordx4 v13, s[16:19], s26 offen lds
  buffer_load_dwordx4 v19, s[16:19], s26 offen offset:1024 lds
  s_mov_b32 m0, 59392
  s_add_u32 s26, s26, 18432
  buffer_load_dwordx4 v13, s[16:19], s26 offen lds
  buffer_load_dwordx4 v19, s[16:19], s26 offen offset:1024 lds
  s_mov_b32 m0, 61440
  s_add_u32 s26, s26, 18432
  buffer_load_dwordx4 v13, s[16:19], s26 offen lds
  buffer_load_dwordx4 v19, s[16:19], s26 offen offset:1024 lds
  s_mov_b32 m0, 63488
  s_add_u32 s26, s26, 18432
  buffer_load_dwordx4 v13, s[16:19], s26 offen lds
  buffer_load_dwordx4 v19, s[16:19], s26 offen offset:1024 lds
  s_add_u32 s23, s23, 1
  s_cmp_eq_u32 s23, 9
  s_cselect_b32 s23, 0, s23
  s_mul_i32 s26, s23, 73728
  s_add_u32 s26, s26, s25
  s_mov_b32 m0, 65536
  s_nop 0
  buffer_load_dwordx4 v13, s[16:19], s26 offen lds
  buffer_load_dwordx4 v19, s[16:19], s26 offen offset:1024 lds
  s_mov_b32 m0, 67584
  s_add_u32 s26, s26, 18432
  buffer_load_dwordx4 v13, s[16:19], s26 offen lds
  buffer_load_dwordx4 v19, s[16:19], s26 offen offset:1024 lds
  s_mov_b32 m0, 69632
  s_add_u32 s26, s26, 18432
  buffer_load_dwordx4 v13, s[16:19], s26 offen lds
  buffer_load_dwordx4 v19, s[16:19], s26 offen offset:1024 lds
  s_mov_b32 m0, 71680
  s_add_u32 s26, s26, 18432
  buffer_load_dwordx4 v13, s[16:19], s26 offen lds
  buffer_load_dwordx4 v19, s[16:19], s26 offen offset:1024 lds
  s_add_u32 s23, s23, 1
  s_cmp_eq_u32 s23, 9
  s_cselect_b32 s23, 0, s23
  s_waitcnt vmcnt(16)
  s_barrier
  s_waitcnt vmcnt(0)
  s_barrier
  s_branch K2_B
K1_COMP:
  s_setprio 1
  v_lshrrev_b32 v8, 4, v0
  v_and_b32 v9, 15, v0
  v_lshrrev_b32 v1, 1, v9
  v_xor_b32 v1, v1, v8
  v_lshlrev_b32 v1, 4, v1
  v_lshl_add_u32 v1, v9, 7, v1
  v_xor_b32 v2, 64, v1
  v_bfe_u32 v3, v0, 2, 2
  v_lshl_add_u32 v3, v8, 3, v3
  v_lshlrev_b32 v3, 6, v3
  v_xor_b32 v10, s3, v8
  v_and_b32 v10, 1, v10
  v_lshl_add_u32 v3, v10, 5, v3
  v_and_b32 v10, 3, v0
  v_lshl_add_u32 v3, v10, 3, v3
  s_lshr_b32 s20, s3, 1
  v_lshl_add_u32 v3, s20, 12, v3
  v_bfe_u32 v6, v0, 2, 2
  v_lshl_add_u32 v6, v8, 3, v6
  v_lshlrev_b32 v6, 7, v6
  v_lshl_add_u32 v6, v10, 3, v6
  v_bfe_u32 v10, v0, 3, 2
  v_xor_b32 v10, s3, v10
  v_lshl_add_u32 v6, v10, 5, v6
  v_lshlrev_b32 v4, 3, v9
  v_add_u32 v4, 129024, v4
  v_mul_u32_u24 v5, 144, v9
  v_lshl_add_u32 v5, v8, 3, v5
  s_lshl_b32 s20, s3, 5
  s_add_u32 s20, s20, 129536
  v_add_u32 v5, s20, v5
  v_mov_b32 v24, 0x3f803f80
  v_mov_b32 v25, 0x3f803f80
  v_mov_b32 v26, 0x3f803f80
  v_mov_b32 v27, 0x3f803f80
  s_waitcnt lgkmcnt(0)
  s_lshl3_add_u32 s44, s3, s35
  s_mul_i32 s44, s44, 9
  s_add_u32 s44, s44, s5
  s_add_u32 s44, s44, 4
  s_lshl_b32 s44, s44, 7
  s_add_u32 s45, s44, 36864
  s_cmp_lt_u32 s34, 4
  s_cselect_b32 s45, s45, 0x10000000
  s_cmp_lt_u32 s3, 2
  s_cselect_b32 s45, s45, 0x10000000
  s_mul_i32 s70, s4, 6
  s_add_u32 s70, s70, s34
  s_mul_i32 s70, s70, 9
  s_add_u32 s70, s70, s5
  s_lshl_b32 s70, s70, 7
  s_add_u32 s70, s70, 3285504
  s_mov_b32 s60, 0x3eae1a93
  s_cmp_eq_u32 s5, 0
  s_cselect_b32 s60, 1.0, s60
  s_cselect_b32 s67, s3, 0
  s_cmp_eq_u32 s67, 3
  s_cselect_b32 s67, 0xffff, 0
  s_mov_b32 s66, 0
  s_cmp_lg_u32 s3, 1
  s_cbranch_scc1 K1_NORS
  s_mov_b32 s28, s48
  s_and_b32 s29, s49, 0xffff
  s_mov_b32 s30, 1152
  s_mov_b32 s31, 0x20000
  s_mov_b32 m0, 161920
  v_lshlrev_b32 v123, 4, v0
  buffer_load_dwordx4 v123, s[28:31], 0 offen lds
  s_mov_b64 exec, 0xff
  buffer_load_dwordx4 v123, s[28:31], 0 offen offset:1024 lds
  s_mov_b64 exec, -1
  v_mov_b32 v122, 0
  v_mov_b32 v123, 163072
  ds_write_b32 v123, v122
  s_waitcnt lgkmcnt(0)
K1_NORS:
  s_mov_b32 s8, s46
  s_and_b32 s9, s47, 0xffff
  s_mov_b32 s10, 4761600
  s_mov_b32 s11, 0x20000
  s_and_b32 s4, s2, 7
  s_lshl_b32 s4, s4, 5
  s_lshr_b32 s5, s2, 3
  s_add_u32 s4, s4, s5
  s_mul_i32 s5, s4, 9216
  s_and_b32 s6, s3, 3
  s_mul_i32 s7, s6, 2560
  s_mov_b32 s12, s36
  s_and_b32 s13, s37, 0xffff
  s_mov_b32 s14, 2359296
  s_mov_b32 s15, 0x20000
  s_mov_b32 s16, s64
  s_and_b32 s17, s65, 0xffff
  s_mov_b32 s18, 2359296
  s_mov_b32 s19, 0x20000
  s_lshl_b32 s23, s6, 3
  s_lshl_b32 s22, s23, 8
  s_add_u32 s22, s22, 2424832
  s_lshl_b32 s20, s23, 11
  s_add_u32 s20, s20, 2359296
  s_mul_i32 s21, s23, 2560
  s_add_u32 s21, s21, 2433024
  s_mul_i32 s25, s6, 288
  s_and_b32 s56, s2, 7
  s_mul_i32 s56, s56, 18
  s_lshr_b32 s57, s2, 3
  s_add_u32 s56, s56, s57
  s_mov_b32 s32, s50
  s_and_b32 s33, s51, 0xffff
  s_mov_b32 s35, 0x20000
  s_mov_b32 s40, s52
  s_and_b32 s41, s53, 0xffff
  s_mov_b32 s43, 0x20000
  s_cmp_lt_u32 s2, 144
  s_cselect_b32 s34, 5308416, 0
  s_mov_b32 s42, s34
  s_and_b32 s57, s3, 3
  s_lshl_b32 s58, s57, 10
  s_mul_i32 s62, s57, 147456
  s_lshl_b32 s57, s56, 6
  s_add_u32 s62, s62, s57
  s_mov_b32 s28, s54
  s_and_b32 s29, s55, 0xffff
  s_mov_b32 s30, 5308416
  s_mov_b32 s31, 0x20000
  s_lshr_b32 s26, s2, 3
  s_lshl_b32 s26, s26, 2
  s_add_u32 s26, s26, s6
  s_and_b32 s64, s2, 7
  s_mul_i32 s64, s64, 81
  s_add_u32 s64, s64, s26
  s_sub_u32 s64, s64, 72
  s_lshl_b32 s64, s64, 13
  s_add_u32 s65, s64, 458752
  s_cmp_lt_u32 s26, 97
  s_cselect_b32 s65, s65, 0x10000000
  s_mul_i32 s59, s6, 2304
  s_add_u32 s59, s59, s5
  s_lshl_b32 s61, s4, 2
  s_add_u32 s61, s61, s6
  s_lshl_b32 s61, s61, 5
  s_add_u32 s61, s61, 2523136
  s_lshl_b32 s63, s2, 2
  s_add_u32 s63, s63, s6
  s_lshl_b32 s63, s63, 10
  s_add_u32 s63, s63, 2826240
  s_cmp_lt_u32 s2, 144
  s_cselect_b32 s30, 0, s30
  s_mul_i32 s27, s6, 18432
  s_add_u32 s27, s27, 2555904
  s_lshl_b32 s68, s3, 10
  s_and_b32 s69, s2, 7
  s_lshl_b32 s69, s69, 2
  s_add_u32 s69, s69, s3
  s_lshl_b32 s69, s69, 11
  s_add_u32 s69, s69, 3350528
  s_lshl_b32 s71, s3, 7
  s_lshl_b32 s49, s3, 5
  s_add_u32 s49, s49, 30208
  s_bfe_i32 s50, s3, 0x10000
  s_mul_i32 s72, s6, 9216
  s_mul_i32 s73, s56, 36864
  s_add_u32 s73, s73, s72
  s_lshl_b32 s46, s56, 6
  s_add_u32 s46, s46, 3416064
  s_and_b32 s36, s56, 12
  s_lshr_b32 s37, s56, 4
  s_lshl_b32 s38, s37, 10
  s_bfe_u32 s47, s56, 0x10001
  s_lshl_b32 s47, s47, 8
  s_add_u32 s38, s38, s47
  s_and_b32 s47, s56, 1
  s_lshl_b32 s47, s47, 1
  s_add_u32 s47, s47, s36
  s_lshl_b32 s47, s47, 4
  s_add_u32 s38, s38, s47
  s_lshl_b32 s37, s37, 7
  s_and_b32 s47, s56, 3
  s_lshl_b32 s47, s47, 4
  s_add_u32 s37, s37, s47
  s_lshl_b32 s36, s36, 2
  s_lshl_b32 s39, s6, 7
  s_add_u32 s39, s39, 18944
  s_sub_u32 s26, s26, 72
  s_mul_i32 s48, s26, 64512
  s_and_b32 s51, s2, 7
  s_mul_i32 s51, s51, 1152
  s_add_u32 s48, s48, s51
  s_add_u32 s51, s48, 3612672
  s_and_b32 s53, s53, 0xffff
  s_mov_b32 s54, s30
  s_mov_b32 s55, 0x20000
  s_barrier
  ds_read_b64_tr_b16 v[28:29], v3 offset:6144
  ds_read_b64_tr_b16 v[30:31], v3 offset:6400
  ds_read_b128 v[40:43], v1 offset:0
  ds_read_b128 v[44:47], v1 offset:2048
  ds_read_b128 v[48:51], v1 offset:4096
  ds_read_b64_tr_b16 v[32:33], v3 offset:8192
  ds_read_b64_tr_b16 v[34:35], v3 offset:8448
  s_waitcnt lgkmcnt(5)
  v_mfma_f32_16x16x32_bf16 v[20:23], v[28:31], v[24:27], 0
  ds_read_b128 v[52:55], v2 offset:0
  s_waitcnt lgkmcnt(5)
  v_mfma_f32_16x16x32_bf16 v[8:11], v[28:31], v[40:43], 0
  ds_read_b128 v[56:59], v2 offset:2048
  s_waitcnt lgkmcnt(5)
  v_mfma_f32_16x16x32_bf16 v[12:15], v[28:31], v[44:47], 0
  ds_read_b128 v[60:63], v2 offset:4096
  s_waitcnt lgkmcnt(5)
  v_mfma_f32_16x16x32_bf16 v[16:19], v[28:31], v[48:51], 0
  s_barrier
  ds_read_b64_tr_b16 v[36:37], v3 offset:20480
  ds_read_b64_tr_b16 v[38:39], v3 offset:20736
  s_waitcnt lgkmcnt(5)
  v_mfma_f32_16x16x32_bf16 v[20:23], v[32:35], v[24:27], v[20:23]
  ds_read_b128 v[64:67], v1 offset:14336
  s_waitcnt lgkmcnt(5)
  v_mfma_f32_16x16x32_bf16 v[8:11], v[32:35], v[52:55], v[8:11]
  ds_read_b128 v[68:71], v1 offset:16384
  s_waitcnt lgkmcnt(5)
  v_mfma_f32_16x16x32_bf16 v[12:15], v[32:35], v[56:59], v[12:15]
  ds_read_b128 v[72:75], v1 offset:18432
  s_waitcnt lgkmcnt(5)
  v_mfma_f32_16x16x32_bf16 v[16:19], v[32:35], v[60:63], v[16:19]
  ds_read_b64_tr_b16 v[28:29], v3 offset:22528
  ds_read_b64_tr_b16 v[30:31], v3 offset:22784
  s_waitcnt lgkmcnt(5)
  v_mfma_f32_16x16x32_bf16 v[20:23], v[36:39], v[24:27], v[20:23]
  ds_read_b128 v[76:79], v2 offset:14336
  s_waitcnt lgkmcnt(5)
  v_mfma_f32_16x16x32_bf16 v[8:11], v[36:39], v[64:67], v[8:11]
  ds_read_b128 v[80:83], v2 offset:16384
  s_waitcnt lgkmcnt(5)
  v_mfma_f32_16x16x32_bf16 v[12:15], v[36:39], v[68:71], v[12:15]
  ds_read_b128 v[84:87], v2 offset:18432
  s_waitcnt lgkmcnt(5)
  v_mfma_f32_16x16x32_bf16 v[16:19], v[36:39], v[72:75], v[16:19]
  s_barrier
  ds_read_b64_tr_b16 v[32:33], v3 offset:34816
  ds_read_b64_tr_b16 v[34:35], v3 offset:35072
  s_waitcnt lgkmcnt(5)
  v_mfma_f32_16x16x32_bf16 v[20:23], v[28:31], v[24:27], v[20:23]
  ds_read_b128 v[88:91], v1 offset:28672
  s_waitcnt lgkmcnt(5)
  v_mfma_f32_16x16x32_bf16 v[8:11], v[28:31], v[76:79], v[8:11]
  ds_read_b128 v[92:95], v1 offset:30720
  s_waitcnt lgkmcnt(5)
  v_mfma_f32_16x16x32_bf16 v[12:15], v[28:31], v[80:83], v[12:15]
  ds_read_b128 v[96:99], v1 offset:32768
  s_waitcnt lgkmcnt(5)
  v_mfma_f32_16x16x32_bf16 v[16:19], v[28:31], v[84:87], v[16:19]
  ds_read_b64_tr_b16 v[36:37], v3 offset:36864
  ds_read_b64_tr_b16 v[38:39], v3 offset:37120
  s_waitcnt lgkmcnt(5)
  v_mfma_f32_16x16x32_bf16 v[20:23], v[32:35], v[24:27], v[20:23]
  ds_read_b128 v[100:103], v2 offset:28672
  s_waitcnt lgkmcnt(5)
  v_mfma_f32_16x16x32_bf16 v[8:11], v[32:35], v[88:91], v[8:11]
  ds_read_b128 v[104:107], v2 offset:30720
  s_waitcnt lgkmcnt(5)
  v_mfma_f32_16x16x32_bf16 v[12:15], v[32:35], v[92:95], v[12:15]
  ds_read_b128 v[108:111], v2 offset:32768
  s_waitcnt lgkmcnt(5)
  v_mfma_f32_16x16x32_bf16 v[16:19], v[32:35], v[96:99], v[16:19]
  s_barrier
  ds_read_b64_tr_b16 v[28:29], v3 offset:49152
  ds_read_b64_tr_b16 v[30:31], v3 offset:49408
  s_waitcnt lgkmcnt(5)
  v_mfma_f32_16x16x32_bf16 v[20:23], v[36:39], v[24:27], v[20:23]
  ds_read_b128 v[112:115], v1 offset:43008
  s_waitcnt lgkmcnt(5)
  v_mfma_f32_16x16x32_bf16 v[8:11], v[36:39], v[100:103], v[8:11]
  ds_read_b128 v[116:119], v1 offset:45056
  s_waitcnt lgkmcnt(5)
  v_mfma_f32_16x16x32_bf16 v[12:15], v[36:39], v[104:107], v[12:15]
  ds_read_b128 v[120:123], v1 offset:47104
  s_waitcnt lgkmcnt(5)
  v_mfma_f32_16x16x32_bf16 v[16:19], v[36:39], v[108:111], v[16:19]
  ds_read_b64_tr_b16 v[32:33], v3 offset:51200
  ds_read_b64_tr_b16 v[34:35], v3 offset:51456
  s_waitcnt lgkmcnt(5)
  v_mfma_f32_16x16x32_bf16 v[20:23], v[28:31], v[24:27], v[20:23]
  ds_read_b128 v[124:127], v2 offset:43008
  s_waitcnt lgkmcnt(5)
  v_mfma_f32_16x16x32_bf16 v[8:11], v[28:31], v[112:115], v[8:11]
  ds_read_b128 v[128:131], v2 offset:45056
  s_waitcnt lgkmcnt(5)
  v_mfma_f32_16x16x32_bf16 v[12:15], v[28:31], v[116:119], v[12:15]
  ds_read_b128 v[132:135], v2 offset:47104
  s_waitcnt lgkmcnt(5)
  v_mfma_f32_16x16x32_bf16 v[16:19], v[28:31], v[120:123], v[16:19]
  s_barrier
  v_add_u32 v1, 57344, v1
  v_add_u32 v2, 57344, v2
  v_add_u32 v3, 57344, v3
  ds_read_b64_tr_b16 v[36:37], v3 offset:6144
  ds_read_b64_tr_b16 v[38:39], v3 offset:6400
  s_waitcnt lgkmcnt(5)
  v_mfma_f32_16x16x32_bf16 v[20:23], v[32:35], v[24:27], v[20:23]
  ds_read_b128 v[136:139], v1 offset:0
  s_waitcnt lgkmcnt(5)
  v_mfma_f32_16x16x32_bf16 v[8:11], v[32:35], v[124:127], v[8:11]
  ds_read_b128 v[140:143], v1 offset:2048
  s_waitcnt lgkmcnt(5)
  v_mfma_f32_16x16x32_bf16 v[12:15], v[32:35], v[128:131], v[12:15]
  ds_read_b128 v[144:147], v1 offset:4096
  s_waitcnt lgkmcnt(5)
  v_mfma_f32_16x16x32_bf16 v[16:19], v[32:35], v[132:135], v[16:19]
  ds_read_b64_tr_b16 v[28:29], v3 offset:8192
  ds_read_b64_tr_b16 v[30:31], v3 offset:8448
  s_waitcnt lgkmcnt(5)
  v_mfma_f32_16x16x32_bf16 v[20:23], v[36:39], v[24:27], v[20:23]
  ds_read_b128 v[148:151], v2 offset:0
  s_waitcnt lgkmcnt(5)
  v_mfma_f32_16x16x32_bf16 v[8:11], v[36:39], v[136:139], v[8:11]
  ds_read_b128 v[152:155], v2 offset:2048
  s_waitcnt lgkmcnt(5)
  v_mfma_f32_16x16x32_bf16 v[12:15], v[36:39], v[140:143], v[12:15]
  ds_read_b128 v[156:159], v2 offset:4096
  s_waitcnt lgkmcnt(5)
  v_mfma_f32_16x16x32_bf16 v[16:19], v[36:39], v[144:147], v[16:19]
  s_barrier
  ds_read_b64_tr_b16 v[32:33], v3 offset:20480
  ds_read_b64_tr_b16 v[34:35], v3 offset:20736
  s_waitcnt lgkmcnt(5)
  v_mfma_f32_16x16x32_bf16 v[20:23], v[28:31], v[24:27], v[20:23]
  ds_read_b128 v[160:163], v1 offset:14336
  s_waitcnt lgkmcnt(5)
  v_mfma_f32_16x16x32_bf16 v[8:11], v[28:31], v[148:151], v[8:11]
  ds_read_b128 v[164:167], v1 offset:16384
  s_waitcnt lgkmcnt(5)
  v_mfma_f32_16x16x32_bf16 v[12:15], v[28:31], v[152:155], v[12:15]
  ds_read_b128 v[168:171], v1 offset:18432
  s_waitcnt lgkmcnt(5)
  v_mfma_f32_16x16x32_bf16 v[16:19], v[28:31], v[156:159], v[16:19]
  ds_read_b64_tr_b16 v[36:37], v3 offset:22528
  ds_read_b64_tr_b16 v[38:39], v3 offset:22784
  s_waitcnt lgkmcnt(5)
  v_mfma_f32_16x16x32_bf16 v[20:23], v[32:35], v[24:27], v[20:23]
  ds_read_b128 v[172:175], v2 offset:14336
  s_waitcnt lgkmcnt(5)
  v_mfma_f32_16x16x32_bf16 v[8:11], v[32:35], v[160:163], v[8:11]
  ds_read_b128 v[176:179], v2 offset:16384
  s_waitcnt lgkmcnt(5)
  v_mfma_f32_16x16x32_bf16 v[12:15], v[32:35], v[164:167], v[12:15]
  ds_read_b128 v[180:183], v2 offset:18432
  s_waitcnt lgkmcnt(5)
  v_mfma_f32_16x16x32_bf16 v[16:19], v[32:35], v[168:171], v[16:19]
  s_barrier
  ds_read_b64_tr_b16 v[28:29], v3 offset:34816
  ds_read_b64_tr_b16 v[30:31], v3 offset:35072
  s_waitcnt lgkmcnt(5)
  v_mfma_f32_16x16x32_bf16 v[20:23], v[36:39], v[24:27], v[20:23]
  ds_read_b128 v[184:187], v1 offset:28672
  s_waitcnt lgkmcnt(5)
  v_mfma_f32_16x16x32_bf16 v[8:11], v[36:39], v[172:175], v[8:11]
  ds_read_b128 v[188:191], v1 offset:30720
  s_waitcnt lgkmcnt(5)
  v_mfma_f32_16x16x32_bf16 v[12:15], v[36:39], v[176:179], v[12:15]
  ds_read_b128 v[192:195], v1 offset:32768
  s_waitcnt lgkmcnt(5)
  v_mfma_f32_16x16x32_bf16 v[16:19], v[36:39], v[180:183], v[16:19]
  ds_read_b64_tr_b16 v[32:33], v3 offset:36864
  ds_read_b64_tr_b16 v[34:35], v3 offset:37120
  s_waitcnt lgkmcnt(5)
  v_mfma_f32_16x16x32_bf16 v[20:23], v[28:31], v[24:27], v[20:23]
  ds_read_b128 v[196:199], v2 offset:28672
  s_waitcnt lgkmcnt(5)
  v_mfma_f32_16x16x32_bf16 v[8:11], v[28:31], v[184:187], v[8:11]
  ds_read_b128 v[200:203], v2 offset:30720
  s_waitcnt lgkmcnt(5)
  v_mfma_f32_16x16x32_bf16 v[12:15], v[28:31], v[188:191], v[12:15]
  ds_read_b128 v[204:207], v2 offset:32768
  s_waitcnt lgkmcnt(5)
  v_mfma_f32_16x16x32_bf16 v[16:19], v[28:31], v[192:195], v[16:19]
  s_barrier
  ds_read_b64_tr_b16 v[36:37], v3 offset:49152
  ds_read_b64_tr_b16 v[38:39], v3 offset:49408
  s_waitcnt lgkmcnt(5)
  v_mfma_f32_16x16x32_bf16 v[20:23], v[32:35], v[24:27], v[20:23]
  ds_read_b128 v[208:211], v1 offset:43008
  s_waitcnt lgkmcnt(5)
  v_mfma_f32_16x16x32_bf16 v[8:11], v[32:35], v[196:199], v[8:11]
  ds_read_b128 v[212:215], v1 offset:45056
  s_waitcnt lgkmcnt(5)
  v_mfma_f32_16x16x32_bf16 v[12:15], v[32:35], v[200:203], v[12:15]
  ds_read_b128 v[216:219], v1 offset:47104
  s_waitcnt lgkmcnt(5)
  v_mfma_f32_16x16x32_bf16 v[16:19], v[32:35], v[204:207], v[16:19]
  ds_read_b64_tr_b16 v[28:29], v3 offset:51200
  ds_read_b64_tr_b16 v[30:31], v3 offset:51456
  s_waitcnt lgkmcnt(5)
  v_mfma_f32_16x16x32_bf16 v[20:23], v[36:39], v[24:27], v[20:23]
  ds_read_b128 v[220:223], v2 offset:43008
  s_waitcnt lgkmcnt(5)
  v_mfma_f32_16x16x32_bf16 v[8:11], v[36:39], v[208:211], v[8:11]
  ds_read_b128 v[224:227], v2 offset:45056
  s_waitcnt lgkmcnt(5)
  v_mfma_f32_16x16x32_bf16 v[12:15], v[36:39], v[212:215], v[12:15]
  ds_read_b128 v[228:231], v2 offset:47104
  s_waitcnt lgkmcnt(5)
  v_mfma_f32_16x16x32_bf16 v[16:19], v[36:39], v[216:219], v[16:19]
  v_add_u32 v1, 57344, v1
  v_add_u32 v2, 57344, v2
  v_add_u32 v3, 57344, v3
  ds_read_b64_tr_b16 v[32:33], v3 offset:6144
  ds_read_b64_tr_b16 v[34:35], v3 offset:6400
  s_waitcnt lgkmcnt(5)
  v_mfma_f32_16x16x32_bf16 v[20:23], v[28:31], v[24:27], v[20:23]
  ds_read_b128 v[232:235], v1 offset:0
  s_waitcnt lgkmcnt(5)
  v_mfma_f32_16x16x32_bf16 v[8:11], v[28:31], v[220:223], v[8:11]
  ds_read_b128 v[236:239], v1 offset:2048
  s_waitcnt lgkmcnt(5)
  v_mfma_f32_16x16x32_bf16 v[12:15], v[28:31], v[224:227], v[12:15]
  ds_read_b128 v[240:243], v1 offset:4096
  s_waitcnt lgkmcnt(5)
  v_mfma_f32_16x16x32_bf16 v[16:19], v[28:31], v[228:231], v[16:19]
  ds_read_b64_tr_b16 v[36:37], v3 offset:8192
  ds_read_b64_tr_b16 v[38:39], v3 offset:8448
  s_waitcnt lgkmcnt(5)
  v_mfma_f32_16x16x32_bf16 v[20:23], v[32:35], v[24:27], v[20:23]
  ds_read_b128 v[244:247], v2 offset:0
  s_waitcnt lgkmcnt(5)
  v_mfma_f32_16x16x32_bf16 v[8:11], v[32:35], v[232:235], v[8:11]
  ds_read_b128 v[248:251], v2 offset:2048
  s_waitcnt lgkmcnt(5)
  v_mfma_f32_16x16x32_bf16 v[12:15], v[32:35], v[236:239], v[12:15]
  ds_read_b128 v[252:255], v2 offset:4096
  s_waitcnt lgkmcnt(5)
  v_mfma_f32_16x16x32_bf16 v[16:19], v[32:35], v[240:243], v[16:19]
  s_waitcnt lgkmcnt(3)
  v_mfma_f32_16x16x32_bf16 v[20:23], v[36:39], v[24:27], v[20:23]
  s_waitcnt lgkmcnt(2)
  v_mfma_f32_16x16x32_bf16 v[8:11], v[36:39], v[244:247], v[8:11]
  s_waitcnt lgkmcnt(1)
  v_mfma_f32_16x16x32_bf16 v[12:15], v[36:39], v[248:251], v[12:15]
  s_waitcnt lgkmcnt(0)
  v_mfma_f32_16x16x32_bf16 v[16:19], v[36:39], v[252:255], v[16:19]
  v_mov_b32 v7, 0x3f80
  s_barrier
  ds_read_b64 v[28:29], v4 offset:0
  ds_read_b64 v[30:31], v4 offset:128
  ds_read_b64 v[32:33], v4 offset:256
  s_waitcnt lgkmcnt(2)
  v_mul_f32 v29, s60, v29
  v_pk_fma_f32 v[8:9], v[20:21], v[28:29], v[8:9] op_sel_hi:[1,0,1]
  v_pk_mul_f32 v[8:9], v[8:9], v[28:29] op_sel:[0,1] op_sel_hi:[1,1]
  v_pk_fma_f32 v[10:11], v[22:23], v[28:29], v[10:11] op_sel_hi:[1,0,1]
  v_pk_mul_f32 v[10:11], v[10:11], v[28:29] op_sel:[0,1] op_sel_hi:[1,1]
  v_cvt_pk_bf16_f32 v34, v8, v9
  v_cvt_pk_bf16_f32 v35, v10, v11
  v_cndmask_b32 v34, v34, v7, s[66:67]
  ds_write_b64 v5, v[34:35] offset:0
  s_waitcnt lgkmcnt(2)
  v_mul_f32 v31, s60, v31
  v_pk_fma_f32 v[12:13], v[20:21], v[30:31], v[12:13] op_sel_hi:[1,0,1]
  v_pk_mul_f32 v[12:13], v[12:13], v[30:31] op_sel:[0,1] op_sel_hi:[1,1]
  v_pk_fma_f32 v[14:15], v[22:23], v[30:31], v[14:15] op_sel_hi:[1,0,1]
  v_pk_mul_f32 v[14:15], v[14:15], v[30:31] op_sel:[0,1] op_sel_hi:[1,1]
  v_cvt_pk_bf16_f32 v36, v12, v13
  v_cvt_pk_bf16_f32 v37, v14, v15
  v_cndmask_b32 v36, v36, v7, s[66:67]
  ds_write_b64 v5, v[36:37] offset:2304
  s_waitcnt lgkmcnt(2)
  v_mul_f32 v33, s60, v33
  v_pk_fma_f32 v[16:17], v[20:21], v[32:33], v[16:17] op_sel_hi:[1,0,1]
  v_pk_mul_f32 v[16:17], v[16:17], v[32:33] op_sel:[0,1] op_sel_hi:[1,1]
  v_pk_fma_f32 v[18:19], v[22:23], v[32:33], v[18:19] op_sel_hi:[1,0,1]
  v_pk_mul_f32 v[18:19], v[18:19], v[32:33] op_sel:[0,1] op_sel_hi:[1,1]
  v_cvt_pk_bf16_f32 v38, v16, v17
  v_cvt_pk_bf16_f32 v39, v18, v19
  v_cndmask_b32 v38, v38, v7, s[66:67]
  ds_write_b64 v5, v[38:39] offset:4608
  s_waitcnt lgkmcnt(0)
  s_barrier
  v_add_u32 v3, 57344, v6
  s_barrier
  ds_read_b64_tr_b16 v[28:29], v6 offset:0
  ds_read_b64_tr_b16 v[30:31], v6 offset:512
  ds_read_b64_tr_b16 v[32:33], v6 offset:4096
  ds_read_b64_tr_b16 v[34:35], v6 offset:4608
  s_waitcnt lgkmcnt(2)
  v_mfma_f32_16x16x32_bf16 v[20:23], v[28:31], v[24:27], 0
  ds_read_b64_tr_b16 v[36:37], v6 offset:8192
  v_mfma_f32_16x16x32_bf16 v[8:11], v[28:31], v[40:43], 0
  ds_read_b64_tr_b16 v[38:39], v6 offset:8704
  v_mfma_f32_16x16x32_bf16 v[12:15], v[28:31], v[44:47], 0
  v_mfma_f32_16x16x32_bf16 v[16:19], v[28:31], v[48:51], 0
  s_waitcnt lgkmcnt(2)
  v_mfma_f32_16x16x32_bf16 v[20:23], v[32:35], v[24:27], v[20:23]
  ds_read_b64_tr_b16 v[28:29], v6 offset:12288
  v_mfma_f32_16x16x32_bf16 v[8:11], v[32:35], v[52:55], v[8:11]
  ds_read_b64_tr_b16 v[30:31], v6 offset:12800
  v_mfma_f32_16x16x32_bf16 v[12:15], v[32:35], v[56:59], v[12:15]
  v_mfma_f32_16x16x32_bf16 v[16:19], v[32:35], v[60:63], v[16:19]
  s_barrier
  s_waitcnt lgkmcnt(2)
  v_mfma_f32_16x16x32_bf16 v[20:23], v[36:39], v[24:27], v[20:23]
  ds_read_b64_tr_b16 v[32:33], v6 offset:16384
  v_mfma_f32_16x16x32_bf16 v[8:11], v[36:39], v[64:67], v[8:11]
  ds_read_b64_tr_b16 v[34:35], v6 offset:16896
  v_mfma_f32_16x16x32_bf16 v[12:15], v[36:39], v[68:71], v[12:15]
  v_mfma_f32_16x16x32_bf16 v[16:19], v[36:39], v[72:75], v[16:19]
  s_waitcnt lgkmcnt(2)
  v_mfma_f32_16x16x32_bf16 v[20:23], v[28:31], v[24:27], v[20:23]
  ds_read_b64_tr_b16 v[36:37], v6 offset:20480
  v_mfma_f32_16x16x32_bf16 v[8:11], v[28:31], v[76:79], v[8:11]
  ds_read_b64_tr_b16 v[38:39], v6 offset:20992
  v_mfma_f32_16x16x32_bf16 v[12:15], v[28:31], v[80:83], v[12:15]
  v_mfma_f32_16x16x32_bf16 v[16:19], v[28:31], v[84:87], v[16:19]
  s_waitcnt lgkmcnt(2)
  v_mfma_f32_16x16x32_bf16 v[20:23], v[32:35], v[24:27], v[20:23]
  ds_read_b64_tr_b16 v[28:29], v6 offset:24576
  v_mfma_f32_16x16x32_bf16 v[8:11], v[32:35], v[88:91], v[8:11]
  ds_read_b64_tr_b16 v[30:31], v6 offset:25088
  v_mfma_f32_16x16x32_bf16 v[12:15], v[32:35], v[92:95], v[12:15]
  v_mfma_f32_16x16x32_bf16 v[16:19], v[32:35], v[96:99], v[16:19]
  s_waitcnt lgkmcnt(2)
  v_mfma_f32_16x16x32_bf16 v[20:23], v[36:39], v[24:27], v[20:23]
  ds_read_b64_tr_b16 v[32:33], v6 offset:28672
  v_mfma_f32_16x16x32_bf16 v[8:11], v[36:39], v[100:103], v[8:11]
  ds_read_b64_tr_b16 v[34:35], v6 offset:29184
  v_mfma_f32_16x16x32_bf16 v[12:15], v[36:39], v[104:107], v[12:15]
  v_mfma_f32_16x16x32_bf16 v[16:19], v[36:39], v[108:111], v[16:19]
  s_barrier
  s_waitcnt lgkmcnt(2)
  v_mfma_f32_16x16x32_bf16 v[20:23], v[28:31], v[24:27], v[20:23]
  ds_read_b64_tr_b16 v[36:37], v6 offset:32768
  v_mfma_f32_16x16x32_bf16 v[8:11], v[28:31], v[112:115], v[8:11]
  ds_read_b64_tr_b16 v[38:39], v6 offset:33280
  v_mfma_f32_16x16x32_bf16 v[12:15], v[28:31], v[116:119], v[12:15]
  v_mfma_f32_16x16x32_bf16 v[16:19], v[28:31], v[120:123], v[16:19]
  s_waitcnt lgkmcnt(2)
  v_mfma_f32_16x16x32_bf16 v[20:23], v[32:35], v[24:27], v[20:23]
  ds_read_b64_tr_b16 v[28:29], v6 offset:36864
  v_mfma_f32_16x16x32_bf16 v[8:11], v[32:35], v[124:127], v[8:11]
  ds_read_b64_tr_b16 v[30:31], v6 offset:37376
  v_mfma_f32_16x16x32_bf16 v[12:15], v[32:35], v[128:131], v[12:15]
  v_mfma_f32_16x16x32_bf16 v[16:19], v[32:35], v[132:135], v[16:19]
  s_waitcnt lgkmcnt(2)
  v_mfma_f32_16x16x32_bf16 v[20:23], v[36:39], v[24:27], v[20:23]
  ds_read_b64_tr_b16 v[32:33], v6 offset:40960
  v_mfma_f32_16x16x32_bf16 v[8:11], v[36:39], v[136:139], v[8:11]
  ds_read_b64_tr_b16 v[34:35], v6 offset:41472
  v_mfma_f32_16x16x32_bf16 v[12:15], v[36:39], v[140:143], v[12:15]
  v_mfma_f32_16x16x32_bf16 v[16:19], v[36:39], v[144:147], v[16:19]
  s_waitcnt lgkmcnt(2)
  v_mfma_f32_16x16x32_bf16 v[20:23], v[28:31], v[24:27], v[20:23]
  ds_read_b64_tr_b16 v[36:37], v6 offset:45056
  v_mfma_f32_16x16x32_bf16 v[8:11], v[28:31], v[148:151], v[8:11]
  ds_read_b64_tr_b16 v[38:39], v6 offset:45568
  v_mfma_f32_16x16x32_bf16 v[12:15], v[28:31], v[152:155], v[12:15]
  v_mfma_f32_16x16x32_bf16 v[16:19], v[28:31], v[156:159], v[16:19]
  s_waitcnt lgkmcnt(2)
  v_mfma_f32_16x16x32_bf16 v[20:23], v[32:35], v[24:27], v[20:23]
  ds_read_b64_tr_b16 v[28:29], v6 offset:49152
  v_mfma_f32_16x16x32_bf16 v[8:11], v[32:35], v[160:163], v[8:11]
  ds_read_b64_tr_b16 v[30:31], v6 offset:49664
  v_mfma_f32_16x16x32_bf16 v[12:15], v[32:35], v[164:167], v[12:15]
  v_mfma_f32_16x16x32_bf16 v[16:19], v[32:35], v[168:171], v[16:19]
  s_waitcnt lgkmcnt(2)
  v_mfma_f32_16x16x32_bf16 v[20:23], v[36:39], v[24:27], v[20:23]
  ds_read_b64_tr_b16 v[32:33], v6 offset:53248
  v_mfma_f32_16x16x32_bf16 v[8:11], v[36:39], v[172:175], v[8:11]
  ds_read_b64_tr_b16 v[34:35], v6 offset:53760
  v_mfma_f32_16x16x32_bf16 v[12:15], v[36:39], v[176:179], v[12:15]
  v_mfma_f32_16x16x32_bf16 v[16:19], v[36:39], v[180:183], v[16:19]
  s_barrier
  s_waitcnt lgkmcnt(2)
  v_mfma_f32_16x16x32_bf16 v[20:23], v[28:31], v[24:27], v[20:23]
  ds_read_b64_tr_b16 v[36:37], v3 offset:0
  v_mfma_f32_16x16x32_bf16 v[8:11], v[28:31], v[184:187], v[8:11]
  ds_read_b64_tr_b16 v[38:39], v3 offset:512
  v_mfma_f32_16x16x32_bf16 v[12:15], v[28:31], v[188:191], v[12:15]
  v_mfma_f32_16x16x32_bf16 v[16:19], v[28:31], v[192:195], v[16:19]
  s_waitcnt lgkmcnt(2)
  v_mfma_f32_16x16x32_bf16 v[20:23], v[32:35], v[24:27], v[20:23]
  ds_read_b64_tr_b16 v[28:29], v3 offset:4096
  v_mfma_f32_16x16x32_bf16 v[8:11], v[32:35], v[196:199], v[8:11]
  ds_read_b64_tr_b16 v[30:31], v3 offset:4608
  v_mfma_f32_16x16x32_bf16 v[12:15], v[32:35], v[200:203], v[12:15]
  v_mfma_f32_16x16x32_bf16 v[16:19], v[32:35], v[204:207], v[16:19]
  s_waitcnt lgkmcnt(2)
  v_mfma_f32_16x16x32_bf16 v[20:23], v[36:39], v[24:27], v[20:23]
  ds_read_b64_tr_b16 v[32:33], v3 offset:8192
  v_mfma_f32_16x16x32_bf16 v[8:11], v[36:39], v[208:211], v[8:11]
  ds_read_b64_tr_b16 v[34:35], v3 offset:8704
  v_mfma_f32_16x16x32_bf16 v[12:15], v[36:39], v[212:215], v[12:15]
  v_mfma_f32_16x16x32_bf16 v[16:19], v[36:39], v[216:219], v[16:19]
  s_waitcnt lgkmcnt(2)
  v_mfma_f32_16x16x32_bf16 v[20:23], v[28:31], v[24:27], v[20:23]
  ds_read_b64_tr_b16 v[36:37], v3 offset:12288
  v_mfma_f32_16x16x32_bf16 v[8:11], v[28:31], v[220:223], v[8:11]
  ds_read_b64_tr_b16 v[38:39], v3 offset:12800
  v_mfma_f32_16x16x32_bf16 v[12:15], v[28:31], v[224:227], v[12:15]
  v_mfma_f32_16x16x32_bf16 v[16:19], v[28:31], v[228:231], v[16:19]
  s_waitcnt lgkmcnt(2)
  v_mfma_f32_16x16x32_bf16 v[20:23], v[32:35], v[24:27], v[20:23]
  v_mfma_f32_16x16x32_bf16 v[8:11], v[32:35], v[232:235], v[8:11]
  v_mfma_f32_16x16x32_bf16 v[12:15], v[32:35], v[236:239], v[12:15]
  v_mfma_f32_16x16x32_bf16 v[16:19], v[32:35], v[240:243], v[16:19]
  s_waitcnt lgkmcnt(0)
  v_mfma_f32_16x16x32_bf16 v[20:23], v[36:39], v[24:27], v[20:23]
  v_mfma_f32_16x16x32_bf16 v[8:11], v[36:39], v[244:247], v[8:11]
  v_mfma_f32_16x16x32_bf16 v[12:15], v[36:39], v[248:251], v[12:15]
  v_mfma_f32_16x16x32_bf16 v[16:19], v[36:39], v[252:255], v[16:19]
  ds_read_b64 v[28:29], v4 offset:0
  ds_read_b64 v[30:31], v4 offset:128
  ds_read_b64 v[32:33], v4 offset:256
  v_lshrrev_b32 v1, 3, v0
  v_and_b32 v2, 7, v0
  v_mul_u32_u24 v3, 144, v1
  v_mul_u32_u24 v1, 1152, v1
  v_lshl_add_u32 v3, v2, 4, v3
  v_lshl_add_u32 v1, v2, 4, v1
  s_mul_i32 s24, s3, 1152
  s_add_u32 s24, s24, 129536
  v_add_u32 v3, s24, v3
  s_waitcnt lgkmcnt(2)
  v_mul_f32 v29, 0x3eae1a93, v29
  v_pk_fma_f32 v[8:9], v[20:21], v[28:29], v[8:9] op_sel_hi:[1,0,1]
  v_pk_mul_f32 v[8:9], v[8:9], v[28:29] op_sel:[0,1] op_sel_hi:[1,1]
  v_pk_fma_f32 v[10:11], v[22:23], v[28:29], v[10:11] op_sel_hi:[1,0,1]
  v_pk_mul_f32 v[10:11], v[10:11], v[28:29] op_sel:[0,1] op_sel_hi:[1,1]
  v_cvt_pk_bf16_f32 v34, v8, v9
  v_cvt_pk_bf16_f32 v35, v10, v11
  ds_write_b64 v5, v[34:35] offset:0
  s_waitcnt lgkmcnt(2)
  v_mul_f32 v31, 0x3eae1a93, v31
  v_pk_fma_f32 v[12:13], v[20:21], v[30:31], v[12:13] op_sel_hi:[1,0,1]
  v_pk_mul_f32 v[12:13], v[12:13], v[30:31] op_sel:[0,1] op_sel_hi:[1,1]
  v_pk_fma_f32 v[14:15], v[22:23], v[30:31], v[14:15] op_sel_hi:[1,0,1]
  v_pk_mul_f32 v[14:15], v[14:15], v[30:31] op_sel:[0,1] op_sel_hi:[1,1]
  v_cvt_pk_bf16_f32 v36, v12, v13
  v_cvt_pk_bf16_f32 v37, v14, v15
  ds_write_b64 v5, v[36:37] offset:2304
  s_waitcnt lgkmcnt(2)
  v_mul_f32 v33, 0x3eae1a93, v33
  v_pk_fma_f32 v[16:17], v[20:21], v[32:33], v[16:17] op_sel_hi:[1,0,1]
  v_pk_mul_f32 v[16:17], v[16:17], v[32:33] op_sel:[0,1] op_sel_hi:[1,1]
  v_pk_fma_f32 v[18:19], v[22:23], v[32:33], v[18:19] op_sel_hi:[1,0,1]
  v_pk_mul_f32 v[18:19], v[18:19], v[32:33] op_sel:[0,1] op_sel_hi:[1,1]
  v_cvt_pk_bf16_f32 v38, v16, v17
  v_cvt_pk_bf16_f32 v39, v18, v19
  ds_write_b64 v5, v[38:39] offset:4608
  s_waitcnt lgkmcnt(0)
  v_mov_b32 v100, v1
  v_mov_b32 v101, v3
  s_mov_b32 s60, 1
  s_branch K2_A
K1_SP0:
  s_cmp_ge_u32 s2, 256
  s_cbranch_scc1 K2_EXIT
  s_load_dwordx2 s[12:13], s[0:1], 0
  s_load_dwordx8 s[36:43], s[0:1], 0
  s_load_dwordx2 s[44:45], s[0:1], 32
  s_load_dwordx2 s[46:47], s[0:1], 96
  s_load_dwordx8 s[48:55], s[0:1], 48
  s_load_dwordx4 s[64:67], s[0:1], 80
  v_lshrrev_b32 v1, 6, v0
  v_and_b32 v0, 63, v0
  v_readfirstlane_b32 s3, v1
  s_xor_b32 s3, s3, 4
  s_getpc_b64 s[68:69]
K1_PC1:
  s_sub_u32 s68, s68, K1_PC1-sequential_preLN__grouped_kv_mqa__moe_arch_mod__prompt_kernel
  s_subb_u32 s69, s69, 0
  s_lshl_b32 s20, s3, 13
  v_lshl_add_u32 v125, v0, 7, s20
  v_min_u32 v125, K2_LAST-sequential_preLN__grouped_kv_mqa__moe_arch_mod__prompt_kernel-4, v125
  global_load_dword v125, v125, s[68:69]
  s_sub_u32 s4, s2, 240
  s_lshl_b32 s60, s4, 7
  s_add_u32 s60, s60, 3225600
  v_lshrrev_b32 v1, 4, v0
  s_cmp_lg_u32 s3, 7
  s_cbranch_scc1 K1_TASK
  s_waitcnt lgkmcnt(0)
  s_mov_b32 s8, s46
  s_and_b32 s9, s47, 0xffff
  s_mov_b32 s10, 4761600
  s_mov_b32 s11, 0x20000
  v_lshlrev_b32 v120, 4, v0
  v_mov_b32 v116, 0
  v_mov_b32 v117, 0
  v_mov_b32 v118, 0
  v_mov_b32 v119, 0
  v_lshlrev_b32 v121, 7, v0
  s_lshl_b32 s20, s4, 13
  s_add_u32 s20, s20, 3219456
  buffer_store_dword v116, v121, s[8:11], s20 offen sc1
  s_lshl_b32 s20, s4, 12
  s_add_u32 s20, s20, 3350528
  buffer_store_dwordx4 v[116:119], v120, s[8:11], s20 offen offset:0 sc1
  buffer_store_dwordx4 v[116:119], v120, s[8:11], s20 offen offset:1024 sc1
  buffer_store_dwordx4 v[116:119], v120, s[8:11], s20 offen offset:2048 sc1
  buffer_store_dwordx4 v[116:119], v120, s[8:11], s20 offen offset:3072 sc1
  s_mov_b32 s16, s38
  s_and_b32 s17, s39, 0xffff
  s_mov_b32 s18, 663552
  s_mov_b32 s19, 0x20000
  v_mul_u32_u24 v2, 52, v0
  v_lshrrev_b32 v2, 8, v2
  v_lshlrev_b32 v2, 9, v2
  v_add_u32 v2, v2, v121
  s_mul_i32 s21, s4, 41472
  buffer_load_dword v4, v2, s[16:19], s21 offen offset:512
  s_add_u32 s21, s21, 13824
  buffer_load_dword v5, v2, s[16:19], s21 offen offset:512
  s_add_u32 s21, s21, 13824
  buffer_load_dword v6, v2, s[16:19], s21 offen offset:512
  v_mov_b32 v2, 163072
  ds_write_b32 v2, v116
  s_waitcnt lgkmcnt(0)
  s_barrier
  s_lshl_b32 s20, s4, 2
  v_mov_b32 v120, s20
  v_mov_b32 v121, 1
  s_mov_b64 exec, 1
  s_waitcnt vmcnt(3)
  global_store_dword v120, v121, s[66:67] sc1
  s_mov_b64 exec, -1
  s_mov_b32 s28, s48
  s_and_b32 s29, s49, 0xffff
  s_mov_b32 s30, 1152
  s_mov_b32 s31, 0x20000
  s_mov_b32 m0, 161920
  v_lshlrev_b32 v123, 4, v0
  buffer_load_dwordx4 v123, s[28:31], 0 offen lds
  s_mov_b64 exec, 0xff
  buffer_load_dwordx4 v123, s[28:31], 0 offen offset:1024 lds
  s_mov_b64 exec, -1
  v_mov_b32 v122, 0
  v_mov_b32 v123, 163072
  ds_write_b32 v123, v122
  s_waitcnt lgkmcnt(0)
  v_lshlrev_b32 v239, 4, v0
  s_and_b32 s24, s2, 7
  s_lshl_b32 s24, s24, 5
  s_lshr_b32 s21, s2, 3
  s_add_u32 s24, s24, s21
  s_mul_i32 s24, s24, 9216
  s_mov_b32 s14, 2359296
  s_mov_b32 s15, 0x20000
  s_mov_b32 m0, 136576
  s_nop 0
  buffer_load_dwordx4 v239, s[12:15], s24 offen offset:0 lds
  s_mov_b32 m0, 136576
  s_nop 0
  buffer_load_dwordx4 v239, s[12:15], s24 offen offset:1024 lds
  s_mov_b32 m0, 136576
  s_nop 0
  buffer_load_dwordx4 v239, s[12:15], s24 offen offset:2048 lds
  s_add_u32 s24, s24, 3072
  s_mov_b32 m0, 139648
  s_nop 0
  buffer_load_dwordx4 v239, s[12:15], s24 offen offset:0 lds
  s_mov_b32 m0, 139648
  s_nop 0
  buffer_load_dwordx4 v239, s[12:15], s24 offen offset:1024 lds
  s_mov_b32 m0, 139648
  s_nop 0
  buffer_load_dwordx4 v239, s[12:15], s24 offen offset:2048 lds
  s_add_u32 s24, s24, 3072
  s_mov_b32 m0, 142720
  s_nop 0
  buffer_load_dwordx4 v239, s[12:15], s24 offen offset:0 lds
  s_mov_b32 m0, 142720
  s_nop 0
  buffer_load_dwordx4 v239, s[12:15], s24 offen offset:1024 lds
  s_mov_b32 m0, 142720
  s_nop 0
  buffer_load_dwordx4 v239, s[12:15], s24 offen offset:2048 lds
  v_bfe_u32 v22, v239, 2, 6
  v_mov_b32 v23, 0
  s_waitcnt vmcnt(0)
  s_mov_b32 s61, 0
K1_WCb:
  v_cmp_eq_u32 vcc, 0, v23
  s_add_u32 s61, s61, 1
  s_cmp_lt_u32 s61, 262144
  s_cselect_b64 vcc, vcc, 0
  s_cbranch_vccz K1_WDb
  global_load_dword v23, v22, s[66:67] sc1
  s_waitcnt vmcnt(0)
  s_branch K1_WCb
K1_WDb:
  v_mov_b32 v122, 4
  ds_write_b32 v123, v122
  s_branch K1_SPD
K1_TASK:
  v_bfe_u32 v13, v0, 3, 1
  v_bfe_u32 v14, v0, 5, 1
  v_lshl_add_u32 v13, v14, 1, v13
  v_bfe_u32 v15, v0, 4, 1
  v_mul_u32_u24 v15, 18, v15
  v_add_u32 v16, v15, v13
  v_mul_u32_u24 v13, 72, v13
  v_add_u32 v17, v15, v13
  v_and_b32 v14, 7, v0
  v_lshlrev_b32 v14, 4, v14
  v_bfe_u32 v2, v0, 2, 2
  v_and_b32 v3, 3, v0
  v_lshl_add_u32 v24, v1, 3, v2
  v_lshlrev_b32 v24, 7, v24
  v_lshl_add_u32 v24, v3, 3, v24
  s_lshl_b32 s22, s3, 13
  v_add_u32 v24, s22, v24
  v_lshlrev_b32 v25, 4, v0
  s_movk_i32 s23, 1152
  s_lshl_b32 s34, s3, 4
  s_add_u32 s34, s34, s4
  s_waitcnt lgkmcnt(0)
  s_mov_b32 s28, s44
  s_and_b32 s29, s45, 0xffff
  s_mov_b32 s30, 663552
  s_mov_b32 s31, 0x20000
  s_movk_i32 s45, 0xff
  s_mov_b32 s8, s46
  s_and_b32 s9, s47, 0xffff
  s_mov_b32 s10, 4761600
  s_mov_b32 s11, 0x20000
  s_barrier
  s_mul_i32 s5, s34, 3641
  s_lshr_b32 s5, s5, 16
  s_mul_i32 s6, s5, 18
  s_sub_u32 s6, s34, s6
  s_and_b32 s7, s6, 1
  s_lshr_b32 s6, s6, 1
  s_mul_i32 s21, s5, 72
  s_lshl_b32 s24, s6, 3
  s_add_u32 s24, s24, s21
  s_add_u32 s24, s24, s7
  s_lshl_b32 s24, s24, 10
  s_add_u32 s24, s24, 2555904
  s_lshl_b32 s26, s7, 2
  s_add_u32 s21, s21, s26
  s_add_u32 s26, s7, 16
  s_cmp_eq_u32 s5, 8
  s_cselect_b32 s21, s26, s21
  s_cselect_b64 vcc, -1, 0
  s_cselect_b32 s26, 0x120, 8
  s_mul_i32 s21, s21, 1152
  s_mul_i32 s26, s26, 1152
  s_lshl_b32 s6, s6, 7
  s_add_u32 s21, s21, s6
  s_cmp_ge_u32 s34, 162
  s_cselect_b32 s24, 0x10000000, s24
  s_cselect_b32 s21, 0x10000000, s21
  s_add_u32 s26, s26, s21
  v_cndmask_b32 v18, v16, v17, vcc
  v_mad_u32_u24 v18, v18, s23, v14
  s_add_u32 m0, s22, 0
  s_add_u32 s27, s21, 0
  buffer_load_dwordx4 v18, s[28:31], s27 offen lds
  s_add_u32 m0, s22, 1024
  s_add_u32 s27, s26, 0
  buffer_load_dwordx4 v18, s[28:31], s27 offen lds
  s_add_u32 m0, s22, 2048
  s_add_u32 s27, s21, 41472
  buffer_load_dwordx4 v18, s[28:31], s27 offen lds
  s_add_u32 m0, s22, 3072
  s_add_u32 s27, s26, 41472
  buffer_load_dwordx4 v18, s[28:31], s27 offen lds
  s_add_u32 s34, s34, 112
  s_mul_i32 s5, s34, 3641
  s_lshr_b32 s5, s5, 16
  s_mul_i32 s6, s5, 18
  s_sub_u32 s6, s34, s6
  s_and_b32 s7, s6, 1
  s_lshr_b32 s6, s6, 1
  s_mul_i32 s21, s5, 72
  s_lshl_b32 s25, s6, 3
  s_add_u32 s25, s25, s21
  s_add_u32 s25, s25, s7
  s_lshl_b32 s25, s25, 10
  s_add_u32 s25, s25, 2555904
  s_lshl_b32 s26, s7, 2
  s_add_u32 s21, s21, s26
  s_add_u32 s26, s7, 16
  s_cmp_eq_u32 s5, 8
  s_cselect_b32 s21, s26, s21
  s_cselect_b64 vcc, -1, 0
  s_cselect_b32 s26, 0x120, 8
  s_mul_i32 s21, s21, 1152
  s_mul_i32 s26, s26, 1152
  s_lshl_b32 s6, s6, 7
  s_add_u32 s21, s21, s6
  s_cmp_ge_u32 s34, 162
  s_cselect_b32 s25, 0x10000000, s25
  s_cselect_b32 s21, 0x10000000, s21
  s_add_u32 s26, s26, s21
  v_cndmask_b32 v19, v16, v17, vcc
  v_mad_u32_u24 v19, v19, s23, v14
  s_add_u32 m0, s22, 4096
  s_add_u32 s27, s21, 0
  buffer_load_dwordx4 v19, s[28:31], s27 offen lds
  s_add_u32 m0, s22, 5120
  s_add_u32 s27, s26, 0
  buffer_load_dwordx4 v19, s[28:31], s27 offen lds
  s_add_u32 m0, s22, 6144
  s_add_u32 s27, s21, 41472
  buffer_load_dwordx4 v19, s[28:31], s27 offen lds
  s_add_u32 m0, s22, 7168
  s_add_u32 s27, s26, 41472
  buffer_load_dwordx4 v19, s[28:31], s27 offen lds
  s_waitcnt vmcnt(4)
  ds_read_b64_tr_b16 v[32:33], v24 offset:0
  ds_read_b64_tr_b16 v[34:35], v24 offset:512
  ds_read_b64_tr_b16 v[36:37], v24 offset:32
  ds_read_b64_tr_b16 v[38:39], v24 offset:544
  ds_read_b64_tr_b16 v[40:41], v24 offset:64
  ds_read_b64_tr_b16 v[42:43], v24 offset:576
  ds_read_b64_tr_b16 v[44:45], v24 offset:96
  ds_read_b64_tr_b16 v[46:47], v24 offset:608
  s_waitcnt lgkmcnt(6)
  buffer_store_dwordx4 v[32:35], v25, s[8:11], s24 offen sc1
  s_add_u32 s24, s24, 2048
  s_waitcnt lgkmcnt(4)
  buffer_store_dwordx4 v[36:39], v25, s[8:11], s24 offen sc1
  s_add_u32 s24, s24, 2048
  s_waitcnt lgkmcnt(2)
  buffer_store_dwordx4 v[40:43], v25, s[8:11], s24 offen sc1
  s_add_u32 s24, s24, 2048
  s_waitcnt lgkmcnt(0)
  buffer_store_dwordx4 v[44:47], v25, s[8:11], s24 offen sc1
  s_waitcnt vmcnt(4)
  ds_read_b64_tr_b16 v[48:49], v24 offset:4096
  ds_read_b64_tr_b16 v[50:51], v24 offset:4608
  ds_read_b64_tr_b16 v[52:53], v24 offset:4128
  ds_read_b64_tr_b16 v[54:55], v24 offset:4640
  ds_read_b64_tr_b16 v[56:57], v24 offset:4160
  ds_read_b64_tr_b16 v[58:59], v24 offset:4672
  ds_read_b64_tr_b16 v[60:61], v24 offset:4192
  ds_read_b64_tr_b16 v[62:63], v24 offset:4704
  s_waitcnt lgkmcnt(6)
  buffer_store_dwordx4 v[48:51], v25, s[8:11], s25 offen sc1
  s_add_u32 s25, s25, 2048
  s_waitcnt lgkmcnt(4)
  buffer_store_dwordx4 v[52:55], v25, s[8:11], s25 offen sc1
  s_add_u32 s25, s25, 2048
  s_waitcnt lgkmcnt(2)
  buffer_store_dwordx4 v[56:59], v25, s[8:11], s25 offen sc1
  s_add_u32 s25, s25, 2048
  s_waitcnt lgkmcnt(0)
  buffer_store_dwordx4 v[60:63], v25, s[8:11], s25 offen sc1
  s_cmp_ge_u32 s3, 4
  s_cbranch_scc1 K1_SPD
  s_mov_b32 s8, s46
  s_and_b32 s9, s47, 0xffff
  s_mov_b32 s10, 4761600
  s_mov_b32 s11, 0x20000
  s_and_b32 s4, s2, 7
  s_lshl_b32 s4, s4, 5
  s_lshr_b32 s5, s2, 3
  s_add_u32 s4, s4, s5
  s_mul_i32 s5, s4, 9216
  s_and_b32 s6, s3, 3
  s_mul_i32 s7, s6, 2560
  s_mov_b32 s12, s36
  s_and_b32 s13, s37, 0xffff
  s_mov_b32 s14, 2359296
  s_mov_b32 s15, 0x20000
  s_mov_b32 s16, s64
  s_and_b32 s17, s65, 0xffff
  s_mov_b32 s18, 2359296
  s_mov_b32 s19, 0x20000
  s_lshl_b32 s23, s6, 3
  s_lshl_b32 s22, s23, 8
  s_add_u32 s22, s22, 2424832
  s_lshl_b32 s20, s23, 11
  s_add_u32 s20, s20, 2359296
  s_mul_i32 s21, s23, 2560
  s_add_u32 s21, s21, 2433024
  s_mul_i32 s25, s6, 288
  s_and_b32 s56, s2, 7
  s_mul_i32 s56, s56, 18
  s_lshr_b32 s57, s2, 3
  s_add_u32 s56, s56, s57
  s_mov_b32 s32, s50
  s_and_b32 s33, s51, 0xffff
  s_mov_b32 s35, 0x20000
  s_mov_b32 s40, s52
  s_and_b32 s41, s53, 0xffff
  s_mov_b32 s43, 0x20000
  s_cmp_lt_u32 s2, 144
  s_cselect_b32 s34, 5308416, 0
  s_mov_b32 s42, s34
  s_and_b32 s57, s3, 3
  s_lshl_b32 s58, s57, 10
  s_mul_i32 s62, s57, 147456
  s_lshl_b32 s57, s56, 6
  s_add_u32 s62, s62, s57
  s_mov_b32 s28, s54
  s_and_b32 s29, s55, 0xffff
  s_mov_b32 s30, 5308416
  s_mov_b32 s31, 0x20000
  s_lshr_b32 s26, s2, 3
  s_lshl_b32 s26, s26, 2
  s_add_u32 s26, s26, s6
  s_and_b32 s64, s2, 7
  s_mul_i32 s64, s64, 81
  s_add_u32 s64, s64, s26
  s_sub_u32 s64, s64, 72
  s_lshl_b32 s64, s64, 13
  s_add_u32 s65, s64, 458752
  s_cmp_lt_u32 s26, 97
  s_cselect_b32 s65, s65, 0x10000000
  s_mul_i32 s59, s6, 2304
  s_add_u32 s59, s59, s5
  s_lshl_b32 s61, s4, 2
  s_add_u32 s61, s61, s6
  s_lshl_b32 s61, s61, 5
  s_add_u32 s61, s61, 2523136
  s_lshl_b32 s63, s2, 2
  s_add_u32 s63, s63, s6
  s_lshl_b32 s63, s63, 10
  s_add_u32 s63, s63, 2826240
  s_cmp_lt_u32 s2, 144
  s_cselect_b32 s30, 0, s30
  s_mul_i32 s27, s6, 18432
  s_add_u32 s27, s27, 2555904
  s_lshl_b32 s68, s3, 10
  s_and_b32 s69, s2, 7
  s_lshl_b32 s69, s69, 2
  s_add_u32 s69, s69, s3
  s_lshl_b32 s69, s69, 11
  s_add_u32 s69, s69, 3350528
  s_lshl_b32 s71, s3, 7
  s_lshl_b32 s49, s3, 5
  s_add_u32 s49, s49, 30208
  s_bfe_i32 s50, s3, 0x10000
  s_mul_i32 s72, s6, 9216
  s_mul_i32 s73, s56, 36864
  s_add_u32 s73, s73, s72
  s_lshl_b32 s46, s56, 6
  s_add_u32 s46, s46, 3416064
  s_and_b32 s36, s56, 12
  s_lshr_b32 s37, s56, 4
  s_lshl_b32 s38, s37, 10
  s_bfe_u32 s47, s56, 0x10001
  s_lshl_b32 s47, s47, 8
  s_add_u32 s38, s38, s47
  s_and_b32 s47, s56, 1
  s_lshl_b32 s47, s47, 1
  s_add_u32 s47, s47, s36
  s_lshl_b32 s47, s47, 4
  s_add_u32 s38, s38, s47
  s_lshl_b32 s37, s37, 7
  s_and_b32 s47, s56, 3
  s_lshl_b32 s47, s47, 4
  s_add_u32 s37, s37, s47
  s_lshl_b32 s36, s36, 2
  s_lshl_b32 s39, s6, 7
  s_add_u32 s39, s39, 18944
  s_sub_u32 s26, s26, 72
  s_mul_i32 s48, s26, 64512
  s_and_b32 s51, s2, 7
  s_mul_i32 s51, s51, 1152
  s_add_u32 s48, s48, s51
  s_add_u32 s51, s48, 3612672
  s_and_b32 s53, s53, 0xffff
  s_mov_b32 s54, s30
  s_mov_b32 s55, 0x20000
  s_mov_b32 s44, 0x10000000
  s_mov_b32 s45, 0x10000000
  v_mov_b64 v[100:101], 0
  s_mov_b32 s70, s60
  s_movk_i32 s60, 0xff
  s_branch K2_A
K1_SPD:
  s_and_b32 s6, s3, 3
  s_movk_i32 s45, 0xff
  v_bfe_u32 v6, v0, 2, 2
  v_and_b32 v7, 1, v0
  v_lshl_add_u32 v6, v6, 1, v7
  v_mul_u32_u24 v6, 1152, v6
  v_bfe_u32 v7, v0, 4, 1
  v_bfe_u32 v8, v0, 1, 1
  v_lshl_add_u32 v7, v7, 1, v8
  v_mad_u32_u24 v245, v7, 36, v6
  v_lshrrev_b32 v7, 5, v0
  v_lshl_add_u32 v244, v7, 4, v245
  v_lshrrev_b32 v1, 5, v0
  v_and_b32 v2, 31, v0
  v_lshlrev_b32 v3, 5, v2
  v_lshl_add_u32 v223, v1, 4, v3
  v_lshlrev_b32 v4, 1, v2
  s_mov_b32 s26, 0xfffff9f8
  v_bfe_u32 v4, s26, v4, 2
  v_cmp_gt_u32 vcc, 16, v2
  v_add_u32 v4, 16, v4
  v_lshlrev_b32 v242, 2, v0
  v_cndmask_b32 v4, v4, v2, vcc
  v_lshlrev_b32 v4, 5, v4
  v_lshl_add_u32 v225, v1, 4, v4
  v_mov_b32 v217, 0xdddddddd
  v_lshlrev_b32 v239, 4, v0
  s_mul_i32 s26, s6, 2560
  v_add_u32 v219, s26, v239
  v_lshl_add_u32 v221, v0, 3, s26
  v_add_u32 v254, 151680, v239
  v_add_u32 v255, 151680, v242
  v_mov_b32 v235, 0
  v_mov_b32 v237, 0
  v_mov_b64 v[64:65], 0
  v_mov_b64 v[66:67], 0
  v_mov_b64 v[68:69], 0
  v_mov_b64 v[70:71], 0
  v_mov_b64 v[72:73], 0
  v_mov_b64 v[74:75], 0
  v_mov_b64 v[76:77], 0
  v_mov_b64 v[78:79], 0
  v_mov_b64 v[90:91], 0
  v_mov_b64 v[92:93], 0
  v_mov_b64 v[94:95], 0
  v_lshrrev_b32 v1, 4, v0
  v_and_b32 v2, 15, v0
  v_bfe_u32 v3, v0, 1, 1
  v_and_b32 v7, 7, v0
  v_lshrrev_b32 v5, 1, v1
  v_mul_u32_u24 v5, 9216, v5
  v_and_b32 v6, 1, v1
  v_mul_u32_u24 v6, 576, v6
  v_add_u32 v5, v5, v6
  v_lshl_add_u32 v5, v2, 2, v5
  v_add_u32 v240, 114816, v5
  v_lshrrev_b32 v5, 1, v1
  v_lshlrev_b32 v5, 4, v5
  v_and_b32 v6, 1, v1
  v_bfe_u32 v8, v0, 3, 1
  v_lshl_add_u32 v6, v8, 1, v6
  v_lshl_add_u32 v5, v6, 2, v5
  v_bfe_u32 v8, v0, 2, 1
  v_add_u32 v5, v5, v8
  v_lshlrev_b32 v5, 6, v5
  v_xor_b32 v6, s6, v6
  v_lshl_add_u32 v5, v6, 4, v5
  v_mul_u32_u24 v6, 36992, v3
  v_add_u32 v5, v5, v6
  v_and_b32 v6, 1, v0
  v_lshl_add_u32 v5, v6, 3, v5
  v_add_u32 v241, 40960, v5
  v_mul_u32_u24 v243, 84, v0
  v_lshrrev_b32 v14, 4, v0
  v_lshrrev_b32 v16, 2, v0
  v_mul_u32_u24 v16, 9216, v16
  v_and_b32 v15, 3, v0
  v_xor_b32 v15, v15, v14
  v_lshl_add_u32 v238, v15, 4, v16
  s_and_b32 s56, s2, 7
  s_mul_i32 s56, s56, 18
  s_lshr_b32 s57, s2, 3
  s_add_u32 s56, s56, s57
  s_mov_b32 s32, s50
  s_and_b32 s33, s51, 0xffff
  s_mov_b32 s35, 0x20000
  s_mov_b32 s40, s52
  s_and_b32 s41, s53, 0xffff
  s_mov_b32 s43, 0x20000
  s_cmp_lt_u32 s2, 144
  s_cselect_b32 s34, 5308416, 0
  s_mov_b32 s42, s34
  s_and_b32 s57, s3, 3
  s_lshl_b32 s58, s57, 10
  s_mul_i32 s62, s57, 147456
  s_lshl_b32 s57, s56, 6
  s_add_u32 s62, s62, s57
  s_waitcnt vmcnt(0)
  s_branch K2_B
.p2align 6
K2_A:
  v_lshrrev_b32 v1, 5, v0
  v_and_b32 v2, 31, v0
  v_lshlrev_b32 v3, 5, v2
  v_lshl_add_u32 v96, v1, 4, v3
  v_lshlrev_b32 v4, 1, v2
  s_mov_b32 s26, 0xfffff9f8
  v_bfe_u32 v4, s26, v4, 2
  v_cmp_gt_u32 vcc, 16, v2
  v_add_u32 v4, 16, v4
  v_lshlrev_b32 v98, 2, v0
  v_cndmask_b32 v4, v4, v2, vcc
  v_lshlrev_b32 v4, 5, v4
  v_lshl_add_u32 v97, v1, 4, v4
  v_lshrrev_b32 v11, 4, v0
  v_mul_u32_u24 v13, 2304, v11
  v_and_b32 v12, 15, v0
  v_lshl_add_u32 v247, v12, 1, s25
  v_add_u32 v254, v247, v13
  v_add_u32 v254, 136576, v254
  v_mov_b64 v[198:199], 0
  v_mov_b64 v[200:201], 0
  v_mov_b64 v[202:203], 0
  v_mov_b64 v[204:205], 0
  v_mov_b64 v[206:207], 0
  v_mov_b64 v[208:209], 0
  v_mov_b64 v[210:211], 0
  v_mov_b64 v[212:213], 0
  v_mov_b64 v[214:215], 0
  v_mov_b64 v[216:217], 0
  v_mov_b64 v[218:219], 0
  v_mov_b64 v[220:221], 0
  v_mov_b64 v[222:223], 0
  v_mov_b64 v[224:225], 0
  v_mov_b64 v[226:227], 0
  v_mov_b64 v[228:229], 0
  v_mov_b64 v[230:231], 0
  v_mov_b64 v[232:233], 0
  s_setprio 2
  s_barrier
  buffer_load_dword v184, v98, s[8:11], s22 offen sc1
  buffer_load_dwordx4 v[112:115], v96, s[8:11], s20 offen offset:0 sc1
  buffer_load_dwordx4 v[116:119], v96, s[8:11], s20 offen offset:1024 sc1
  ds_read_u16_d16_hi v198, v254 offset:0
  ds_read_u16_d16_hi v199, v254 offset:1152
  ds_read_u16_d16_hi v202, v254 offset:32
  ds_read_u16_d16_hi v203, v254 offset:1184
  buffer_load_dwordx4 v[136:139], v97, s[8:11], s21 offen offset:0 sc1
  ds_read_u16_d16_hi v206, v254 offset:64
  ds_read_u16_d16_hi v207, v254 offset:1216
  ds_read_u16_d16_hi v210, v254 offset:96
  ds_read_u16_d16_hi v211, v254 offset:1248
  buffer_load_dwordx4 v[140:143], v97, s[8:11], s21 offen offset:640 sc1
  ds_read_u16_d16_hi v214, v254 offset:128
  ds_read_u16_d16_hi v215, v254 offset:1280
  s_waitcnt lgkmcnt(8)
  ds_read_u16_d16_hi v218, v254 offset:160
  buffer_load_dwordx4 v[144:147], v97, s[8:11], s21 offen offset:1280 sc1
  ds_read_u16_d16_hi v219, v254 offset:1312
  s_waitcnt lgkmcnt(8)
  ds_read_u16_d16_hi v222, v254 offset:192
  ds_read_u16_d16_hi v223, v254 offset:1344
  buffer_load_dwordx4 v[148:151], v97, s[8:11], s21 offen offset:1920 sc1
  ds_read_b128 v[104:107], v101
  ds_read_b128 v[108:111], v101 offset:4608
  s_waitcnt lgkmcnt(1)
  buffer_store_dwordx4 v[104:107], v100, s[8:11], s44 offen sc1
  s_waitcnt lgkmcnt(0)
  buffer_store_dwordx4 v[108:111], v100, s[8:11], s45 offen sc1
  s_waitcnt lgkmcnt(8)
  ds_read_u16_d16_hi v226, v254 offset:224
  ds_read_u16_d16_hi v227, v254 offset:1376
  s_waitcnt lgkmcnt(8)
  s_add_u32 s22, s22, 256
  s_add_u32 s20, s20, 2048
  s_add_u32 s21, s21, 2560
  buffer_load_dword v186, v98, s[8:11], s22 offen sc1
  ds_read_u16_d16_hi v230, v254 offset:256
  ds_read_u16_d16_hi v231, v254 offset:1408
  s_waitcnt lgkmcnt(8)
  v_bfe_u32 v8, v0, 1, 1
  buffer_load_dwordx4 v[120:123], v96, s[8:11], s20 offen offset:0 sc1
  v_mul_u32_u24 v8, 0xaaaa, v8
  v_add_u32 v185, 0xdddd4444, v8
  v_lshlrev_b32 v187, 4, v0
  v_lshlrev_b32 v189, 3, v0
  buffer_load_dwordx4 v[124:127], v96, s[8:11], s20 offen offset:1024 sc1
  v_add_u32 v197, s7, v187
  v_add_u32 v244, s7, v189
  v_add_u32 v245, 151680, v187
  v_add_u32 v246, 151680, v98
  buffer_load_dwordx4 v[152:155], v97, s[8:11], s21 offen offset:0 sc1
  v_mov_b32 v196, 0
  v_mov_b32 v195, 0
  v_mov_b32 v253, 0
  v_mov_b32 v243, 0
  buffer_load_dwordx4 v[156:159], v97, s[8:11], s21 offen offset:640 sc1
  v_lshrrev_b32 v14, 4, v0
  v_lshrrev_b32 v16, 2, v0
  v_mul_u32_u24 v16, 9216, v16
  v_and_b32 v15, 3, v0
  buffer_load_dwordx4 v[160:163], v97, s[8:11], s21 offen offset:1280 sc1
  v_xor_b32 v15, v15, v14
  v_lshl_add_u32 v255, v15, 4, v16
  v_min_u32 v8, 62, v0
  v_mul_u32_u24 v9, 57, v8
  buffer_load_dwordx4 v[164:167], v97, s[8:11], s21 offen offset:1920 sc1
  v_lshrrev_b32 v9, 9, v9
  v_mul_u32_u24 v9, 8064, v9
  v_lshl_add_u32 v9, v8, 7, v9
  s_cmp_lt_u32 s2, 144
  s_cselect_b64 vcc, -1, 0
  v_cndmask_b32 v255, v9, v255, vcc
  v_lshlrev_b32 v254, 3, v187
  v_mov_b32 v99, 163072
  v_mov_b32 v102, 1
  v_lshlrev_b32 v103, 13, v0
  v_mov_b32 v194, 0
  s_nop 1
  v_mfma_f32_32x32x8_bf16 v[64:79], v[194:195], v[196:197], 0
  v_mfma_f32_32x32x8_bf16 v[80:95], v[194:195], v[196:197], 0
  s_barrier
  ds_read_b32 v194, v246 offset:1024
  ds_read_b128 v[190:193], v245 offset:0
  ds_read_b32 v252, v246 offset:2304
  ds_read_b128 v[248:251], v245 offset:1280
  s_add_u32 s22, s22, 256
  s_add_u32 s20, s20, 2048
  s_add_u32 s21, s21, 2560
  buffer_load_dword v188, v98, s[8:11], s22 offen sc1
  buffer_load_dwordx4 v[128:131], v96, s[8:11], s20 offen offset:0 sc1
  buffer_load_dwordx4 v[132:135], v96, s[8:11], s20 offen offset:1024 sc1
  s_waitcnt vmcnt(16)
  s_waitcnt lgkmcnt(0)
  v_mfma_f32_32x32x4_2b_bf16 v[0:31], v[184:185], v[194:195], 0
  buffer_load_dwordx4 v[168:171], v97, s[8:11], s21 offen offset:0 sc1
  buffer_load_dwordx4 v[172:175], v97, s[8:11], s21 offen offset:640 sc1
  s_nop 15
  v_mfma_f32_32x32x16_bf16 v[0:15], v[112:115], v[190:193], v[0:15]
  v_mfma_f32_32x32x16_bf16 v[16:31], v[116:119], v[190:193], v[16:31]
  buffer_load_dwordx4 v[176:179], v97, s[8:11], s21 offen offset:1280 sc1
  buffer_load_dwordx4 v[180:183], v97, s[8:11], s21 offen offset:1920 sc1
  s_setprio 0
  s_nop 7
  v_exp_f32 v0, v0
  v_exp_f32 v1, v1
  v_exp_f32 v2, v2
  v_exp_f32 v3, v3
  v_exp_f32 v4, v4
  v_mfma_f32_32x32x4_2b_bf16 v[32:63], v[184:185], v[252:253], 0
  v_exp_f32 v5, v5
  v_exp_f32 v6, v6
  v_exp_f32 v7, v7
  v_exp_f32 v8, v8
  v_exp_f32 v9, v9
  v_exp_f32 v10, v10
  v_exp_f32 v11, v11
  v_exp_f32 v12, v12
  s_waitcnt vmcnt(18)
  v_smfmac_f32_32x32x32_bf16 v[64:79], v[136:139], v[0:7], v185 abid:1
  v_exp_f32 v13, v13
  v_exp_f32 v14, v14
  v_exp_f32 v15, v15
  s_waitcnt vmcnt(14)
  s_mov_b64 exec, 1
  ds_add_rtn_u32 v99, v99, v102
  s_mov_b64 exec, -1
  v_exp_f32 v16, v16
  v_exp_f32 v17, v17
  v_smfmac_f32_32x32x32_bf16 v[64:79], v[140:143], v[8:15], v185 abid:1
  v_exp_f32 v18, v18
  v_exp_f32 v19, v19
  v_exp_f32 v20, v20
  v_mfma_f32_32x32x16_bf16 v[32:47], v[112:115], v[248:251], v[32:47]
  v_exp_f32 v21, v21
  v_exp_f32 v22, v22
  v_exp_f32 v23, v23
  v_mfma_f32_32x32x16_bf16 v[48:63], v[116:119], v[248:251], v[48:63]
  v_exp_f32 v24, v24
  v_exp_f32 v25, v25
  v_exp_f32 v26, v26
  v_smfmac_f32_32x32x32_bf16 v[64:79], v[144:147], v[16:23], v185 abid:1
  v_exp_f32 v27, v27
  v_exp_f32 v28, v28
  v_exp_f32 v29, v29
  s_waitcnt lgkmcnt(0)
  v_cmp_eq_u32 vcc, 7, v99
  s_cbranch_vccz K2_NOFB
  s_mov_b32 exec_lo, s60
  s_mov_b32 exec_hi, 0
  buffer_store_dword v102, v103, s[8:11], s70 offen sc1
  s_mov_b64 exec, -1
K2_NOFB:
  v_exp_f32 v30, v30
  v_exp_f32 v31, v31
  v_exp_f32 v32, v32
  v_exp_f32 v33, v33
  v_smfmac_f32_32x32x32_bf16 v[64:79], v[148:151], v[24:31], v185 abid:1
  v_exp_f32 v34, v34
  v_exp_f32 v35, v35
  v_exp_f32 v36, v36
  s_waitcnt vmcnt(11)
  v_mfma_f32_32x32x4_2b_bf16 v[0:31], v[186:187], v[194:195], 0
  v_exp_f32 v37, v37
  v_exp_f32 v38, v38
  v_exp_f32 v39, v39
  v_exp_f32 v40, v40
  v_exp_f32 v41, v41
  v_exp_f32 v42, v42
  v_exp_f32 v43, v43
  v_exp_f32 v44, v44
  v_smfmac_f32_32x32x32_bf16 v[80:95], v[136:139], v[32:39], v185 abid:1
  v_exp_f32 v45, v45
  v_exp_f32 v46, v46
  v_exp_f32 v47, v47
  v_exp_f32 v48, v48
  v_exp_f32 v49, v49
  v_smfmac_f32_32x32x32_bf16 v[80:95], v[140:143], v[40:47], v185 abid:1
  v_exp_f32 v50, v50
  v_exp_f32 v51, v51
  v_exp_f32 v52, v52
  v_mfma_f32_32x32x16_bf16 v[0:15], v[120:123], v[190:193], v[0:15]
  v_exp_f32 v53, v53
  v_exp_f32 v54, v54
  v_exp_f32 v55, v55
  v_mfma_f32_32x32x16_bf16 v[16:31], v[124:127], v[190:193], v[16:31]
  v_exp_f32 v56, v56
  v_exp_f32 v57, v57
  v_exp_f32 v58, v58
  v_smfmac_f32_32x32x32_bf16 v[80:95], v[144:147], v[48:55], v185 abid:1
  v_exp_f32 v59, v59
  v_exp_f32 v60, v60
  v_exp_f32 v61, v61
  v_exp_f32 v62, v62
  v_exp_f32 v63, v63
  v_exp_f32 v0, v0
  v_exp_f32 v1, v1
  v_smfmac_f32_32x32x32_bf16 v[80:95], v[148:151], v[56:63], v185 abid:1
  v_exp_f32 v2, v2
  v_exp_f32 v3, v3
  v_exp_f32 v4, v4
  v_mfma_f32_32x32x4_2b_bf16 v[32:63], v[186:187], v[252:253], 0
  v_exp_f32 v5, v5
  v_exp_f32 v6, v6
  v_exp_f32 v7, v7
  v_exp_f32 v8, v8
  v_exp_f32 v9, v9
  v_exp_f32 v10, v10
  v_exp_f32 v11, v11
  v_exp_f32 v12, v12
  s_waitcnt vmcnt(9)
  v_smfmac_f32_32x32x32_bf16 v[64:79], v[152:155], v[0:7], v185 abid:1
  v_exp_f32 v13, v13
  v_exp_f32 v14, v14
  v_exp_f32 v15, v15
  v_exp_f32 v16, v16
  v_exp_f32 v17, v17
  v_smfmac_f32_32x32x32_bf16 v[64:79], v[156:159], v[8:15], v185 abid:1
  v_exp_f32 v18, v18
  v_exp_f32 v19, v19
  v_exp_f32 v20, v20
  v_mfma_f32_32x32x16_bf16 v[32:47], v[120:123], v[248:251], v[32:47]
  v_exp_f32 v21, v21
  v_exp_f32 v22, v22
  v_exp_f32 v23, v23
  v_mfma_f32_32x32x16_bf16 v[48:63], v[124:127], v[248:251], v[48:63]
  v_exp_f32 v24, v24
  v_exp_f32 v25, v25
  v_exp_f32 v26, v26
  s_waitcnt vmcnt(7)
  v_smfmac_f32_32x32x32_bf16 v[64:79], v[160:163], v[16:23], v185 abid:1
  v_exp_f32 v27, v27
  v_exp_f32 v28, v28
  v_exp_f32 v29, v29
  v_exp_f32 v30, v30
  v_exp_f32 v31, v31
  v_exp_f32 v32, v32
  v_exp_f32 v33, v33
  v_smfmac_f32_32x32x32_bf16 v[64:79], v[164:167], v[24:31], v185 abid:1
  v_exp_f32 v34, v34
  v_exp_f32 v35, v35
  v_exp_f32 v36, v36
  s_waitcnt vmcnt(4)
  v_mfma_f32_32x32x4_2b_bf16 v[0:31], v[188:189], v[194:195], 0
  v_exp_f32 v37, v37
  v_exp_f32 v38, v38
  v_exp_f32 v39, v39
  v_exp_f32 v40, v40
  v_exp_f32 v41, v41
  v_exp_f32 v42, v42
  v_exp_f32 v43, v43
  v_exp_f32 v44, v44
  v_smfmac_f32_32x32x32_bf16 v[80:95], v[152:155], v[32:39], v185 abid:1
  v_exp_f32 v45, v45
  v_exp_f32 v46, v46
  v_exp_f32 v47, v47
  v_exp_f32 v48, v48
  v_exp_f32 v49, v49
  v_smfmac_f32_32x32x32_bf16 v[80:95], v[156:159], v[40:47], v185 abid:1
  v_exp_f32 v50, v50
  v_exp_f32 v51, v51
  v_exp_f32 v52, v52
  v_mfma_f32_32x32x16_bf16 v[0:15], v[128:131], v[190:193], v[0:15]
  v_exp_f32 v53, v53
  v_exp_f32 v54, v54
  v_exp_f32 v55, v55
  v_mfma_f32_32x32x16_bf16 v[16:31], v[132:135], v[190:193], v[16:31]
  v_exp_f32 v56, v56
  v_exp_f32 v57, v57
  v_exp_f32 v58, v58
  v_smfmac_f32_32x32x32_bf16 v[80:95], v[160:163], v[48:55], v185 abid:1
  v_exp_f32 v59, v59
  v_exp_f32 v60, v60
  v_exp_f32 v61, v61
  v_exp_f32 v62, v62
  v_exp_f32 v63, v63
  v_exp_f32 v0, v0
  v_exp_f32 v1, v1
  v_smfmac_f32_32x32x32_bf16 v[80:95], v[164:167], v[56:63], v185 abid:1
  v_exp_f32 v2, v2
  v_exp_f32 v3, v3
  v_exp_f32 v4, v4
  v_mfma_f32_32x32x4_2b_bf16 v[32:63], v[188:189], v[252:253], 0
  v_exp_f32 v5, v5
  v_exp_f32 v6, v6
  v_exp_f32 v7, v7
  v_exp_f32 v8, v8
  v_exp_f32 v9, v9
  v_exp_f32 v10, v10
  v_exp_f32 v11, v11
  v_exp_f32 v12, v12
  s_waitcnt vmcnt(2)
  v_smfmac_f32_32x32x32_bf16 v[64:79], v[168:171], v[0:7], v185 abid:1
  v_exp_f32 v13, v13
  v_exp_f32 v14, v14
  v_exp_f32 v15, v15
  v_exp_f32 v16, v16
  v_exp_f32 v17, v17
  v_smfmac_f32_32x32x32_bf16 v[64:79], v[172:175], v[8:15], v185 abid:1
  v_exp_f32 v18, v18
  v_exp_f32 v19, v19
  v_exp_f32 v20, v20
  v_mfma_f32_32x32x16_bf16 v[32:47], v[128:131], v[248:251], v[32:47]
  v_exp_f32 v21, v21
  v_exp_f32 v22, v22
  v_exp_f32 v23, v23
  v_mfma_f32_32x32x16_bf16 v[48:63], v[132:135], v[248:251], v[48:63]
  v_exp_f32 v24, v24
  v_exp_f32 v25, v25
  v_exp_f32 v26, v26
  s_waitcnt vmcnt(0)
  v_smfmac_f32_32x32x32_bf16 v[64:79], v[176:179], v[16:23], v185 abid:1
  v_exp_f32 v27, v27
  v_exp_f32 v28, v28
  v_exp_f32 v29, v29
  ds_read_b32 v194, v246 offset:3584
  ds_read_b128 v[190:193], v245 offset:2560
  v_exp_f32 v30, v30
  v_exp_f32 v31, v31
  v_exp_f32 v32, v32
  v_exp_f32 v33, v33
  v_smfmac_f32_32x32x32_bf16 v[64:79], v[180:183], v[24:31], v185 abid:1
  v_exp_f32 v34, v34
  v_exp_f32 v35, v35
  v_exp_f32 v36, v36
  s_waitcnt lgkmcnt(0)
  v_mfma_f32_32x32x4_2b_bf16 v[0:31], v[184:185], v[194:195], 0
  v_exp_f32 v37, v37
  v_exp_f32 v38, v38
  v_exp_f32 v39, v39
  v_exp_f32 v40, v40
  v_exp_f32 v41, v41
  v_exp_f32 v42, v42
  v_exp_f32 v43, v43
  v_exp_f32 v44, v44
  v_smfmac_f32_32x32x32_bf16 v[80:95], v[168:171], v[32:39], v185 abid:1
  v_exp_f32 v45, v45
  v_exp_f32 v46, v46
  v_exp_f32 v47, v47
  ds_write_b128 v197, v[64:67] offset:30720
  ds_write_b128 v197, v[68:71] offset:31744
  ds_write_b64 v244, v[72:73] offset:32768
  v_exp_f32 v48, v48
  v_exp_f32 v49, v49
  v_smfmac_f32_32x32x32_bf16 v[80:95], v[172:175], v[40:47], v185 abid:1
  v_exp_f32 v50, v50
  v_exp_f32 v51, v51
  v_exp_f32 v52, v52
  v_mfma_f32_32x32x16_bf16 v[0:15], v[112:115], v[190:193], v[0:15]
  v_exp_f32 v53, v53
  v_exp_f32 v54, v54
  v_exp_f32 v55, v55
  v_mfma_f32_32x32x16_bf16 v[16:31], v[116:119], v[190:193], v[16:31]
  v_exp_f32 v56, v56
  v_exp_f32 v57, v57
  v_exp_f32 v58, v58
  v_smfmac_f32_32x32x32_bf16 v[80:95], v[176:179], v[48:55], v185 abid:1
  v_exp_f32 v59, v59
  v_exp_f32 v60, v60
  v_exp_f32 v61, v61
  s_waitcnt lgkmcnt(0)
  v_mfma_f32_32x32x8_bf16 v[64:79], v[194:195], v[196:197], 0
  v_exp_f32 v62, v62
  v_exp_f32 v63, v63
  v_exp_f32 v0, v0
  v_exp_f32 v1, v1
  v_smfmac_f32_32x32x32_bf16 v[80:95], v[180:183], v[56:63], v185 abid:1
  v_exp_f32 v2, v2
  v_exp_f32 v3, v3
  v_exp_f32 v4, v4
  v_mfma_f32_32x32x4_2b_bf16 v[32:63], v[186:187], v[194:195], 0
  v_exp_f32 v5, v5
  v_exp_f32 v6, v6
  v_exp_f32 v7, v7
  v_exp_f32 v8, v8
  v_exp_f32 v9, v9
  v_exp_f32 v10, v10
  v_exp_f32 v11, v11
  v_exp_f32 v12, v12
  v_smfmac_f32_32x32x32_bf16 v[64:79], v[136:139], v[0:7], v185 abid:1
  v_exp_f32 v13, v13
  v_exp_f32 v14, v14
  v_exp_f32 v15, v15
  ds_write_b128 v197, v[80:83] offset:10240
  ds_write_b128 v197, v[84:87] offset:11264
  ds_write_b64 v244, v[88:89] offset:12288
  v_exp_f32 v16, v16
  v_exp_f32 v17, v17
  v_smfmac_f32_32x32x32_bf16 v[64:79], v[140:143], v[8:15], v185 abid:1
  v_exp_f32 v18, v18
  v_exp_f32 v19, v19
  v_exp_f32 v20, v20
  v_mfma_f32_32x32x16_bf16 v[32:47], v[120:123], v[190:193], v[32:47]
  v_exp_f32 v21, v21
  v_exp_f32 v22, v22
  v_exp_f32 v23, v23
  v_mfma_f32_32x32x16_bf16 v[48:63], v[124:127], v[190:193], v[48:63]
  v_exp_f32 v24, v24
  v_exp_f32 v25, v25
  v_exp_f32 v26, v26
  v_smfmac_f32_32x32x32_bf16 v[64:79], v[144:147], v[16:23], v185 abid:1
  v_exp_f32 v27, v27
  v_exp_f32 v28, v28
  v_exp_f32 v29, v29
  v_exp_f32 v30, v30
  v_exp_f32 v31, v31
  v_exp_f32 v32, v32
  v_exp_f32 v33, v33
  v_smfmac_f32_32x32x32_bf16 v[64:79], v[148:151], v[24:31], v185 abid:1
  v_exp_f32 v34, v34
  v_exp_f32 v35, v35
  v_exp_f32 v36, v36
  v_mfma_f32_32x32x4_2b_bf16 v[0:31], v[188:189], v[194:195], 0
  v_exp_f32 v37, v37
  v_exp_f32 v38, v38
  v_exp_f32 v39, v39
  v_exp_f32 v40, v40
  v_exp_f32 v41, v41
  v_exp_f32 v42, v42
  v_exp_f32 v43, v43
  v_exp_f32 v44, v44
  v_smfmac_f32_32x32x32_bf16 v[64:79], v[152:155], v[32:39], v185 abid:1
  v_exp_f32 v45, v45
  v_exp_f32 v46, v46
  v_exp_f32 v47, v47
  v_exp_f32 v48, v48
  v_exp_f32 v49, v49
  v_smfmac_f32_32x32x32_bf16 v[64:79], v[156:159], v[40:47], v185 abid:1
  v_exp_f32 v50, v50
  v_exp_f32 v51, v51
  v_exp_f32 v52, v52
  v_mfma_f32_32x32x16_bf16 v[0:15], v[128:131], v[190:193], v[0:15]
  v_exp_f32 v53, v53
  v_exp_f32 v54, v54
  v_exp_f32 v55, v55
  v_mfma_f32_32x32x16_bf16 v[16:31], v[132:135], v[190:193], v[16:31]
  v_exp_f32 v56, v56
  v_exp_f32 v57, v57
  v_exp_f32 v58, v58
  v_smfmac_f32_32x32x32_bf16 v[64:79], v[160:163], v[48:55], v185 abid:1
  v_exp_f32 v59, v59
  v_exp_f32 v60, v60
  v_exp_f32 v61, v61
  v_exp_f32 v62, v62
  v_exp_f32 v63, v63
  s_waitcnt lgkmcnt(0)
  s_barrier
  s_setprio 2
  ds_read_b32 v252, v246 offset:4864
  ds_read_b128 v[248:251], v245 offset:3840
  v_exp_f32 v0, v0
  v_exp_f32 v1, v1
  v_smfmac_f32_32x32x32_bf16 v[64:79], v[164:167], v[56:63], v185 abid:1
  v_exp_f32 v2, v2
  v_exp_f32 v3, v3
  v_exp_f32 v4, v4
  s_waitcnt lgkmcnt(0)
  v_mfma_f32_32x32x4_2b_bf16 v[32:63], v[184:185], v[252:253], 0
  v_exp_f32 v5, v5
  v_exp_f32 v6, v6
  v_exp_f32 v7, v7
  v_exp_f32 v8, v8
  v_exp_f32 v9, v9
  v_exp_f32 v10, v10
  v_exp_f32 v11, v11
  v_exp_f32 v12, v12
  v_smfmac_f32_32x32x32_bf16 v[64:79], v[168:171], v[0:7], v185 abid:1
  v_exp_f32 v13, v13
  v_exp_f32 v14, v14
  v_exp_f32 v15, v15
  v_exp_f32 v16, v16
  v_exp_f32 v17, v17
  v_smfmac_f32_32x32x32_bf16 v[64:79], v[172:175], v[8:15], v185 abid:1
  v_exp_f32 v18, v18
  v_exp_f32 v19, v19
  v_exp_f32 v20, v20
  v_mfma_f32_32x32x16_bf16 v[32:47], v[112:115], v[248:251], v[32:47]
  v_exp_f32 v21, v21
  v_exp_f32 v22, v22
  v_exp_f32 v23, v23
  v_mfma_f32_32x32x16_bf16 v[48:63], v[116:119], v[248:251], v[48:63]
  v_exp_f32 v24, v24
  v_exp_f32 v25, v25
  v_exp_f32 v26, v26
  v_smfmac_f32_32x32x32_bf16 v[64:79], v[176:179], v[16:23], v185 abid:1
  v_exp_f32 v27, v27
  v_exp_f32 v28, v28
  v_exp_f32 v29, v29
  v_exp_f32 v30, v30
  v_exp_f32 v31, v31
  s_nop 1
  v_smfmac_f32_32x32x32_bf16 v[64:79], v[180:183], v[24:31], v185 abid:1
  s_add_u32 s24, s27, 0
  buffer_load_dwordx4 v[80:83], v187, s[8:11], s24 offen sc1
  buffer_load_dwordx4 v[84:87], v187, s[8:11], s24 offen offset:1024 sc1
  s_add_u32 s24, s27, 2048
  buffer_load_dwordx4 v[88:91], v187, s[8:11], s24 offen sc1
  buffer_load_dwordx4 v[92:95], v187, s[8:11], s24 offen offset:1024 sc1
  s_add_u32 s24, s27, 4096
  buffer_load_dwordx4 v[96:99], v187, s[8:11], s24 offen sc1
  buffer_load_dwordx4 v[100:103], v187, s[8:11], s24 offen offset:1024 sc1
  s_add_u32 s24, s27, 6144
  buffer_load_dwordx4 v[104:107], v187, s[8:11], s24 offen sc1
  buffer_load_dwordx4 v[108:111], v187, s[8:11], s24 offen offset:1024 sc1
  ds_write_b128 v197, v[64:67] offset:0
  ds_write_b128 v197, v[68:71] offset:1024
  ds_write_b64 v244, v[72:73] offset:2048
  s_add_u32 m0, s58, 53248
  s_add_u32 s57, s62, 1769472
  buffer_load_dwordx4 v255, s[32:35], s57 offen lds
  s_add_u32 m0, s58, 57344
  s_add_u32 s57, s62, 2359296
  buffer_load_dwordx4 v255, s[32:35], s57 offen lds
  s_add_u32 m0, s58, 61440
  s_add_u32 s57, s62, 2949120
  buffer_load_dwordx4 v255, s[32:35], s57 offen lds
  s_mov_b32 m0, 163136
  s_nop 0
  buffer_load_dword v255, s[52:55], s48 offen lds
  s_waitcnt lgkmcnt(0)
  s_setprio 0
  v_exp_f32 v32, v32
  v_exp_f32 v33, v33
  v_mfma_f32_32x32x8_bf16 v[64:79], v[252:253], v[196:197], 0
  v_exp_f32 v34, v34
  v_exp_f32 v35, v35
  v_exp_f32 v36, v36
  v_mfma_f32_32x32x4_2b_bf16 v[0:31], v[186:187], v[252:253], 0
  v_exp_f32 v37, v37
  v_exp_f32 v38, v38
  v_exp_f32 v39, v39
  v_exp_f32 v40, v40
  v_exp_f32 v41, v41
  v_exp_f32 v42, v42
  v_exp_f32 v43, v43
  v_exp_f32 v44, v44
  v_smfmac_f32_32x32x32_bf16 v[64:79], v[136:139], v[32:39], v185 abid:1
  v_exp_f32 v45, v45
  v_exp_f32 v46, v46
  v_exp_f32 v47, v47
  v_exp_f32 v48, v48
  v_exp_f32 v49, v49
  v_smfmac_f32_32x32x32_bf16 v[64:79], v[140:143], v[40:47], v185 abid:1
  v_exp_f32 v50, v50
  v_exp_f32 v51, v51
  v_exp_f32 v52, v52
  v_mfma_f32_32x32x16_bf16 v[0:15], v[120:123], v[248:251], v[0:15]
  v_exp_f32 v53, v53
  v_exp_f32 v54, v54
  v_exp_f32 v55, v55
  v_mfma_f32_32x32x16_bf16 v[16:31], v[124:127], v[248:251], v[16:31]
  v_exp_f32 v56, v56
  v_exp_f32 v57, v57
  v_exp_f32 v58, v58
  v_smfmac_f32_32x32x32_bf16 v[64:79], v[144:147], v[48:55], v185 abid:1
  v_exp_f32 v59, v59
  v_exp_f32 v60, v60
  v_exp_f32 v61, v61
  v_exp_f32 v62, v62
  v_exp_f32 v63, v63
  s_waitcnt lgkmcnt(0)
  s_barrier
  s_setprio 2
  v_exp_f32 v0, v0
  v_exp_f32 v1, v1
  v_smfmac_f32_32x32x32_bf16 v[64:79], v[148:151], v[56:63], v185 abid:1
  v_exp_f32 v2, v2
  v_exp_f32 v3, v3
  v_exp_f32 v4, v4
  v_mfma_f32_32x32x4_2b_bf16 v[32:63], v[188:189], v[252:253], 0
  v_exp_f32 v5, v5
  v_exp_f32 v6, v6
  v_exp_f32 v7, v7
  v_exp_f32 v8, v8
  v_exp_f32 v9, v9
  v_exp_f32 v10, v10
  v_exp_f32 v11, v11
  v_exp_f32 v12, v12
  v_smfmac_f32_32x32x32_bf16 v[64:79], v[152:155], v[0:7], v185 abid:1
  v_exp_f32 v13, v13
  v_exp_f32 v14, v14
  v_exp_f32 v15, v15
  v_exp_f32 v16, v16
  v_exp_f32 v17, v17
  v_smfmac_f32_32x32x32_bf16 v[64:79], v[156:159], v[8:15], v185 abid:1
  v_exp_f32 v18, v18
  v_exp_f32 v19, v19
  v_exp_f32 v20, v20
  v_mfma_f32_32x32x16_bf16 v[32:47], v[128:131], v[248:251], v[32:47]
  v_exp_f32 v21, v21
  v_exp_f32 v22, v22
  v_exp_f32 v23, v23
  v_mfma_f32_32x32x16_bf16 v[48:63], v[132:135], v[248:251], v[48:63]
  v_exp_f32 v24, v24
  v_exp_f32 v25, v25
  v_exp_f32 v26, v26
  v_smfmac_f32_32x32x32_bf16 v[64:79], v[160:163], v[16:23], v185 abid:1
  v_exp_f32 v27, v27
  v_exp_f32 v28, v28
  v_exp_f32 v29, v29
  v_exp_f32 v30, v30
  v_exp_f32 v31, v31
  ds_read_b32 v194, v246 offset:6144
  ds_read_b128 v[190:193], v245 offset:5120
  v_exp_f32 v32, v32
  v_exp_f32 v33, v33
  v_smfmac_f32_32x32x32_bf16 v[64:79], v[164:167], v[24:31], v185 abid:1
  v_exp_f32 v34, v34
  v_exp_f32 v35, v35
  v_exp_f32 v36, v36
  s_waitcnt lgkmcnt(0)
  v_mfma_f32_32x32x4_2b_bf16 v[0:31], v[184:185], v[194:195], 0
  v_exp_f32 v37, v37
  v_exp_f32 v38, v38
  v_exp_f32 v39, v39
  v_exp_f32 v40, v40
  v_exp_f32 v41, v41
  v_exp_f32 v42, v42
  v_exp_f32 v43, v43
  v_exp_f32 v44, v44
  v_smfmac_f32_32x32x32_bf16 v[64:79], v[168:171], v[32:39], v185 abid:1
  v_exp_f32 v45, v45
  v_exp_f32 v46, v46
  v_exp_f32 v47, v47
  v_exp_f32 v48, v48
  v_exp_f32 v49, v49
  v_smfmac_f32_32x32x32_bf16 v[64:79], v[172:175], v[40:47], v185 abid:1
  v_exp_f32 v50, v50
  v_exp_f32 v51, v51
  v_exp_f32 v52, v52
  v_mfma_f32_32x32x16_bf16 v[0:15], v[112:115], v[190:193], v[0:15]
  v_exp_f32 v53, v53
  v_exp_f32 v54, v54
  v_exp_f32 v55, v55
  v_mfma_f32_32x32x16_bf16 v[16:31], v[116:119], v[190:193], v[16:31]
  v_exp_f32 v56, v56
  v_exp_f32 v57, v57
  v_exp_f32 v58, v58
  v_smfmac_f32_32x32x32_bf16 v[64:79], v[176:179], v[48:55], v185 abid:1
  v_exp_f32 v59, v59
  v_exp_f32 v60, v60
  v_exp_f32 v61, v61
  v_exp_f32 v62, v62
  v_exp_f32 v63, v63
  s_nop 1
  v_smfmac_f32_32x32x32_bf16 v[64:79], v[180:183], v[56:63], v185 abid:1
  s_add_u32 s24, s27, 16384
  buffer_load_dwordx4 v[32:35], v187, s[8:11], s24 offen sc1
  buffer_load_dwordx4 v[36:39], v187, s[8:11], s24 offen offset:1024 sc1
  v_mov_b64 v[40:41], -1
  v_mov_b64 v[42:43], -1
  s_cmp_lt_u32 s2, 144
  s_cbranch_scc1 K2_CD0
  buffer_store_dwordx4 v[40:43], v187, s[8:11], s63 offen sc1
  s_add_u32 s63, s63, 458752
K2_CD0:
  buffer_store_dwordx4 v[40:43], v187, s[16:19], s59 offen offset:0 sc1
  s_nop 3
  ds_write_b128 v197, v[64:67] offset:10240
  ds_write_b128 v197, v[68:71] offset:11264
  ds_write_b64 v244, v[72:73] offset:12288
  ds_read_b64 v[40:41], v189 offset:22528
  ds_read_b64 v[42:43], v189 offset:25088
  ds_read_b64 v[44:45], v189 offset:27648
  ds_read_b64 v[46:47], v189 offset:30208
  ds_read_b128 v[48:51], v187 offset:20480
  ds_read_b128 v[52:55], v187 offset:23040
  ds_read_b128 v[56:59], v187 offset:25600
  ds_read_b128 v[60:63], v187 offset:28160
  ds_read_b128 v[64:67], v187 offset:21504
  ds_read_b128 v[68:71], v187 offset:24064
  ds_read_b128 v[72:75], v187 offset:26624
  ds_read_b128 v[76:79], v187 offset:29184
  s_waitcnt lgkmcnt(8)
  v_pk_add_f32 v[40:41], v[40:41], v[42:43]
  v_pk_add_f32 v[44:45], v[44:45], v[46:47]
  v_pk_add_f32 v[40:41], v[40:41], v[44:45]
  v_rcp_f32 v42, v41
  s_waitcnt lgkmcnt(4)
  v_pk_add_f32 v[48:49], v[48:49], v[52:53]
  v_pk_add_f32 v[56:57], v[56:57], v[60:61]
  v_pk_add_f32 v[48:49], v[48:49], v[56:57]
  v_pk_add_f32 v[50:51], v[50:51], v[54:55]
  v_pk_add_f32 v[58:59], v[58:59], v[62:63]
  v_pk_add_f32 v[50:51], v[50:51], v[58:59]
  v_pk_mul_f32 v[48:49], v[48:49], v[42:43] op_sel_hi:[1,0]
  v_pk_mul_f32 v[50:51], v[50:51], v[42:43] op_sel_hi:[1,0]
  v_cvt_pk_bf16_f32 v234, v48, v49
  v_cvt_pk_bf16_f32 v235, v50, v51
  s_waitcnt lgkmcnt(0)
  v_pk_add_f32 v[64:65], v[64:65], v[68:69]
  v_pk_add_f32 v[72:73], v[72:73], v[76:77]
  v_pk_add_f32 v[64:65], v[64:65], v[72:73]
  v_pk_add_f32 v[66:67], v[66:67], v[70:71]
  v_pk_add_f32 v[74:75], v[74:75], v[78:79]
  v_pk_add_f32 v[66:67], v[66:67], v[74:75]
  v_pk_mul_f32 v[64:65], v[64:65], v[42:43] op_sel_hi:[1,0]
  v_pk_mul_f32 v[66:67], v[66:67], v[42:43] op_sel_hi:[1,0]
  v_cvt_pk_bf16_f32 v236, v64, v65
  v_cvt_pk_bf16_f32 v237, v66, v67
  v_max3_u32 v243, v243, v41, v42
  v_mul_f32 v242, v40, v42
  s_waitcnt vmcnt(13)
  v_smfmac_f32_16x16x64_bf16 v[198:201], v[234:237], v[80:87], v185
  s_add_u32 s24, s27, 8192
  buffer_load_dwordx4 v[80:83], v187, s[8:11], s24 offen sc1
  buffer_load_dwordx4 v[84:87], v187, s[8:11], s24 offen offset:1024 sc1
  s_waitcnt vmcnt(13)
  v_smfmac_f32_16x16x64_bf16 v[202:205], v[234:237], v[88:95], v185
  s_add_u32 s24, s27, 10240
  buffer_load_dwordx4 v[88:91], v187, s[8:11], s24 offen sc1
  buffer_load_dwordx4 v[92:95], v187, s[8:11], s24 offen offset:1024 sc1
  s_waitcnt vmcnt(13)
  v_smfmac_f32_16x16x64_bf16 v[206:209], v[234:237], v[96:103], v185
  s_add_u32 s24, s27, 12288
  buffer_load_dwordx4 v[96:99], v187, s[8:11], s24 offen sc1
  buffer_load_dwordx4 v[100:103], v187, s[8:11], s24 offen offset:1024 sc1
  s_waitcnt vmcnt(13)
  v_smfmac_f32_16x16x64_bf16 v[210:213], v[234:237], v[104:111], v185
  s_add_u32 s24, s27, 14336
  buffer_load_dwordx4 v[104:107], v187, s[8:11], s24 offen sc1
  buffer_load_dwordx4 v[108:111], v187, s[8:11], s24 offen offset:1024 sc1
  s_waitcnt vmcnt(9)
  v_smfmac_f32_16x16x64_bf16 v[230:233], v[234:237], v[32:39], v185
  s_add_u32 m0, s58, 65536
  s_add_u32 s57, s62, 3538944
  buffer_load_dwordx4 v255, s[32:35], s57 offen lds
  s_add_u32 m0, s58, 69632
  s_add_u32 s57, s62, 4128768
  buffer_load_dwordx4 v255, s[32:35], s57 offen lds
  s_add_u32 m0, s58, 73728
  s_add_u32 s57, s62, 4718592
  buffer_load_dwordx4 v255, s[32:35], s57 offen lds
  s_mov_b32 m0, 163136
  s_nop 0
  buffer_load_dword v255, s[52:55], s51 offen lds
  s_waitcnt lgkmcnt(0)
  s_setprio 0
  v_exp_f32 v0, v0
  v_exp_f32 v1, v1
  v_mfma_f32_32x32x8_bf16 v[64:79], v[194:195], v[196:197], 0
  v_exp_f32 v2, v2
  v_exp_f32 v3, v3
  v_exp_f32 v4, v4
  v_mfma_f32_32x32x4_2b_bf16 v[32:63], v[186:187], v[194:195], 0
  v_exp_f32 v5, v5
  v_exp_f32 v6, v6
  v_exp_f32 v7, v7
  v_exp_f32 v8, v8
  v_exp_f32 v9, v9
  v_exp_f32 v10, v10
  v_exp_f32 v11, v11
  v_exp_f32 v12, v12
  v_smfmac_f32_32x32x32_bf16 v[64:79], v[136:139], v[0:7], v185 abid:1
  v_exp_f32 v13, v13
  v_exp_f32 v14, v14
  v_exp_f32 v15, v15
  v_exp_f32 v16, v16
  v_exp_f32 v17, v17
  v_smfmac_f32_32x32x32_bf16 v[64:79], v[140:143], v[8:15], v185 abid:1
  v_exp_f32 v18, v18
  v_exp_f32 v19, v19
  v_exp_f32 v20, v20
  v_mfma_f32_32x32x16_bf16 v[32:47], v[120:123], v[190:193], v[32:47]
  v_exp_f32 v21, v21
  v_exp_f32 v22, v22
  v_exp_f32 v23, v23
  v_mfma_f32_32x32x16_bf16 v[48:63], v[124:127], v[190:193], v[48:63]
  v_exp_f32 v24, v24
  v_exp_f32 v25, v25
  v_exp_f32 v26, v26
  v_smfmac_f32_32x32x32_bf16 v[64:79], v[144:147], v[16:23], v185 abid:1
  v_exp_f32 v27, v27
  v_exp_f32 v28, v28
  v_exp_f32 v29, v29
  v_exp_f32 v30, v30
  v_exp_f32 v31, v31
  s_waitcnt lgkmcnt(0)
  s_barrier
  s_setprio 2
  v_exp_f32 v32, v32
  v_exp_f32 v33, v33
  v_smfmac_f32_32x32x32_bf16 v[64:79], v[148:151], v[24:31], v185 abid:1
  v_exp_f32 v34, v34
  v_exp_f32 v35, v35
  v_exp_f32 v36, v36
  v_mfma_f32_32x32x4_2b_bf16 v[0:31], v[188:189], v[194:195], 0
  v_exp_f32 v37, v37
  v_exp_f32 v38, v38
  v_exp_f32 v39, v39
  v_exp_f32 v40, v40
  v_exp_f32 v41, v41
  v_exp_f32 v42, v42
  v_exp_f32 v43, v43
  v_exp_f32 v44, v44
  v_smfmac_f32_32x32x32_bf16 v[64:79], v[152:155], v[32:39], v185 abid:1
  v_exp_f32 v45, v45
  v_exp_f32 v46, v46
  v_exp_f32 v47, v47
  v_exp_f32 v48, v48
  v_exp_f32 v49, v49
  v_smfmac_f32_32x32x32_bf16 v[64:79], v[156:159], v[40:47], v185 abid:1
  v_exp_f32 v50, v50
  v_exp_f32 v51, v51
  v_exp_f32 v52, v52
  v_mfma_f32_32x32x16_bf16 v[0:15], v[128:131], v[190:193], v[0:15]
  v_exp_f32 v53, v53
  v_exp_f32 v54, v54
  v_exp_f32 v55, v55
  v_mfma_f32_32x32x16_bf16 v[16:31], v[132:135], v[190:193], v[16:31]
  v_exp_f32 v56, v56
  v_exp_f32 v57, v57
  v_exp_f32 v58, v58
  v_smfmac_f32_32x32x32_bf16 v[64:79], v[160:163], v[48:55], v185 abid:1
  v_exp_f32 v59, v59
  v_exp_f32 v60, v60
  v_exp_f32 v61, v61
  v_exp_f32 v62, v62
  v_exp_f32 v63, v63
  ds_read_b32 v252, v246 offset:7424
  ds_read_b128 v[248:251], v245 offset:6400
  s_waitcnt vmcnt(10)
  v_smfmac_f32_16x16x64_bf16 v[214:217], v[234:237], v[80:87], v185
  s_add_u32 s24, s27, 73728
  buffer_load_dwordx4 v[80:83], v187, s[8:11], s24 offen sc1
  buffer_load_dwordx4 v[84:87], v187, s[8:11], s24 offen offset:1024 sc1
  s_waitcnt vmcnt(10)
  v_smfmac_f32_16x16x64_bf16 v[218:221], v[234:237], v[88:95], v185
  s_add_u32 s24, s27, 75776
  buffer_load_dwordx4 v[88:91], v187, s[8:11], s24 offen sc1
  buffer_load_dwordx4 v[92:95], v187, s[8:11], s24 offen offset:1024 sc1
  s_waitcnt vmcnt(10)
  v_smfmac_f32_16x16x64_bf16 v[222:225], v[234:237], v[96:103], v185
  s_add_u32 s24, s27, 77824
  buffer_load_dwordx4 v[96:99], v187, s[8:11], s24 offen sc1
  buffer_load_dwordx4 v[100:103], v187, s[8:11], s24 offen offset:1024 sc1
  s_waitcnt vmcnt(10)
  v_smfmac_f32_16x16x64_bf16 v[226:229], v[234:237], v[104:111], v185
  s_add_u32 s24, s27, 79872
  buffer_load_dwordx4 v[104:107], v187, s[8:11], s24 offen sc1
  buffer_load_dwordx4 v[108:111], v187, s[8:11], s24 offen offset:1024 sc1
  v_exp_f32 v0, v0
  v_exp_f32 v1, v1
  v_smfmac_f32_32x32x32_bf16 v[64:79], v[164:167], v[56:63], v185 abid:1
  v_exp_f32 v2, v2
  v_exp_f32 v3, v3
  v_exp_f32 v4, v4
  s_waitcnt lgkmcnt(0)
  v_mfma_f32_32x32x4_2b_bf16 v[32:63], v[184:185], v[252:253], 0
  v_exp_f32 v5, v5
  v_exp_f32 v6, v6
  v_exp_f32 v7, v7
  v_exp_f32 v8, v8
  v_exp_f32 v9, v9
  v_exp_f32 v10, v10
  v_exp_f32 v11, v11
  v_exp_f32 v12, v12
  v_smfmac_f32_32x32x32_bf16 v[64:79], v[168:171], v[0:7], v185 abid:1
  v_exp_f32 v13, v13
  v_exp_f32 v14, v14
  v_exp_f32 v15, v15
  v_exp_f32 v16, v16
  v_exp_f32 v17, v17
  v_smfmac_f32_32x32x32_bf16 v[64:79], v[172:175], v[8:15], v185 abid:1
  v_exp_f32 v18, v18
  v_exp_f32 v19, v19
  v_exp_f32 v20, v20
  v_mfma_f32_32x32x16_bf16 v[32:47], v[112:115], v[248:251], v[32:47]
  v_exp_f32 v21, v21
  v_exp_f32 v22, v22
  v_exp_f32 v23, v23
  v_mfma_f32_32x32x16_bf16 v[48:63], v[116:119], v[248:251], v[48:63]
  v_exp_f32 v24, v24
  v_exp_f32 v25, v25
  v_exp_f32 v26, v26
  v_smfmac_f32_32x32x32_bf16 v[64:79], v[176:179], v[16:23], v185 abid:1
  v_exp_f32 v27, v27
  v_exp_f32 v28, v28
  v_exp_f32 v29, v29
  v_exp_f32 v30, v30
  v_exp_f32 v31, v31
  s_nop 1
  v_smfmac_f32_32x32x32_bf16 v[64:79], v[180:183], v[24:31], v185 abid:1
  s_add_u32 s24, s27, 90112
  buffer_load_dwordx4 v[0:3], v187, s[8:11], s24 offen sc1
  buffer_load_dwordx4 v[4:7], v187, s[8:11], s24 offen offset:1024 sc1
  v_mov_b64 v[8:9], -1
  v_mov_b64 v[10:11], -1
  s_cmp_lt_u32 s2, 144
  s_cbranch_scc1 K2_CD1
  buffer_store_dwordx4 v[8:11], v187, s[8:11], s63 offen sc1
  s_add_u32 s63, s63, 458752
K2_CD1:
  buffer_store_dwordx4 v[8:11], v187, s[16:19], s59 offen offset:1024 sc1
  s_nop 3
  ds_write_b128 v197, v[64:67] offset:0
  ds_write_b128 v197, v[68:71] offset:1024
  ds_write_b64 v244, v[72:73] offset:2048
  ds_read_b64 v[8:9], v189 offset:32768
  ds_read_b64 v[10:11], v189 offset:35328
  ds_read_b64 v[12:13], v189 offset:37888
  ds_read_b64 v[14:15], v189 offset:40448
  ds_read_b128 v[16:19], v187 offset:30720
  ds_read_b128 v[20:23], v187 offset:33280
  ds_read_b128 v[24:27], v187 offset:35840
  ds_read_b128 v[28:31], v187 offset:38400
  ds_read_b128 v[64:67], v187 offset:31744
  ds_read_b128 v[68:71], v187 offset:34304
  ds_read_b128 v[72:75], v187 offset:36864
  ds_read_b128 v[76:79], v187 offset:39424
  s_waitcnt lgkmcnt(8)
  v_pk_add_f32 v[8:9], v[8:9], v[10:11]
  v_pk_add_f32 v[12:13], v[12:13], v[14:15]
  v_pk_add_f32 v[8:9], v[8:9], v[12:13]
  v_rcp_f32 v10, v9
  s_waitcnt lgkmcnt(4)
  v_pk_add_f32 v[16:17], v[16:17], v[20:21]
  v_pk_add_f32 v[24:25], v[24:25], v[28:29]
  v_pk_add_f32 v[16:17], v[16:17], v[24:25]
  v_pk_add_f32 v[18:19], v[18:19], v[22:23]
  v_pk_add_f32 v[26:27], v[26:27], v[30:31]
  v_pk_add_f32 v[18:19], v[18:19], v[26:27]
  v_pk_mul_f32 v[16:17], v[16:17], v[10:11] op_sel_hi:[1,0]
  v_pk_mul_f32 v[18:19], v[18:19], v[10:11] op_sel_hi:[1,0]
  v_cvt_pk_bf16_f32 v234, v16, v17
  v_cvt_pk_bf16_f32 v235, v18, v19
  s_waitcnt lgkmcnt(0)
  v_pk_add_f32 v[64:65], v[64:65], v[68:69]
  v_pk_add_f32 v[72:73], v[72:73], v[76:77]
  v_pk_add_f32 v[64:65], v[64:65], v[72:73]
  v_pk_add_f32 v[66:67], v[66:67], v[70:71]
  v_pk_add_f32 v[74:75], v[74:75], v[78:79]
  v_pk_add_f32 v[66:67], v[66:67], v[74:75]
  v_pk_mul_f32 v[64:65], v[64:65], v[10:11] op_sel_hi:[1,0]
  v_pk_mul_f32 v[66:67], v[66:67], v[10:11] op_sel_hi:[1,0]
  v_cvt_pk_bf16_f32 v236, v64, v65
  v_cvt_pk_bf16_f32 v237, v66, v67
  v_max3_u32 v243, v243, v9, v10
  v_mul_f32 v8, v8, v10
  v_cvt_pk_bf16_f32 v238, v242, v8
  s_waitcnt vmcnt(9)
  v_smfmac_f32_16x16x64_bf16 v[198:201], v[234:237], v[80:87], v185
  s_add_u32 s24, s27, 81920
  buffer_load_dwordx4 v[80:83], v187, s[8:11], s24 offen sc1
  buffer_load_dwordx4 v[84:87], v187, s[8:11], s24 offen offset:1024 sc1
  s_waitcnt vmcnt(9)
  v_smfmac_f32_16x16x64_bf16 v[202:205], v[234:237], v[88:95], v185
  s_add_u32 s24, s27, 83968
  buffer_load_dwordx4 v[88:91], v187, s[8:11], s24 offen sc1
  buffer_load_dwordx4 v[92:95], v187, s[8:11], s24 offen offset:1024 sc1
  s_waitcnt vmcnt(9)
  v_smfmac_f32_16x16x64_bf16 v[206:209], v[234:237], v[96:103], v185
  s_add_u32 s24, s27, 86016
  buffer_load_dwordx4 v[96:99], v187, s[8:11], s24 offen sc1
  buffer_load_dwordx4 v[100:103], v187, s[8:11], s24 offen offset:1024 sc1
  s_waitcnt vmcnt(9)
  v_smfmac_f32_16x16x64_bf16 v[210:213], v[234:237], v[104:111], v185
  s_add_u32 s24, s27, 88064
  buffer_load_dwordx4 v[104:107], v187, s[8:11], s24 offen sc1
  buffer_load_dwordx4 v[108:111], v187, s[8:11], s24 offen offset:1024 sc1
  s_waitcnt vmcnt(9)
  v_smfmac_f32_16x16x64_bf16 v[230:233], v[234:237], v[0:7], v185
  s_add_u32 m0, s58, 77952
  s_add_u32 s57, s62, 0
  buffer_load_dwordx4 v255, s[40:43], s57 offen lds
  s_add_u32 m0, s58, 82048
  s_add_u32 s57, s62, 589824
  buffer_load_dwordx4 v255, s[40:43], s57 offen lds
  s_add_u32 m0, s58, 86144
  s_add_u32 s57, s62, 1179648
  buffer_load_dwordx4 v255, s[40:43], s57 offen lds
  s_mov_b32 m0, 163136
  s_nop 0
  buffer_load_dword v254, s[28:31], s64 offen lds
  s_waitcnt lgkmcnt(0)
  s_setprio 0
  v_exp_f32 v32, v32
  v_exp_f32 v33, v33
  v_mfma_f32_32x32x8_bf16 v[64:79], v[252:253], v[196:197], 0
  v_exp_f32 v34, v34
  v_exp_f32 v35, v35
  v_exp_f32 v36, v36
  v_mfma_f32_32x32x4_2b_bf16 v[0:31], v[186:187], v[252:253], 0
  v_exp_f32 v37, v37
  v_exp_f32 v38, v38
  v_exp_f32 v39, v39
  v_exp_f32 v40, v40
  v_exp_f32 v41, v41
  v_exp_f32 v42, v42
  v_exp_f32 v43, v43
  v_exp_f32 v44, v44
  v_smfmac_f32_32x32x32_bf16 v[64:79], v[136:139], v[32:39], v185 abid:1
  v_exp_f32 v45, v45
  v_exp_f32 v46, v46
  v_exp_f32 v47, v47
  v_exp_f32 v48, v48
  v_exp_f32 v49, v49
  v_smfmac_f32_32x32x32_bf16 v[64:79], v[140:143], v[40:47], v185 abid:1
  v_exp_f32 v50, v50
  v_exp_f32 v51, v51
  v_exp_f32 v52, v52
  v_mfma_f32_32x32x16_bf16 v[0:15], v[120:123], v[248:251], v[0:15]
  v_exp_f32 v53, v53
  v_exp_f32 v54, v54
  v_exp_f32 v55, v55
  v_mfma_f32_32x32x16_bf16 v[16:31], v[124:127], v[248:251], v[16:31]
  v_exp_f32 v56, v56
  v_exp_f32 v57, v57
  v_exp_f32 v58, v58
  v_smfmac_f32_32x32x32_bf16 v[64:79], v[144:147], v[48:55], v185 abid:1
  v_exp_f32 v59, v59
  v_exp_f32 v60, v60
  v_exp_f32 v61, v61
  v_exp_f32 v62, v62
  v_exp_f32 v63, v63
  s_waitcnt lgkmcnt(0)
  s_barrier
  s_setprio 2
  v_exp_f32 v0, v0
  v_exp_f32 v1, v1
  v_smfmac_f32_32x32x32_bf16 v[64:79], v[148:151], v[56:63], v185 abid:1
  v_exp_f32 v2, v2
  v_exp_f32 v3, v3
  v_exp_f32 v4, v4
  v_mfma_f32_32x32x4_2b_bf16 v[32:63], v[188:189], v[252:253], 0
  v_exp_f32 v5, v5
  v_exp_f32 v6, v6
  v_exp_f32 v7, v7
  v_exp_f32 v8, v8
  v_exp_f32 v9, v9
  v_exp_f32 v10, v10
  v_exp_f32 v11, v11
  v_exp_f32 v12, v12
  v_smfmac_f32_32x32x32_bf16 v[64:79], v[152:155], v[0:7], v185 abid:1
  v_exp_f32 v13, v13
  v_exp_f32 v14, v14
  v_exp_f32 v15, v15
  v_exp_f32 v16, v16
  v_exp_f32 v17, v17
  v_smfmac_f32_32x32x32_bf16 v[64:79], v[156:159], v[8:15], v185 abid:1
  v_exp_f32 v18, v18
  v_exp_f32 v19, v19
  v_exp_f32 v20, v20
  v_mfma_f32_32x32x16_bf16 v[32:47], v[128:131], v[248:251], v[32:47]
  v_exp_f32 v21, v21
  v_exp_f32 v22, v22
  v_exp_f32 v23, v23
  v_mfma_f32_32x32x16_bf16 v[48:63], v[132:135], v[248:251], v[48:63]
  v_exp_f32 v24, v24
  v_exp_f32 v25, v25
  v_exp_f32 v26, v26
  v_smfmac_f32_32x32x32_bf16 v[64:79], v[160:163], v[16:23], v185 abid:1
  v_exp_f32 v27, v27
  v_exp_f32 v28, v28
  v_exp_f32 v29, v29
  v_exp_f32 v30, v30
  v_exp_f32 v31, v31
  ds_read_b32 v194, v246 offset:8704
  ds_read_b128 v[190:193], v245 offset:7680
  s_waitcnt vmcnt(10)
  v_smfmac_f32_16x16x64_bf16 v[214:217], v[234:237], v[80:87], v185
  s_add_u32 s24, s27, 147456
  buffer_load_dwordx4 v[80:83], v187, s[8:11], s24 offen sc1
  buffer_load_dwordx4 v[84:87], v187, s[8:11], s24 offen offset:1024 sc1
  s_waitcnt vmcnt(10)
  v_smfmac_f32_16x16x64_bf16 v[218:221], v[234:237], v[88:95], v185
  s_add_u32 s24, s27, 149504
  buffer_load_dwordx4 v[88:91], v187, s[8:11], s24 offen sc1
  buffer_load_dwordx4 v[92:95], v187, s[8:11], s24 offen offset:1024 sc1
  s_waitcnt vmcnt(10)
  v_smfmac_f32_16x16x64_bf16 v[222:225], v[234:237], v[96:103], v185
  s_add_u32 s24, s27, 151552
  buffer_load_dwordx4 v[96:99], v187, s[8:11], s24 offen sc1
  buffer_load_dwordx4 v[100:103], v187, s[8:11], s24 offen offset:1024 sc1
  s_waitcnt vmcnt(10)
  v_smfmac_f32_16x16x64_bf16 v[226:229], v[234:237], v[104:111], v185
  s_add_u32 s24, s27, 153600
  buffer_load_dwordx4 v[104:107], v187, s[8:11], s24 offen sc1
  buffer_load_dwordx4 v[108:111], v187, s[8:11], s24 offen offset:1024 sc1
  v_exp_f32 v32, v32
  v_exp_f32 v33, v33
  v_smfmac_f32_32x32x32_bf16 v[64:79], v[164:167], v[24:31], v185 abid:1
  v_exp_f32 v34, v34
  v_exp_f32 v35, v35
  v_exp_f32 v36, v36
  s_waitcnt lgkmcnt(0)
  v_mfma_f32_32x32x4_2b_bf16 v[0:31], v[184:185], v[194:195], 0
  v_exp_f32 v37, v37
  v_exp_f32 v38, v38
  v_exp_f32 v39, v39
  v_exp_f32 v40, v40
  v_exp_f32 v41, v41
  v_exp_f32 v42, v42
  v_exp_f32 v43, v43
  v_exp_f32 v44, v44
  v_smfmac_f32_32x32x32_bf16 v[64:79], v[168:171], v[32:39], v185 abid:1
  v_exp_f32 v45, v45
  v_exp_f32 v46, v46
  v_exp_f32 v47, v47
  v_exp_f32 v48, v48
  v_exp_f32 v49, v49
  v_smfmac_f32_32x32x32_bf16 v[64:79], v[172:175], v[40:47], v185 abid:1
  v_exp_f32 v50, v50
  v_exp_f32 v51, v51
  v_exp_f32 v52, v52
  v_mfma_f32_32x32x16_bf16 v[0:15], v[112:115], v[190:193], v[0:15]
  v_exp_f32 v53, v53
  v_exp_f32 v54, v54
  v_exp_f32 v55, v55
  v_mfma_f32_32x32x16_bf16 v[16:31], v[116:119], v[190:193], v[16:31]
  v_exp_f32 v56, v56
  v_exp_f32 v57, v57
  v_exp_f32 v58, v58
  v_smfmac_f32_32x32x32_bf16 v[64:79], v[176:179], v[48:55], v185 abid:1
  v_exp_f32 v59, v59
  v_exp_f32 v60, v60
  v_exp_f32 v61, v61
  v_exp_f32 v62, v62
  v_exp_f32 v63, v63
  s_nop 1
  v_smfmac_f32_32x32x32_bf16 v[64:79], v[180:183], v[56:63], v185 abid:1
  s_add_u32 s24, s27, 163840
  buffer_load_dwordx4 v[32:35], v187, s[8:11], s24 offen sc1
  buffer_load_dwordx4 v[36:39], v187, s[8:11], s24 offen offset:1024 sc1
  v_mov_b64 v[40:41], -1
  v_mov_b64 v[42:43], -1
  s_cmp_lt_u32 s2, 144
  s_cbranch_scc1 K2_CD2
  buffer_store_dwordx4 v[40:43], v187, s[8:11], s63 offen sc1
  s_add_u32 s63, s63, 458752
K2_CD2:
  s_mov_b64 exec, 0xffff
  buffer_store_dwordx4 v[40:43], v187, s[16:19], s59 offen offset:2048 sc1
  s_mov_b64 exec, -1
  s_nop 3
  ds_write_b128 v197, v[64:67] offset:10240
  ds_write_b128 v197, v[68:71] offset:11264
  ds_write_b64 v244, v[72:73] offset:12288
  ds_read_b64 v[40:41], v189 offset:22528
  ds_read_b64 v[42:43], v189 offset:25088
  ds_read_b64 v[44:45], v189 offset:27648
  ds_read_b64 v[46:47], v189 offset:30208
  ds_read_b128 v[48:51], v187 offset:20480
  ds_read_b128 v[52:55], v187 offset:23040
  ds_read_b128 v[56:59], v187 offset:25600
  ds_read_b128 v[60:63], v187 offset:28160
  ds_read_b128 v[64:67], v187 offset:21504
  ds_read_b128 v[68:71], v187 offset:24064
  ds_read_b128 v[72:75], v187 offset:26624
  ds_read_b128 v[76:79], v187 offset:29184
  s_waitcnt lgkmcnt(8)
  v_pk_add_f32 v[40:41], v[40:41], v[42:43]
  v_pk_add_f32 v[44:45], v[44:45], v[46:47]
  v_pk_add_f32 v[40:41], v[40:41], v[44:45]
  v_rcp_f32 v42, v41
  s_waitcnt lgkmcnt(4)
  v_pk_add_f32 v[48:49], v[48:49], v[52:53]
  v_pk_add_f32 v[56:57], v[56:57], v[60:61]
  v_pk_add_f32 v[48:49], v[48:49], v[56:57]
  v_pk_add_f32 v[50:51], v[50:51], v[54:55]
  v_pk_add_f32 v[58:59], v[58:59], v[62:63]
  v_pk_add_f32 v[50:51], v[50:51], v[58:59]
  v_pk_mul_f32 v[48:49], v[48:49], v[42:43] op_sel_hi:[1,0]
  v_pk_mul_f32 v[50:51], v[50:51], v[42:43] op_sel_hi:[1,0]
  v_cvt_pk_bf16_f32 v234, v48, v49
  v_cvt_pk_bf16_f32 v235, v50, v51
  s_waitcnt lgkmcnt(0)
  v_pk_add_f32 v[64:65], v[64:65], v[68:69]
  v_pk_add_f32 v[72:73], v[72:73], v[76:77]
  v_pk_add_f32 v[64:65], v[64:65], v[72:73]
  v_pk_add_f32 v[66:67], v[66:67], v[70:71]
  v_pk_add_f32 v[74:75], v[74:75], v[78:79]
  v_pk_add_f32 v[66:67], v[66:67], v[74:75]
  v_pk_mul_f32 v[64:65], v[64:65], v[42:43] op_sel_hi:[1,0]
  v_pk_mul_f32 v[66:67], v[66:67], v[42:43] op_sel_hi:[1,0]
  v_cvt_pk_bf16_f32 v236, v64, v65
  v_cvt_pk_bf16_f32 v237, v66, v67
  v_max3_u32 v243, v243, v41, v42
  v_mul_f32 v242, v40, v42
  s_waitcnt vmcnt(9)
  v_smfmac_f32_16x16x64_bf16 v[198:201], v[234:237], v[80:87], v185
  s_add_u32 s24, s27, 155648
  buffer_load_dwordx4 v[80:83], v187, s[8:11], s24 offen sc1
  buffer_load_dwordx4 v[84:87], v187, s[8:11], s24 offen offset:1024 sc1
  s_waitcnt vmcnt(9)
  v_smfmac_f32_16x16x64_bf16 v[202:205], v[234:237], v[88:95], v185
  s_add_u32 s24, s27, 157696
  buffer_load_dwordx4 v[88:91], v187, s[8:11], s24 offen sc1
  buffer_load_dwordx4 v[92:95], v187, s[8:11], s24 offen offset:1024 sc1
  s_waitcnt vmcnt(9)
  v_smfmac_f32_16x16x64_bf16 v[206:209], v[234:237], v[96:103], v185
  s_add_u32 s24, s27, 159744
  buffer_load_dwordx4 v[96:99], v187, s[8:11], s24 offen sc1
  buffer_load_dwordx4 v[100:103], v187, s[8:11], s24 offen offset:1024 sc1
  s_waitcnt vmcnt(9)
  v_smfmac_f32_16x16x64_bf16 v[210:213], v[234:237], v[104:111], v185
  s_add_u32 s24, s27, 161792
  buffer_load_dwordx4 v[104:107], v187, s[8:11], s24 offen sc1
  buffer_load_dwordx4 v[108:111], v187, s[8:11], s24 offen offset:1024 sc1
  s_waitcnt vmcnt(9)
  v_smfmac_f32_16x16x64_bf16 v[230:233], v[234:237], v[32:39], v185
  s_add_u32 m0, s58, 90240
  s_add_u32 s57, s62, 1769472
  buffer_load_dwordx4 v255, s[40:43], s57 offen lds
  s_add_u32 m0, s58, 94336
  s_add_u32 s57, s62, 2359296
  buffer_load_dwordx4 v255, s[40:43], s57 offen lds
  s_add_u32 m0, s58, 98432
  s_add_u32 s57, s62, 2949120
  buffer_load_dwordx4 v255, s[40:43], s57 offen lds
  s_mov_b32 m0, 163136
  s_nop 0
  buffer_load_dword v254, s[28:31], s65 offen lds
  s_waitcnt lgkmcnt(0)
  s_setprio 0
  v_exp_f32 v0, v0
  v_exp_f32 v1, v1
  v_mfma_f32_32x32x8_bf16 v[64:79], v[194:195], v[196:197], 0
  v_exp_f32 v2, v2
  v_exp_f32 v3, v3
  v_exp_f32 v4, v4
  v_mfma_f32_32x32x4_2b_bf16 v[32:63], v[186:187], v[194:195], 0
  v_exp_f32 v5, v5
  v_exp_f32 v6, v6
  v_exp_f32 v7, v7
  v_exp_f32 v8, v8
  v_exp_f32 v9, v9
  v_exp_f32 v10, v10
  v_exp_f32 v11, v11
  v_exp_f32 v12, v12
  v_smfmac_f32_32x32x32_bf16 v[64:79], v[136:139], v[0:7], v185 abid:1
  v_exp_f32 v13, v13
  v_exp_f32 v14, v14
  v_exp_f32 v15, v15
  v_exp_f32 v16, v16
  v_exp_f32 v17, v17
  v_smfmac_f32_32x32x32_bf16 v[64:79], v[140:143], v[8:15], v185 abid:1
  v_exp_f32 v18, v18
  v_exp_f32 v19, v19
  v_exp_f32 v20, v20
  v_mfma_f32_32x32x16_bf16 v[32:47], v[120:123], v[190:193], v[32:47]
  v_exp_f32 v21, v21
  v_exp_f32 v22, v22
  v_exp_f32 v23, v23
  v_mfma_f32_32x32x16_bf16 v[48:63], v[124:127], v[190:193], v[48:63]
  v_exp_f32 v24, v24
  v_exp_f32 v25, v25
  v_exp_f32 v26, v26
  v_smfmac_f32_32x32x32_bf16 v[64:79], v[144:147], v[16:23], v185 abid:1
  v_exp_f32 v27, v27
  v_exp_f32 v28, v28
  v_exp_f32 v29, v29
  v_exp_f32 v30, v30
  v_exp_f32 v31, v31
  s_waitcnt lgkmcnt(0)
  s_barrier
  s_setprio 2
  v_exp_f32 v32, v32
  v_exp_f32 v33, v33
  v_smfmac_f32_32x32x32_bf16 v[64:79], v[148:151], v[24:31], v185 abid:1
  v_exp_f32 v34, v34
  v_exp_f32 v35, v35
  v_exp_f32 v36, v36
  v_mfma_f32_32x32x4_2b_bf16 v[0:31], v[188:189], v[194:195], 0
  v_exp_f32 v37, v37
  v_exp_f32 v38, v38
  v_exp_f32 v39, v39
  v_exp_f32 v40, v40
  v_exp_f32 v41, v41
  v_exp_f32 v42, v42
  v_exp_f32 v43, v43
  v_exp_f32 v44, v44
  v_smfmac_f32_32x32x32_bf16 v[64:79], v[152:155], v[32:39], v185 abid:1
  v_exp_f32 v45, v45
  v_exp_f32 v46, v46
  v_exp_f32 v47, v47
  v_exp_f32 v48, v48
  v_exp_f32 v49, v49
  v_smfmac_f32_32x32x32_bf16 v[64:79], v[156:159], v[40:47], v185 abid:1
  v_exp_f32 v50, v50
  v_exp_f32 v51, v51
  v_exp_f32 v52, v52
  v_mfma_f32_32x32x16_bf16 v[0:15], v[128:131], v[190:193], v[0:15]
  v_exp_f32 v53, v53
  v_exp_f32 v54, v54
  v_exp_f32 v55, v55
  v_mfma_f32_32x32x16_bf16 v[16:31], v[132:135], v[190:193], v[16:31]
  v_exp_f32 v56, v56
  v_exp_f32 v57, v57
  v_exp_f32 v58, v58
  v_smfmac_f32_32x32x32_bf16 v[64:79], v[160:163], v[48:55], v185 abid:1
  v_exp_f32 v59, v59
  v_exp_f32 v60, v60
  v_exp_f32 v61, v61
  v_exp_f32 v62, v62
  v_exp_f32 v63, v63
  ds_read_b32 v252, v246 offset:9984
  ds_read_b128 v[248:251], v245 offset:8960
  s_waitcnt vmcnt(10)
  v_smfmac_f32_16x16x64_bf16 v[214:217], v[234:237], v[80:87], v185
  s_add_u32 s24, s27, 221184
  buffer_load_dwordx4 v[80:83], v187, s[8:11], s24 offen sc1
  buffer_load_dwordx4 v[84:87], v187, s[8:11], s24 offen offset:1024 sc1
  s_waitcnt vmcnt(10)
  v_smfmac_f32_16x16x64_bf16 v[218:221], v[234:237], v[88:95], v185
  s_add_u32 s24, s27, 223232
  buffer_load_dwordx4 v[88:91], v187, s[8:11], s24 offen sc1
  buffer_load_dwordx4 v[92:95], v187, s[8:11], s24 offen offset:1024 sc1
  s_waitcnt vmcnt(10)
  v_smfmac_f32_16x16x64_bf16 v[222:225], v[234:237], v[96:103], v185
  s_add_u32 s24, s27, 225280
  buffer_load_dwordx4 v[96:99], v187, s[8:11], s24 offen sc1
  buffer_load_dwordx4 v[100:103], v187, s[8:11], s24 offen offset:1024 sc1
  s_waitcnt vmcnt(10)
  v_smfmac_f32_16x16x64_bf16 v[226:229], v[234:237], v[104:111], v185
  s_add_u32 s24, s27, 227328
  buffer_load_dwordx4 v[104:107], v187, s[8:11], s24 offen sc1
  buffer_load_dwordx4 v[108:111], v187, s[8:11], s24 offen offset:1024 sc1
  v_exp_f32 v0, v0
  v_exp_f32 v1, v1
  v_smfmac_f32_32x32x32_bf16 v[64:79], v[164:167], v[56:63], v185 abid:1
  v_exp_f32 v2, v2
  v_exp_f32 v3, v3
  v_exp_f32 v4, v4
  s_waitcnt lgkmcnt(0)
  v_mfma_f32_32x32x4_2b_bf16 v[32:63], v[184:185], v[252:253], 0
  v_exp_f32 v5, v5
  v_exp_f32 v6, v6
  v_exp_f32 v7, v7
  v_exp_f32 v8, v8
  v_exp_f32 v9, v9
  v_exp_f32 v10, v10
  v_exp_f32 v11, v11
  v_exp_f32 v12, v12
  v_smfmac_f32_32x32x32_bf16 v[64:79], v[168:171], v[0:7], v185 abid:1
  v_exp_f32 v13, v13
  v_exp_f32 v14, v14
  v_exp_f32 v15, v15
  v_exp_f32 v16, v16
  v_exp_f32 v17, v17
  v_smfmac_f32_32x32x32_bf16 v[64:79], v[172:175], v[8:15], v185 abid:1
  v_exp_f32 v18, v18
  v_exp_f32 v19, v19
  v_exp_f32 v20, v20
  v_mfma_f32_32x32x16_bf16 v[32:47], v[112:115], v[248:251], v[32:47]
  v_exp_f32 v21, v21
  v_exp_f32 v22, v22
  v_exp_f32 v23, v23
  v_mfma_f32_32x32x16_bf16 v[48:63], v[116:119], v[248:251], v[48:63]
  v_exp_f32 v24, v24
  v_exp_f32 v25, v25
  v_exp_f32 v26, v26
  v_smfmac_f32_32x32x32_bf16 v[64:79], v[176:179], v[16:23], v185 abid:1
  v_exp_f32 v27, v27
  v_exp_f32 v28, v28
  v_exp_f32 v29, v29
  v_exp_f32 v30, v30
  v_exp_f32 v31, v31
  s_nop 1
  v_smfmac_f32_32x32x32_bf16 v[64:79], v[180:183], v[24:31], v185 abid:1
  s_add_u32 s24, s27, 237568
  buffer_load_dwordx4 v[0:3], v187, s[8:11], s24 offen sc1
  buffer_load_dwordx4 v[4:7], v187, s[8:11], s24 offen offset:1024 sc1
  v_mov_b64 v[8:9], -1
  v_mov_b64 v[10:11], -1
  s_mov_b64 exec, 3
  buffer_store_dwordx4 v[8:11], v187, s[8:11], s61 offen sc1
  s_mov_b64 exec, -1
  s_nop 3
  ds_write_b128 v197, v[64:67] offset:0
  ds_write_b128 v197, v[68:71] offset:1024
  ds_write_b64 v244, v[72:73] offset:2048
  ds_read_b64 v[8:9], v189 offset:32768
  ds_read_b64 v[10:11], v189 offset:35328
  ds_read_b64 v[12:13], v189 offset:37888
  ds_read_b64 v[14:15], v189 offset:40448
  ds_read_b128 v[16:19], v187 offset:30720
  ds_read_b128 v[20:23], v187 offset:33280
  ds_read_b128 v[24:27], v187 offset:35840
  ds_read_b128 v[28:31], v187 offset:38400
  ds_read_b128 v[64:67], v187 offset:31744
  ds_read_b128 v[68:71], v187 offset:34304
  ds_read_b128 v[72:75], v187 offset:36864
  ds_read_b128 v[76:79], v187 offset:39424
  s_waitcnt lgkmcnt(8)
  v_pk_add_f32 v[8:9], v[8:9], v[10:11]
  v_pk_add_f32 v[12:13], v[12:13], v[14:15]
  v_pk_add_f32 v[8:9], v[8:9], v[12:13]
  v_rcp_f32 v10, v9
  s_waitcnt lgkmcnt(4)
  v_pk_add_f32 v[16:17], v[16:17], v[20:21]
  v_pk_add_f32 v[24:25], v[24:25], v[28:29]
  v_pk_add_f32 v[16:17], v[16:17], v[24:25]
  v_pk_add_f32 v[18:19], v[18:19], v[22:23]
  v_pk_add_f32 v[26:27], v[26:27], v[30:31]
  v_pk_add_f32 v[18:19], v[18:19], v[26:27]
  v_pk_mul_f32 v[16:17], v[16:17], v[10:11] op_sel_hi:[1,0]
  v_pk_mul_f32 v[18:19], v[18:19], v[10:11] op_sel_hi:[1,0]
  v_cvt_pk_bf16_f32 v234, v16, v17
  v_cvt_pk_bf16_f32 v235, v18, v19
  s_waitcnt lgkmcnt(0)
  v_pk_add_f32 v[64:65], v[64:65], v[68:69]
  v_pk_add_f32 v[72:73], v[72:73], v[76:77]
  v_pk_add_f32 v[64:65], v[64:65], v[72:73]
  v_pk_add_f32 v[66:67], v[66:67], v[70:71]
  v_pk_add_f32 v[74:75], v[74:75], v[78:79]
  v_pk_add_f32 v[66:67], v[66:67], v[74:75]
  v_pk_mul_f32 v[64:65], v[64:65], v[10:11] op_sel_hi:[1,0]
  v_pk_mul_f32 v[66:67], v[66:67], v[10:11] op_sel_hi:[1,0]
  v_cvt_pk_bf16_f32 v236, v64, v65
  v_cvt_pk_bf16_f32 v237, v66, v67
  v_max3_u32 v243, v243, v9, v10
  v_mul_f32 v8, v8, v10
  v_cvt_pk_bf16_f32 v239, v242, v8
  s_waitcnt vmcnt(9)
  v_smfmac_f32_16x16x64_bf16 v[198:201], v[234:237], v[80:87], v185
  s_add_u32 s24, s27, 229376
  buffer_load_dwordx4 v[80:83], v187, s[8:11], s24 offen sc1
  buffer_load_dwordx4 v[84:87], v187, s[8:11], s24 offen offset:1024 sc1
  s_waitcnt vmcnt(9)
  v_smfmac_f32_16x16x64_bf16 v[202:205], v[234:237], v[88:95], v185
  s_add_u32 s24, s27, 231424
  buffer_load_dwordx4 v[88:91], v187, s[8:11], s24 offen sc1
  buffer_load_dwordx4 v[92:95], v187, s[8:11], s24 offen offset:1024 sc1
  s_waitcnt vmcnt(9)
  v_smfmac_f32_16x16x64_bf16 v[206:209], v[234:237], v[96:103], v185
  s_add_u32 s24, s27, 233472
  buffer_load_dwordx4 v[96:99], v187, s[8:11], s24 offen sc1
  buffer_load_dwordx4 v[100:103], v187, s[8:11], s24 offen offset:1024 sc1
  s_waitcnt vmcnt(9)
  v_smfmac_f32_16x16x64_bf16 v[210:213], v[234:237], v[104:111], v185
  s_add_u32 s24, s27, 235520
  buffer_load_dwordx4 v[104:107], v187, s[8:11], s24 offen sc1
  buffer_load_dwordx4 v[108:111], v187, s[8:11], s24 offen offset:1024 sc1
  s_waitcnt vmcnt(9)
  v_smfmac_f32_16x16x64_bf16 v[230:233], v[234:237], v[0:7], v185
  s_add_u32 m0, s58, 102528
  s_add_u32 s57, s62, 3538944
  buffer_load_dwordx4 v255, s[40:43], s57 offen lds
  s_add_u32 m0, s58, 106624
  s_add_u32 s57, s62, 4128768
  buffer_load_dwordx4 v255, s[40:43], s57 offen lds
  s_add_u32 m0, s58, 110720
  s_add_u32 s57, s62, 4718592
  buffer_load_dwordx4 v255, s[40:43], s57 offen lds
  s_waitcnt lgkmcnt(0)
  s_setprio 0
  v_exp_f32 v32, v32
  v_exp_f32 v33, v33
  v_mfma_f32_32x32x8_bf16 v[64:79], v[252:253], v[196:197], 0
  v_exp_f32 v34, v34
  v_exp_f32 v35, v35
  v_exp_f32 v36, v36
  v_mfma_f32_32x32x4_2b_bf16 v[0:31], v[186:187], v[252:253], 0
  v_exp_f32 v37, v37
  v_exp_f32 v38, v38
  v_exp_f32 v39, v39
  v_exp_f32 v40, v40
  v_exp_f32 v41, v41
  v_exp_f32 v42, v42
  v_exp_f32 v43, v43
  v_exp_f32 v44, v44
  v_smfmac_f32_32x32x32_bf16 v[64:79], v[136:139], v[32:39], v185 abid:1
  v_exp_f32 v45, v45
  v_exp_f32 v46, v46
  v_exp_f32 v47, v47
  v_exp_f32 v48, v48
  v_exp_f32 v49, v49
  v_smfmac_f32_32x32x32_bf16 v[64:79], v[140:143], v[40:47], v185 abid:1
  v_exp_f32 v50, v50
  v_exp_f32 v51, v51
  v_exp_f32 v52, v52
  v_mfma_f32_32x32x16_bf16 v[0:15], v[120:123], v[248:251], v[0:15]
  v_exp_f32 v53, v53
  v_exp_f32 v54, v54
  v_exp_f32 v55, v55
  v_mfma_f32_32x32x16_bf16 v[16:31], v[124:127], v[248:251], v[16:31]
  v_exp_f32 v56, v56
  v_exp_f32 v57, v57
  v_exp_f32 v58, v58
  v_smfmac_f32_32x32x32_bf16 v[64:79], v[144:147], v[48:55], v185 abid:1
  v_exp_f32 v59, v59
  v_exp_f32 v60, v60
  v_exp_f32 v61, v61
  v_exp_f32 v62, v62
  v_exp_f32 v63, v63
  s_waitcnt lgkmcnt(0)
  s_barrier
  s_setprio 2
  v_exp_f32 v0, v0
  v_exp_f32 v1, v1
  v_smfmac_f32_32x32x32_bf16 v[64:79], v[148:151], v[56:63], v185 abid:1
  v_exp_f32 v2, v2
  v_exp_f32 v3, v3
  v_exp_f32 v4, v4
  v_mfma_f32_32x32x4_2b_bf16 v[32:63], v[188:189], v[252:253], 0
  v_exp_f32 v5, v5
  v_exp_f32 v6, v6
  v_exp_f32 v7, v7
  v_exp_f32 v8, v8
  v_exp_f32 v9, v9
  v_exp_f32 v10, v10
  v_exp_f32 v11, v11
  v_exp_f32 v12, v12
  v_smfmac_f32_32x32x32_bf16 v[64:79], v[152:155], v[0:7], v185 abid:1
  v_exp_f32 v13, v13
  v_exp_f32 v14, v14
  v_exp_f32 v15, v15
  v_exp_f32 v16, v16
  v_exp_f32 v17, v17
  v_smfmac_f32_32x32x32_bf16 v[64:79], v[156:159], v[8:15], v185 abid:1
  v_exp_f32 v18, v18
  v_exp_f32 v19, v19
  v_exp_f32 v20, v20
  v_mfma_f32_32x32x16_bf16 v[32:47], v[128:131], v[248:251], v[32:47]
  v_exp_f32 v21, v21
  v_exp_f32 v22, v22
  v_exp_f32 v23, v23
  v_mfma_f32_32x32x16_bf16 v[48:63], v[132:135], v[248:251], v[48:63]
  v_exp_f32 v24, v24
  v_exp_f32 v25, v25
  v_exp_f32 v26, v26
  v_smfmac_f32_32x32x32_bf16 v[64:79], v[160:163], v[16:23], v185 abid:1
  v_exp_f32 v27, v27
  v_exp_f32 v28, v28
  v_exp_f32 v29, v29
  v_exp_f32 v30, v30
  v_exp_f32 v31, v31
  s_waitcnt vmcnt(9)
  v_smfmac_f32_16x16x64_bf16 v[214:217], v[234:237], v[80:87], v185
  s_add_u32 s24, s27, 294912
  buffer_load_dwordx4 v[80:83], v187, s[8:11], s24 offen sc1
  buffer_load_dwordx4 v[84:87], v187, s[8:11], s24 offen offset:1024 sc1
  s_waitcnt vmcnt(9)
  v_smfmac_f32_16x16x64_bf16 v[218:221], v[234:237], v[88:95], v185
  s_add_u32 s24, s27, 296960
  buffer_load_dwordx4 v[88:91], v187, s[8:11], s24 offen sc1
  buffer_load_dwordx4 v[92:95], v187, s[8:11], s24 offen offset:1024 sc1
  s_waitcnt vmcnt(9)
  v_smfmac_f32_16x16x64_bf16 v[222:225], v[234:237], v[96:103], v185
  s_add_u32 s24, s27, 299008
  buffer_load_dwordx4 v[96:99], v187, s[8:11], s24 offen sc1
  buffer_load_dwordx4 v[100:103], v187, s[8:11], s24 offen offset:1024 sc1
  s_waitcnt vmcnt(9)
  v_smfmac_f32_16x16x64_bf16 v[226:229], v[234:237], v[104:111], v185
  s_add_u32 s24, s27, 301056
  buffer_load_dwordx4 v[104:107], v187, s[8:11], s24 offen sc1
  buffer_load_dwordx4 v[108:111], v187, s[8:11], s24 offen offset:1024 sc1
  v_exp_f32 v32, v32
  v_exp_f32 v33, v33
  v_smfmac_f32_32x32x32_bf16 v[64:79], v[164:167], v[24:31], v185 abid:1
  v_exp_f32 v34, v34
  v_exp_f32 v35, v35
  v_exp_f32 v36, v36
  v_exp_f32 v37, v37
  v_exp_f32 v38, v38
  v_exp_f32 v39, v39
  v_exp_f32 v40, v40
  v_exp_f32 v41, v41
  v_exp_f32 v42, v42
  v_exp_f32 v43, v43
  v_exp_f32 v44, v44
  v_smfmac_f32_32x32x32_bf16 v[64:79], v[168:171], v[32:39], v185 abid:1
  v_exp_f32 v45, v45
  v_exp_f32 v46, v46
  v_exp_f32 v47, v47
  v_exp_f32 v48, v48
  v_exp_f32 v49, v49
  v_smfmac_f32_32x32x32_bf16 v[64:79], v[172:175], v[40:47], v185 abid:1
  v_exp_f32 v50, v50
  v_exp_f32 v51, v51
  v_exp_f32 v52, v52
  v_exp_f32 v53, v53
  v_exp_f32 v54, v54
  v_exp_f32 v55, v55
  v_exp_f32 v56, v56
  v_exp_f32 v57, v57
  v_exp_f32 v58, v58
  v_smfmac_f32_32x32x32_bf16 v[64:79], v[176:179], v[48:55], v185 abid:1
  v_exp_f32 v59, v59
  v_exp_f32 v60, v60
  v_exp_f32 v61, v61
  v_exp_f32 v62, v62
  v_exp_f32 v63, v63
  s_nop 1
  v_smfmac_f32_32x32x32_bf16 v[64:79], v[180:183], v[56:63], v185 abid:1
  s_add_u32 s24, s27, 311296
  buffer_load_dwordx4 v[32:35], v187, s[8:11], s24 offen sc1
  buffer_load_dwordx4 v[36:39], v187, s[8:11], s24 offen offset:1024 sc1
  s_add_u32 s24, s27, 368640
  buffer_load_dwordx4 v[112:115], v187, s[8:11], s24 offen sc1
  buffer_load_dwordx4 v[116:119], v187, s[8:11], s24 offen offset:1024 sc1
  s_add_u32 s24, s27, 370688
  buffer_load_dwordx4 v[120:123], v187, s[8:11], s24 offen sc1
  buffer_load_dwordx4 v[124:127], v187, s[8:11], s24 offen offset:1024 sc1
  s_add_u32 s24, s27, 372736
  buffer_load_dwordx4 v[128:131], v187, s[8:11], s24 offen sc1
  buffer_load_dwordx4 v[132:135], v187, s[8:11], s24 offen offset:1024 sc1
  ds_write_b128 v197, v[64:67] offset:10240
  ds_write_b128 v197, v[68:71] offset:11264
  ds_write_b64 v244, v[72:73] offset:12288
  ds_read_b64 v[40:41], v189 offset:22528
  ds_read_b64 v[42:43], v189 offset:25088
  ds_read_b64 v[44:45], v189 offset:27648
  ds_read_b64 v[46:47], v189 offset:30208
  ds_read_b128 v[48:51], v187 offset:20480
  ds_read_b128 v[52:55], v187 offset:23040
  ds_read_b128 v[56:59], v187 offset:25600
  ds_read_b128 v[60:63], v187 offset:28160
  ds_read_b128 v[64:67], v187 offset:21504
  ds_read_b128 v[68:71], v187 offset:24064
  ds_read_b128 v[72:75], v187 offset:26624
  ds_read_b128 v[76:79], v187 offset:29184
  s_waitcnt lgkmcnt(8)
  v_pk_add_f32 v[40:41], v[40:41], v[42:43]
  v_pk_add_f32 v[44:45], v[44:45], v[46:47]
  v_pk_add_f32 v[40:41], v[40:41], v[44:45]
  v_rcp_f32 v42, v41
  s_waitcnt lgkmcnt(4)
  v_pk_add_f32 v[48:49], v[48:49], v[52:53]
  v_pk_add_f32 v[56:57], v[56:57], v[60:61]
  v_pk_add_f32 v[48:49], v[48:49], v[56:57]
  v_pk_add_f32 v[50:51], v[50:51], v[54:55]
  v_pk_add_f32 v[58:59], v[58:59], v[62:63]
  v_pk_add_f32 v[50:51], v[50:51], v[58:59]
  v_pk_mul_f32 v[48:49], v[48:49], v[42:43] op_sel_hi:[1,0]
  v_pk_mul_f32 v[50:51], v[50:51], v[42:43] op_sel_hi:[1,0]
  v_cvt_pk_bf16_f32 v234, v48, v49
  v_cvt_pk_bf16_f32 v235, v50, v51
  s_waitcnt lgkmcnt(0)
  v_pk_add_f32 v[64:65], v[64:65], v[68:69]
  v_pk_add_f32 v[72:73], v[72:73], v[76:77]
  v_pk_add_f32 v[64:65], v[64:65], v[72:73]
  v_pk_add_f32 v[66:67], v[66:67], v[70:71]
  v_pk_add_f32 v[74:75], v[74:75], v[78:79]
  v_pk_add_f32 v[66:67], v[66:67], v[74:75]
  v_pk_mul_f32 v[64:65], v[64:65], v[42:43] op_sel_hi:[1,0]
  v_pk_mul_f32 v[66:67], v[66:67], v[42:43] op_sel_hi:[1,0]
  v_cvt_pk_bf16_f32 v236, v64, v65
  v_cvt_pk_bf16_f32 v237, v66, v67
  v_max3_u32 v243, v243, v41, v42
  v_mul_f32 v242, v40, v42
  s_waitcnt vmcnt(14)
  v_smfmac_f32_16x16x64_bf16 v[198:201], v[234:237], v[80:87], v185
  s_add_u32 s24, s27, 303104
  buffer_load_dwordx4 v[80:83], v187, s[8:11], s24 offen sc1
  buffer_load_dwordx4 v[84:87], v187, s[8:11], s24 offen offset:1024 sc1
  s_waitcnt vmcnt(14)
  v_smfmac_f32_16x16x64_bf16 v[202:205], v[234:237], v[88:95], v185
  s_add_u32 s24, s27, 305152
  buffer_load_dwordx4 v[88:91], v187, s[8:11], s24 offen sc1
  buffer_load_dwordx4 v[92:95], v187, s[8:11], s24 offen offset:1024 sc1
  s_waitcnt vmcnt(14)
  v_smfmac_f32_16x16x64_bf16 v[206:209], v[234:237], v[96:103], v185
  s_add_u32 s24, s27, 307200
  buffer_load_dwordx4 v[96:99], v187, s[8:11], s24 offen sc1
  buffer_load_dwordx4 v[100:103], v187, s[8:11], s24 offen offset:1024 sc1
  s_waitcnt vmcnt(14)
  v_smfmac_f32_16x16x64_bf16 v[210:213], v[234:237], v[104:111], v185
  s_add_u32 s24, s27, 309248
  buffer_load_dwordx4 v[104:107], v187, s[8:11], s24 offen sc1
  buffer_load_dwordx4 v[108:111], v187, s[8:11], s24 offen offset:1024 sc1
  s_waitcnt vmcnt(14)
  v_smfmac_f32_16x16x64_bf16 v[230:233], v[234:237], v[32:39], v185
  s_add_u32 s24, s27, 374784
  buffer_load_dwordx4 v[136:139], v187, s[8:11], s24 offen sc1
  buffer_load_dwordx4 v[140:143], v187, s[8:11], s24 offen offset:1024 sc1
  s_add_u32 s24, s27, 376832
  buffer_load_dwordx4 v[144:147], v187, s[8:11], s24 offen sc1
  buffer_load_dwordx4 v[148:151], v187, s[8:11], s24 offen offset:1024 sc1
  s_add_u32 s24, s27, 378880
  buffer_load_dwordx4 v[152:155], v187, s[8:11], s24 offen sc1
  buffer_load_dwordx4 v[156:159], v187, s[8:11], s24 offen offset:1024 sc1
  s_add_u32 s24, s27, 380928
  buffer_load_dwordx4 v[160:163], v187, s[8:11], s24 offen sc1
  buffer_load_dwordx4 v[164:167], v187, s[8:11], s24 offen offset:1024 sc1
  s_add_u32 s24, s27, 382976
  buffer_load_dwordx4 v[168:171], v187, s[8:11], s24 offen sc1
  buffer_load_dwordx4 v[172:175], v187, s[8:11], s24 offen offset:1024 sc1
  s_waitcnt vmcnt(16)
  v_smfmac_f32_16x16x64_bf16 v[214:217], v[234:237], v[80:87], v185
  s_waitcnt vmcnt(14)
  v_smfmac_f32_16x16x64_bf16 v[218:221], v[234:237], v[88:95], v185
  s_waitcnt vmcnt(12)
  v_smfmac_f32_16x16x64_bf16 v[222:225], v[234:237], v[96:103], v185
  s_waitcnt vmcnt(10)
  v_smfmac_f32_16x16x64_bf16 v[226:229], v[234:237], v[104:111], v185
  s_waitcnt lgkmcnt(0)
  s_barrier
  s_add_u32 s24, s27, 385024
  buffer_load_dwordx4 v[176:179], v187, s[8:11], s24 offen sc1
  buffer_load_dwordx4 v[180:183], v187, s[8:11], s24 offen offset:1024 sc1
  s_add_u32 s24, s27, 442368
  buffer_load_dwordx4 v[80:83], v187, s[8:11], s24 offen sc1
  buffer_load_dwordx4 v[84:87], v187, s[8:11], s24 offen offset:1024 sc1
  s_add_u32 s24, s27, 444416
  buffer_load_dwordx4 v[88:91], v187, s[8:11], s24 offen sc1
  buffer_load_dwordx4 v[92:95], v187, s[8:11], s24 offen offset:1024 sc1
  ds_read_b64 v[40:41], v189 offset:32768
  ds_read_b64 v[42:43], v189 offset:35328
  ds_read_b64 v[44:45], v189 offset:37888
  ds_read_b64 v[46:47], v189 offset:40448
  ds_read_b128 v[48:51], v187 offset:30720
  ds_read_b128 v[52:55], v187 offset:33280
  ds_read_b128 v[56:59], v187 offset:35840
  ds_read_b128 v[60:63], v187 offset:38400
  ds_read_b128 v[64:67], v187 offset:31744
  ds_read_b128 v[68:71], v187 offset:34304
  ds_read_b128 v[72:75], v187 offset:36864
  ds_read_b128 v[76:79], v187 offset:39424
  s_waitcnt lgkmcnt(8)
  v_pk_add_f32 v[40:41], v[40:41], v[42:43]
  v_pk_add_f32 v[44:45], v[44:45], v[46:47]
  v_pk_add_f32 v[40:41], v[40:41], v[44:45]
  v_rcp_f32 v42, v41
  s_waitcnt lgkmcnt(4)
  v_pk_add_f32 v[48:49], v[48:49], v[52:53]
  v_pk_add_f32 v[56:57], v[56:57], v[60:61]
  v_pk_add_f32 v[48:49], v[48:49], v[56:57]
  v_pk_add_f32 v[50:51], v[50:51], v[54:55]
  v_pk_add_f32 v[58:59], v[58:59], v[62:63]
  v_pk_add_f32 v[50:51], v[50:51], v[58:59]
  v_pk_mul_f32 v[48:49], v[48:49], v[42:43] op_sel_hi:[1,0]
  v_pk_mul_f32 v[50:51], v[50:51], v[42:43] op_sel_hi:[1,0]
  v_cvt_pk_bf16_f32 v234, v48, v49
  v_cvt_pk_bf16_f32 v235, v50, v51
  s_waitcnt lgkmcnt(0)
  v_pk_add_f32 v[64:65], v[64:65], v[68:69]
  v_pk_add_f32 v[72:73], v[72:73], v[76:77]
  v_pk_add_f32 v[64:65], v[64:65], v[72:73]
  v_pk_add_f32 v[66:67], v[66:67], v[70:71]
  v_pk_add_f32 v[74:75], v[74:75], v[78:79]
  v_pk_add_f32 v[66:67], v[66:67], v[74:75]
  v_pk_mul_f32 v[64:65], v[64:65], v[42:43] op_sel_hi:[1,0]
  v_pk_mul_f32 v[66:67], v[66:67], v[42:43] op_sel_hi:[1,0]
  v_cvt_pk_bf16_f32 v236, v64, v65
  v_cvt_pk_bf16_f32 v237, v66, v67
  v_max3_u32 v243, v243, v41, v42
  v_mul_f32 v40, v40, v42
  v_cvt_pk_bf16_f32 v240, v242, v40
  s_add_u32 s24, s27, 446464
  buffer_load_dwordx4 v[96:99], v187, s[8:11], s24 offen sc1
  buffer_load_dwordx4 v[100:103], v187, s[8:11], s24 offen offset:1024 sc1
  v_smfmac_f32_16x16x64_bf16 v[198:201], v[234:237], v[112:119], v185
  s_add_u32 s24, s27, 448512
  buffer_load_dwordx4 v[104:107], v187, s[8:11], s24 offen sc1
  buffer_load_dwordx4 v[108:111], v187, s[8:11], s24 offen offset:1024 sc1
  v_smfmac_f32_16x16x64_bf16 v[202:205], v[234:237], v[120:127], v185
  s_add_u32 s24, s27, 450560
  buffer_load_dwordx4 v[0:3], v187, s[8:11], s24 offen sc1
  buffer_load_dwordx4 v[4:7], v187, s[8:11], s24 offen offset:1024 sc1
  v_smfmac_f32_16x16x64_bf16 v[206:209], v[234:237], v[128:135], v185
  s_add_u32 s24, s27, 452608
  buffer_load_dwordx4 v[8:11], v187, s[8:11], s24 offen sc1
  buffer_load_dwordx4 v[12:15], v187, s[8:11], s24 offen offset:1024 sc1
  s_waitcnt vmcnt(22)
  v_smfmac_f32_16x16x64_bf16 v[210:213], v[234:237], v[136:143], v185
  s_add_u32 s24, s27, 454656
  buffer_load_dwordx4 v[16:19], v187, s[8:11], s24 offen sc1
  buffer_load_dwordx4 v[20:23], v187, s[8:11], s24 offen offset:1024 sc1
  s_waitcnt vmcnt(22)
  v_smfmac_f32_16x16x64_bf16 v[214:217], v[234:237], v[144:151], v185
  s_add_u32 s24, s27, 456704
  buffer_load_dwordx4 v[24:27], v187, s[8:11], s24 offen sc1
  buffer_load_dwordx4 v[28:31], v187, s[8:11], s24 offen offset:1024 sc1
  s_waitcnt vmcnt(22)
  v_smfmac_f32_16x16x64_bf16 v[218:221], v[234:237], v[152:159], v185
  s_add_u32 s24, s27, 458752
  buffer_load_dwordx4 v[32:35], v187, s[8:11], s24 offen sc1
  buffer_load_dwordx4 v[36:39], v187, s[8:11], s24 offen offset:1024 sc1
  s_waitcnt vmcnt(22)
  v_smfmac_f32_16x16x64_bf16 v[222:225], v[234:237], v[160:167], v185
  s_waitcnt vmcnt(20)
  v_smfmac_f32_16x16x64_bf16 v[226:229], v[234:237], v[168:175], v185
  s_waitcnt vmcnt(18)
  v_smfmac_f32_16x16x64_bf16 v[230:233], v[234:237], v[176:183], v185
  s_add_u32 s24, s27, 516096
  buffer_load_dwordx4 v[112:115], v187, s[8:11], s24 offen sc1
  buffer_load_dwordx4 v[116:119], v187, s[8:11], s24 offen offset:1024 sc1
  s_add_u32 s24, s27, 518144
  buffer_load_dwordx4 v[120:123], v187, s[8:11], s24 offen sc1
  buffer_load_dwordx4 v[124:127], v187, s[8:11], s24 offen offset:1024 sc1
  s_add_u32 s24, s27, 520192
  buffer_load_dwordx4 v[128:131], v187, s[8:11], s24 offen sc1
  buffer_load_dwordx4 v[132:135], v187, s[8:11], s24 offen offset:1024 sc1
  s_add_u32 s24, s27, 522240
  buffer_load_dwordx4 v[136:139], v187, s[8:11], s24 offen sc1
  buffer_load_dwordx4 v[140:143], v187, s[8:11], s24 offen offset:1024 sc1
  s_waitcnt lgkmcnt(0)
  s_barrier
  s_add_u32 s24, s27, 524288
  buffer_load_dwordx4 v[144:147], v187, s[8:11], s24 offen sc1
  buffer_load_dwordx4 v[148:151], v187, s[8:11], s24 offen offset:1024 sc1
  s_add_u32 s24, s27, 526336
  buffer_load_dwordx4 v[152:155], v187, s[8:11], s24 offen sc1
  buffer_load_dwordx4 v[156:159], v187, s[8:11], s24 offen offset:1024 sc1
  s_add_u32 s24, s27, 528384
  buffer_load_dwordx4 v[160:163], v187, s[8:11], s24 offen sc1
  buffer_load_dwordx4 v[164:167], v187, s[8:11], s24 offen offset:1024 sc1
  ds_read_b64 v[40:41], v189 offset:22528
  ds_read_b64 v[42:43], v189 offset:25088
  ds_read_b64 v[44:45], v189 offset:27648
  ds_read_b64 v[46:47], v189 offset:30208
  ds_read_b128 v[48:51], v187 offset:20480
  ds_read_b128 v[52:55], v187 offset:23040
  ds_read_b128 v[56:59], v187 offset:25600
  ds_read_b128 v[60:63], v187 offset:28160
  ds_read_b128 v[64:67], v187 offset:21504
  ds_read_b128 v[68:71], v187 offset:24064
  ds_read_b128 v[72:75], v187 offset:26624
  ds_read_b128 v[76:79], v187 offset:29184
  s_waitcnt lgkmcnt(8)
  v_pk_add_f32 v[40:41], v[40:41], v[42:43]
  v_pk_add_f32 v[44:45], v[44:45], v[46:47]
  v_pk_add_f32 v[40:41], v[40:41], v[44:45]
  v_rcp_f32 v42, v41
  s_waitcnt lgkmcnt(4)
  v_pk_add_f32 v[48:49], v[48:49], v[52:53]
  v_pk_add_f32 v[56:57], v[56:57], v[60:61]
  v_pk_add_f32 v[48:49], v[48:49], v[56:57]
  v_pk_add_f32 v[50:51], v[50:51], v[54:55]
  v_pk_add_f32 v[58:59], v[58:59], v[62:63]
  v_pk_add_f32 v[50:51], v[50:51], v[58:59]
  v_pk_mul_f32 v[48:49], v[48:49], v[42:43] op_sel_hi:[1,0]
  v_pk_mul_f32 v[50:51], v[50:51], v[42:43] op_sel_hi:[1,0]
  v_cvt_pk_bf16_f32 v234, v48, v49
  v_cvt_pk_bf16_f32 v235, v50, v51
  s_waitcnt lgkmcnt(0)
  v_pk_add_f32 v[64:65], v[64:65], v[68:69]
  v_pk_add_f32 v[72:73], v[72:73], v[76:77]
  v_pk_add_f32 v[64:65], v[64:65], v[72:73]
  v_pk_add_f32 v[66:67], v[66:67], v[70:71]
  v_pk_add_f32 v[74:75], v[74:75], v[78:79]
  v_pk_add_f32 v[66:67], v[66:67], v[74:75]
  v_pk_mul_f32 v[64:65], v[64:65], v[42:43] op_sel_hi:[1,0]
  v_pk_mul_f32 v[66:67], v[66:67], v[42:43] op_sel_hi:[1,0]
  v_cvt_pk_bf16_f32 v236, v64, v65
  v_cvt_pk_bf16_f32 v237, v66, v67
  v_max3_u32 v243, v243, v41, v42
  v_mul_f32 v242, v40, v42
  v_add_u32 v254, s72, v187
  v_add_u32 v254, 114816, v254
  s_add_u32 s24, s27, 530432
  buffer_load_dwordx4 v[168:171], v187, s[8:11], s24 offen sc1
  buffer_load_dwordx4 v[172:175], v187, s[8:11], s24 offen offset:1024 sc1
  s_add_u32 s24, s27, 532480
  buffer_load_dwordx4 v[176:179], v187, s[8:11], s24 offen sc1
  buffer_load_dwordx4 v[180:183], v187, s[8:11], s24 offen offset:1024 sc1
  s_waitcnt vmcnt(34)
  v_smfmac_f32_16x16x64_bf16 v[198:201], v[234:237], v[80:87], v185
  s_add_u32 s24, s27, 589824
  buffer_load_dwordx4 v[80:83], v187, s[8:11], s24 offen sc1
  buffer_load_dwordx4 v[84:87], v187, s[8:11], s24 offen offset:1024 sc1
  s_waitcnt vmcnt(34)
  v_smfmac_f32_16x16x64_bf16 v[202:205], v[234:237], v[88:95], v185
  s_add_u32 s24, s27, 591872
  buffer_load_dwordx4 v[88:91], v187, s[8:11], s24 offen sc1
  buffer_load_dwordx4 v[92:95], v187, s[8:11], s24 offen offset:1024 sc1
  s_waitcnt vmcnt(34)
  v_smfmac_f32_16x16x64_bf16 v[206:209], v[234:237], v[96:103], v185
  s_add_u32 s24, s27, 593920
  buffer_load_dwordx4 v[96:99], v187, s[8:11], s24 offen sc1
  buffer_load_dwordx4 v[100:103], v187, s[8:11], s24 offen offset:1024 sc1
  s_waitcnt vmcnt(34)
  v_smfmac_f32_16x16x64_bf16 v[210:213], v[234:237], v[104:111], v185
  s_add_u32 s24, s27, 595968
  buffer_load_dwordx4 v[104:107], v187, s[8:11], s24 offen sc1
  buffer_load_dwordx4 v[108:111], v187, s[8:11], s24 offen offset:1024 sc1
  s_waitcnt vmcnt(34)
  v_smfmac_f32_16x16x64_bf16 v[214:217], v[234:237], v[0:7], v185
  s_add_u32 s24, s27, 598016
  buffer_load_dwordx4 v[0:3], v187, s[8:11], s24 offen sc1
  buffer_load_dwordx4 v[4:7], v187, s[8:11], s24 offen offset:1024 sc1
  s_waitcnt vmcnt(34)
  v_smfmac_f32_16x16x64_bf16 v[218:221], v[234:237], v[8:15], v185
  s_add_u32 s24, s27, 600064
  buffer_load_dwordx4 v[8:11], v187, s[8:11], s24 offen sc1
  buffer_load_dwordx4 v[12:15], v187, s[8:11], s24 offen offset:1024 sc1
  s_waitcnt vmcnt(34)
  v_smfmac_f32_16x16x64_bf16 v[222:225], v[234:237], v[16:23], v185
  s_add_u32 s24, s27, 602112
  buffer_load_dwordx4 v[16:19], v187, s[8:11], s24 offen sc1
  buffer_load_dwordx4 v[20:23], v187, s[8:11], s24 offen offset:1024 sc1
  s_waitcnt vmcnt(34)
  v_smfmac_f32_16x16x64_bf16 v[226:229], v[234:237], v[24:31], v185
  s_add_u32 s24, s27, 604160
  buffer_load_dwordx4 v[24:27], v187, s[8:11], s24 offen sc1
  buffer_load_dwordx4 v[28:31], v187, s[8:11], s24 offen offset:1024 sc1
  s_waitcnt vmcnt(34)
  v_smfmac_f32_16x16x64_bf16 v[230:233], v[234:237], v[32:39], v185
  s_add_u32 s24, s27, 606208
  buffer_load_dwordx4 v[32:35], v187, s[8:11], s24 offen sc1
  buffer_load_dwordx4 v[36:39], v187, s[8:11], s24 offen offset:1024 sc1
  s_waitcnt lgkmcnt(4)
  v_add_u32 v254, 161920, v247
  ds_read_u16 v184, v254 offset:0
  ds_read_u16 v186, v254 offset:32
  ds_read_u16 v188, v254 offset:64
  ds_read_u16 v190, v254 offset:96
  ds_read_u16 v191, v254 offset:128
  ds_read_u16 v192, v254 offset:160
  ds_read_u16 v193, v254 offset:192
  ds_read_u16 v194, v254 offset:224
  ds_read_u16 v195, v254 offset:256
  v_lshrrev_b32 v252, 7, v187
  v_lshl_add_u32 v252, v252, 4, s39
  v_lshrrev_b32 v253, 8, v187
  v_bfe_u32 v251, v187, 5, 2
  v_lshl_add_u32 v253, v253, 2, v251
  v_mul_u32_u24 v253, 1184, v253
  v_and_or_b32 v253, v252, 16, v253
  v_and_b32 v251, 8, v189
  v_add3_u32 v253, v253, v251, s25
  s_waitcnt lgkmcnt(0)
  s_barrier
  ds_read_b64 v[40:41], v189 offset:32768
  ds_read_b64 v[42:43], v189 offset:35328
  ds_read_b64 v[44:45], v189 offset:37888
  ds_read_b64 v[46:47], v189 offset:40448
  ds_read_b128 v[48:51], v187 offset:30720
  ds_read_b128 v[52:55], v187 offset:33280
  ds_read_b128 v[56:59], v187 offset:35840
  ds_read_b128 v[60:63], v187 offset:38400
  ds_read_b128 v[64:67], v187 offset:31744
  ds_read_b128 v[68:71], v187 offset:34304
  ds_read_b128 v[72:75], v187 offset:36864
  ds_read_b128 v[76:79], v187 offset:39424
  v_lshlrev_b32 v184, 16, v184
  v_lshlrev_b32 v186, 16, v186
  v_lshlrev_b32 v188, 16, v188
  v_lshlrev_b32 v190, 16, v190
  v_lshlrev_b32 v191, 16, v191
  v_lshlrev_b32 v192, 16, v192
  v_lshlrev_b32 v193, 16, v193
  v_lshlrev_b32 v194, 16, v194
  v_lshlrev_b32 v195, 16, v195
  s_waitcnt lgkmcnt(8)
  v_pk_add_f32 v[40:41], v[40:41], v[42:43]
  v_pk_add_f32 v[44:45], v[44:45], v[46:47]
  v_pk_add_f32 v[40:41], v[40:41], v[44:45]
  v_rcp_f32 v42, v41
  s_waitcnt lgkmcnt(4)
  v_pk_add_f32 v[48:49], v[48:49], v[52:53]
  v_pk_add_f32 v[56:57], v[56:57], v[60:61]
  v_pk_add_f32 v[48:49], v[48:49], v[56:57]
  v_pk_add_f32 v[50:51], v[50:51], v[54:55]
  v_pk_add_f32 v[58:59], v[58:59], v[62:63]
  v_pk_add_f32 v[50:51], v[50:51], v[58:59]
  v_pk_mul_f32 v[48:49], v[48:49], v[42:43] op_sel_hi:[1,0]
  v_pk_mul_f32 v[50:51], v[50:51], v[42:43] op_sel_hi:[1,0]
  v_cvt_pk_bf16_f32 v234, v48, v49
  v_cvt_pk_bf16_f32 v235, v50, v51
  s_waitcnt lgkmcnt(0)
  v_pk_add_f32 v[64:65], v[64:65], v[68:69]
  v_pk_add_f32 v[72:73], v[72:73], v[76:77]
  v_pk_add_f32 v[64:65], v[64:65], v[72:73]
  v_pk_add_f32 v[66:67], v[66:67], v[70:71]
  v_pk_add_f32 v[74:75], v[74:75], v[78:79]
  v_pk_add_f32 v[66:67], v[66:67], v[74:75]
  v_pk_mul_f32 v[64:65], v[64:65], v[42:43] op_sel_hi:[1,0]
  v_pk_mul_f32 v[66:67], v[66:67], v[42:43] op_sel_hi:[1,0]
  v_cvt_pk_bf16_f32 v236, v64, v65
  v_cvt_pk_bf16_f32 v237, v66, v67
  v_max3_u32 v243, v243, v41, v42
  v_mul_f32 v40, v40, v42
  v_cvt_pk_bf16_f32 v241, v242, v40
  v_cmp_lt_u32 vcc, 0x5d800000, v243
K2_OP7:
  s_waitcnt vmcnt(34)
  v_smfmac_f32_16x16x64_bf16 v[198:201], v[234:237], v[112:119], v185
  s_waitcnt vmcnt(32)
  v_smfmac_f32_16x16x64_bf16 v[202:205], v[234:237], v[120:127], v185
  s_waitcnt vmcnt(30)
  v_smfmac_f32_16x16x64_bf16 v[206:209], v[234:237], v[128:135], v185
  s_waitcnt vmcnt(28)
  v_smfmac_f32_16x16x64_bf16 v[210:213], v[234:237], v[136:143], v185
  s_cbranch_vccnz K2_SAFE
  s_waitcnt vmcnt(16)
  v_smfmac_f32_16x16x64_bf16 v[198:201], v[238:241], v[80:87], v185
  v_smfmac_f32_16x16x64_bf16 v[214:217], v[234:237], v[144:151], v185
  s_waitcnt vmcnt(14)
  v_smfmac_f32_16x16x64_bf16 v[202:205], v[238:241], v[88:95], v185
  v_smfmac_f32_16x16x64_bf16 v[218:221], v[234:237], v[152:159], v185
  s_waitcnt vmcnt(12)
  v_smfmac_f32_16x16x64_bf16 v[206:209], v[238:241], v[96:103], v185
  v_smfmac_f32_16x16x64_bf16 v[222:225], v[234:237], v[160:167], v185
  s_waitcnt vmcnt(10)
  v_smfmac_f32_16x16x64_bf16 v[210:213], v[238:241], v[104:111], v185
  v_smfmac_f32_16x16x64_bf16 v[226:229], v[234:237], v[168:175], v185
  s_waitcnt vmcnt(8)
  v_smfmac_f32_16x16x64_bf16 v[214:217], v[238:241], v[0:7], v185
  v_smfmac_f32_16x16x64_bf16 v[230:233], v[234:237], v[176:183], v185
  v_pk_add_f32 v[198:199], v[198:199], v[200:201]
  v_pk_mul_f32 v[42:43], v[198:199], v[198:199]
  v_pk_mul_f32 v[44:45], v[198:199], v[184:185] op_sel_hi:[1,0]
  s_waitcnt vmcnt(6)
  v_smfmac_f32_16x16x64_bf16 v[218:221], v[238:241], v[8:15], v185
  v_pk_add_f32 v[202:203], v[202:203], v[204:205]
  v_pk_add_f32 v[40:41], v[198:199], v[202:203]
  v_pk_fma_f32 v[42:43], v[202:203], v[202:203], v[42:43]
  v_pk_fma_f32 v[44:45], v[202:203], v[186:187], v[44:45] op_sel:[0,0,0] op_sel_hi:[1,0,1]
  s_waitcnt vmcnt(4)
  v_smfmac_f32_16x16x64_bf16 v[222:225], v[238:241], v[16:23], v185
  v_pk_add_f32 v[206:207], v[206:207], v[208:209]
  v_pk_add_f32 v[40:41], v[40:41], v[206:207]
  v_pk_fma_f32 v[42:43], v[206:207], v[206:207], v[42:43]
  v_pk_fma_f32 v[44:45], v[206:207], v[188:189], v[44:45] op_sel:[0,0,0] op_sel_hi:[1,0,1]
  s_waitcnt vmcnt(2)
  v_smfmac_f32_16x16x64_bf16 v[226:229], v[238:241], v[24:31], v185
  v_pk_add_f32 v[210:211], v[210:211], v[212:213]
  v_pk_add_f32 v[40:41], v[40:41], v[210:211]
  v_pk_fma_f32 v[42:43], v[210:211], v[210:211], v[42:43]
  v_pk_fma_f32 v[44:45], v[210:211], v[190:191], v[44:45] op_sel:[0,0,0] op_sel_hi:[1,0,1]
  s_waitcnt vmcnt(0)
  v_smfmac_f32_16x16x64_bf16 v[230:233], v[238:241], v[32:39], v185
  v_pk_add_f32 v[214:215], v[214:215], v[216:217]
  v_pk_add_f32 v[40:41], v[40:41], v[214:215]
  v_pk_fma_f32 v[42:43], v[214:215], v[214:215], v[42:43]
  v_pk_fma_f32 v[44:45], v[214:215], v[190:191], v[44:45] op_sel:[0,1,0] op_sel_hi:[1,1,1]
  v_pk_add_f32 v[218:219], v[218:219], v[220:221]
  v_pk_add_f32 v[40:41], v[40:41], v[218:219]
  v_pk_fma_f32 v[42:43], v[218:219], v[218:219], v[42:43]
  v_pk_fma_f32 v[44:45], v[218:219], v[192:193], v[44:45] op_sel:[0,0,0] op_sel_hi:[1,0,1]
  v_pk_add_f32 v[222:223], v[222:223], v[224:225]
  v_pk_add_f32 v[40:41], v[40:41], v[222:223]
  v_pk_fma_f32 v[42:43], v[222:223], v[222:223], v[42:43]
  v_pk_fma_f32 v[44:45], v[222:223], v[192:193], v[44:45] op_sel:[0,1,0] op_sel_hi:[1,1,1]
  v_pk_add_f32 v[226:227], v[226:227], v[228:229]
  v_pk_add_f32 v[40:41], v[40:41], v[226:227]
  v_pk_fma_f32 v[42:43], v[226:227], v[226:227], v[42:43]
  v_pk_fma_f32 v[44:45], v[226:227], v[194:195], v[44:45] op_sel:[0,0,0] op_sel_hi:[1,0,1]
  v_pk_add_f32 v[230:231], v[230:231], v[232:233]
  v_pk_add_f32 v[40:41], v[40:41], v[230:231]
  v_pk_fma_f32 v[42:43], v[230:231], v[230:231], v[42:43]
  v_pk_fma_f32 v[44:45], v[230:231], v[194:195], v[44:45] op_sel:[0,1,0] op_sel_hi:[1,1,1]
  v_add_f32_dpp v248, v40, v40 row_ror:8 row_mask:0xf bank_mask:0x3
  v_add_f32_dpp v249, v42, v42 row_ror:8 row_mask:0xf bank_mask:0x3
  v_add_f32_dpp v250, v44, v44 row_ror:8 row_mask:0xf bank_mask:0x3
  v_add_f32_dpp v248, v41, v41 row_ror:8 row_mask:0xf bank_mask:0xc
  v_add_f32_dpp v249, v43, v43 row_ror:8 row_mask:0xf bank_mask:0xc
  v_add_f32_dpp v250, v45, v45 row_ror:8 row_mask:0xf bank_mask:0xc
  v_add_f32_dpp v248, v248, v248 row_half_mirror row_mask:0xf bank_mask:0xf
  v_add_f32_dpp v249, v249, v249 row_half_mirror row_mask:0xf bank_mask:0xf
  v_add_f32_dpp v250, v250, v250 row_half_mirror row_mask:0xf bank_mask:0xf
  v_add_f32_dpp v248, v248, v248 quad_perm:[2,3,0,1] row_mask:0xf bank_mask:0xf
  v_add_f32_dpp v249, v249, v249 quad_perm:[2,3,0,1] row_mask:0xf bank_mask:0xf
  v_add_f32_dpp v250, v250, v250 quad_perm:[2,3,0,1] row_mask:0xf bank_mask:0xf
  v_add_f32_dpp v248, v248, v248 quad_perm:[1,0,3,2] row_mask:0xf bank_mask:0xf
  v_add_f32_dpp v249, v249, v249 quad_perm:[1,0,3,2] row_mask:0xf bank_mask:0xf
  v_add_f32_dpp v250, v250, v250 quad_perm:[1,0,3,2] row_mask:0xf bank_mask:0xf
  s_mov_b32 exec_lo, 0x01010101
  s_mov_b32 exec_hi, 0x01010101
  ds_write_b128 v252, v[248:251]
  s_mov_b64 exec, -1
  s_waitcnt lgkmcnt(0)
  s_barrier
  s_setprio 0
  ds_write_b64 v253, v[198:199] offset:0
  ds_write_b64 v253, v[202:203] offset:32
  ds_write_b64 v253, v[206:207] offset:64
  ds_write_b64 v253, v[210:211] offset:96
  ds_write_b64 v253, v[214:215] offset:128
  ds_write_b64 v253, v[218:219] offset:160
  ds_write_b64 v253, v[222:223] offset:192
  ds_write_b64 v253, v[226:227] offset:224
  ds_write_b64 v253, v[230:231] offset:256
  v_lshrrev_b32 v0, 4, v187
  s_cmp_ge_u32 s2, 144
  s_waitcnt lgkmcnt(0)
  s_barrier
  s_cbranch_scc1 K2_END
  s_setprio 2
  v_lshrrev_b32 v1, 4, v0
  v_bfe_u32 v3, v0, 1, 1
  v_and_b32 v7, 7, v0
  v_lshrrev_b32 v2, 3, v0
  v_bfe_i32 v51, v0, 2, 1
  v_bfe_i32 v52, v0, 1, 1
  v_bfe_i32 v53, v0, 0, 1
  v_xor_b32 v52, v52, v51
  v_xor_b32 v53, v53, v51
  v_not_b32 v48, v51
  v_not_b32 v49, v52
  v_not_b32 v50, v53
  v_bfe_i32 v5, v0, 3, 1
  v_xor_b32 v54, v5, v48
  v_xor_b32 v55, v5, v49
  v_xor_b32 v56, v5, v50
  v_bfe_i32 v5, v0, 4, 1
  v_xor_b32 v57, v5, v48
  v_xor_b32 v58, v5, v49
  v_xor_b32 v59, v5, v50
  v_bfe_i32 v5, v0, 5, 1
  v_xor_b32 v60, v5, v48
  v_xor_b32 v61, v5, v49
  v_xor_b32 v62, v5, v50
  v_lshlrev_b32 v69, 2, v0
  v_and_b32 v87, 0x7c, v69
  v_xor_b32 v63, s50, v48
  v_xor_b32 v64, s50, v49
  v_xor_b32 v65, s50, v50
  v_and_b32 v5, 12, v51
  v_xor_b32 v66, v5, v69
  v_xor_b32 v67, 28, v66
  v_lshlrev_b32 v78, 2, v7
  v_add_u32 v68, s49, v78
  v_lshlrev_b32 v70, 4, v0
  v_lshlrev_b32 v71, 5, v1
  v_lshl_add_u32 v71, v3, 4, v71
  v_add_u32 v72, s68, v70
  s_mov_b32 s70, 0
  v_mov_b32 v24, 163072
K2_WK:
  ds_read_b32 v25, v24
  s_waitcnt lgkmcnt(0)
  v_cmp_gt_u32 vcc, 9, v25
  s_cbranch_vccnz K2_WK
K2_POLL:
  buffer_load_dword v96, v66, s[8:11], s69 offen offset:0 sc1
  buffer_load_dword v97, v67, s[8:11], s69 offen offset:256 sc1
  buffer_load_dword v98, v66, s[8:11], s69 offen offset:512 sc1
  buffer_load_dword v99, v67, s[8:11], s69 offen offset:768 sc1
  buffer_load_dword v100, v66, s[8:11], s69 offen offset:1024 sc1
  buffer_load_dword v101, v67, s[8:11], s69 offen offset:1280 sc1
  buffer_load_dword v102, v66, s[8:11], s69 offen offset:1536 sc1
  buffer_load_dword v103, v67, s[8:11], s69 offen offset:1792 sc1
  s_add_u32 s70, s70, 1
  s_waitcnt vmcnt(0)
  v_min3_u32 v24, v96, v97, v98
  v_min3_u32 v25, v99, v100, v101
  v_min3_u32 v24, v24, v102, v103
  v_max_u32 v16, v96, v97
  v_max_u32 v18, v98, v99
  v_max_u32 v20, v100, v101
  v_max_u32 v22, v102, v103
  v_min_u32 v24, v24, v25
  v_cmp_eq_u32 vcc, 0, v24
  s_cmp_lt_u32 s70, 262144
  s_cselect_b64 vcc, vcc, 0
  s_cbranch_vccnz K2_POLL
K2_GOT:
  v_mov_b32_dpp v17, v16 row_half_mirror row_mask:0xf bank_mask:0xf bound_ctrl:1
  v_mov_b32_dpp v19, v18 row_half_mirror row_mask:0xf bank_mask:0xf bound_ctrl:1
  v_mov_b32_dpp v21, v20 row_half_mirror row_mask:0xf bank_mask:0xf bound_ctrl:1
  v_mov_b32_dpp v23, v22 row_half_mirror row_mask:0xf bank_mask:0xf bound_ctrl:1
  v_med3_u32 v16, v16, v17, v48
  v_med3_u32 v18, v18, v19, v51
  v_med3_u32 v20, v20, v21, v48
  v_med3_u32 v22, v22, v23, v51
  v_mov_b32_dpp v17, v16 quad_perm:[2,3,0,1] row_mask:0xf bank_mask:0xf bound_ctrl:1
  v_mov_b32_dpp v19, v18 quad_perm:[2,3,0,1] row_mask:0xf bank_mask:0xf bound_ctrl:1
  v_mov_b32_dpp v21, v20 quad_perm:[2,3,0,1] row_mask:0xf bank_mask:0xf bound_ctrl:1
  v_mov_b32_dpp v23, v22 quad_perm:[2,3,0,1] row_mask:0xf bank_mask:0xf bound_ctrl:1
  v_med3_u32 v16, v16, v17, v49
  v_med3_u32 v18, v18, v19, v52
  v_med3_u32 v20, v20, v21, v49
  v_med3_u32 v22, v22, v23, v52
  v_mov_b32_dpp v17, v16 quad_perm:[1,0,3,2] row_mask:0xf bank_mask:0xf bound_ctrl:1
  v_mov_b32_dpp v19, v18 quad_perm:[1,0,3,2] row_mask:0xf bank_mask:0xf bound_ctrl:1
  v_mov_b32_dpp v21, v20 quad_perm:[1,0,3,2] row_mask:0xf bank_mask:0xf bound_ctrl:1
  v_mov_b32_dpp v23, v22 quad_perm:[1,0,3,2] row_mask:0xf bank_mask:0xf bound_ctrl:1
  v_med3_u32 v16, v16, v17, v50
  v_med3_u32 v18, v18, v19, v53
  v_med3_u32 v20, v20, v21, v50
  v_med3_u32 v22, v22, v23, v53
  v_max_u32 v16, v16, v18
  v_max_u32 v18, v20, v22
  s_nop 0
  v_mov_b32_dpp v17, v16 row_half_mirror row_mask:0xf bank_mask:0xf bound_ctrl:1
  v_mov_b32_dpp v19, v18 row_half_mirror row_mask:0xf bank_mask:0xf bound_ctrl:1
  v_med3_u32 v16, v16, v17, v48
  v_med3_u32 v18, v18, v19, v51
  s_nop 0
  v_mov_b32_dpp v17, v16 quad_perm:[2,3,0,1] row_mask:0xf bank_mask:0xf bound_ctrl:1
  v_mov_b32_dpp v19, v18 quad_perm:[2,3,0,1] row_mask:0xf bank_mask:0xf bound_ctrl:1
  v_med3_u32 v16, v16, v17, v49
  v_med3_u32 v18, v18, v19, v52
  s_nop 0
  v_mov_b32_dpp v17, v16 quad_perm:[1,0,3,2] row_mask:0xf bank_mask:0xf bound_ctrl:1
  v_mov_b32_dpp v19, v18 quad_perm:[1,0,3,2] row_mask:0xf bank_mask:0xf bound_ctrl:1
  v_med3_u32 v16, v16, v17, v50
  v_med3_u32 v18, v18, v19, v53
  v_max_u32 v16, v16, v18
  s_nop 1
  v_mov_b32_dpp v17, v16 row_half_mirror row_mask:0xf bank_mask:0xf bound_ctrl:1
  v_med3_u32 v16, v16, v17, v54
  s_nop 1
  v_mov_b32_dpp v17, v16 quad_perm:[2,3,0,1] row_mask:0xf bank_mask:0xf bound_ctrl:1
  v_med3_u32 v16, v16, v17, v55
  s_nop 1
  v_mov_b32_dpp v17, v16 quad_perm:[1,0,3,2] row_mask:0xf bank_mask:0xf bound_ctrl:1
  v_med3_u32 v16, v16, v17, v56
  s_nop 1
  v_max_u32_dpp v16, v16, v16 row_ror:8 row_mask:0xf bank_mask:0xf bound_ctrl:1
  s_nop 1
  v_mov_b32_dpp v17, v16 row_half_mirror row_mask:0xf bank_mask:0xf bound_ctrl:1
  v_med3_u32 v16, v16, v17, v57
  s_nop 1
  v_mov_b32_dpp v17, v16 quad_perm:[2,3,0,1] row_mask:0xf bank_mask:0xf bound_ctrl:1
  v_med3_u32 v16, v16, v17, v58
  s_nop 1
  v_mov_b32_dpp v17, v16 quad_perm:[1,0,3,2] row_mask:0xf bank_mask:0xf bound_ctrl:1
  v_med3_u32 v16, v16, v17, v59
  v_mov_b32 v17, v16
  s_nop 1
  v_permlane16_swap_b32 v16, v17
  v_max_u32 v16, v16, v17
  s_nop 1
  v_mov_b32_dpp v17, v16 row_half_mirror row_mask:0xf bank_mask:0xf bound_ctrl:1
  v_med3_u32 v16, v16, v17, v60
  s_nop 1
  v_mov_b32_dpp v17, v16 quad_perm:[2,3,0,1] row_mask:0xf bank_mask:0xf bound_ctrl:1
  v_med3_u32 v16, v16, v17, v61
  s_nop 1
  v_mov_b32_dpp v17, v16 quad_perm:[1,0,3,2] row_mask:0xf bank_mask:0xf bound_ctrl:1
  v_med3_u32 v16, v16, v17, v62
  v_mov_b32 v17, v16
  s_nop 1
  v_permlane32_swap_b32 v16, v17
  v_max_u32 v16, v16, v17
  s_nop 1
  v_mov_b32_dpp v17, v16 row_half_mirror row_mask:0xf bank_mask:0xf bound_ctrl:1
  v_med3_u32 v16, v16, v17, v63
  s_nop 1
  v_mov_b32_dpp v17, v16 quad_perm:[2,3,0,1] row_mask:0xf bank_mask:0xf bound_ctrl:1
  v_med3_u32 v16, v16, v17, v64
  s_nop 1
  v_mov_b32_dpp v17, v16 quad_perm:[1,0,3,2] row_mask:0xf bank_mask:0xf bound_ctrl:1
  v_med3_u32 v16, v16, v17, v65
  s_mov_b64 exec, 0xff
  ds_write_b32 v68, v16
  s_mov_b64 exec, -1
  s_branch K2_TOP
K2_SAFE:
  s_waitcnt vmcnt(0)
  s_nop 7
  v_lshrrev_b32 v0, 4, v187
  v_lshrrev_b32 v1, 5, v0
  v_and_b32 v2, 31, v0
  v_lshlrev_b32 v3, 5, v2
  v_lshl_add_u32 v96, v1, 4, v3
  v_lshlrev_b32 v4, 1, v2
  s_mov_b32 s26, 0xfffff9f8
  v_bfe_u32 v4, s26, v4, 2
  v_cmp_gt_u32 vcc, 16, v2
  v_add_u32 v4, 16, v4
  v_lshlrev_b32 v98, 2, v0
  v_cndmask_b32 v4, v4, v2, vcc
  v_lshlrev_b32 v4, 5, v4
  v_lshl_add_u32 v97, v1, 4, v4
  v_bfe_u32 v6, v0, 2, 2
  v_and_b32 v7, 1, v0
  v_lshl_add_u32 v6, v6, 1, v7
  v_mul_u32_u24 v6, 1152, v6
  v_bfe_u32 v7, v0, 4, 1
  v_bfe_u32 v8, v0, 1, 1
  v_lshl_add_u32 v7, v7, 1, v8
  v_mad_u32_u24 v100, v7, 36, v6
  v_lshrrev_b32 v7, 5, v0
  v_lshl_add_u32 v99, v7, 4, v100
  v_lshrrev_b32 v1, 4, v0
  v_mul_u32_u24 v1, 2304, v1
  v_add_u32 v1, v1, v247
  v_mov_b32 v198, 0
  v_mov_b32 v199, 0
  v_mov_b32 v200, 0
  v_mov_b32 v201, 0
  v_mov_b32 v202, 0
  v_mov_b32 v203, 0
  v_mov_b32 v204, 0
  v_mov_b32 v205, 0
  v_mov_b32 v206, 0
  v_mov_b32 v207, 0
  v_mov_b32 v208, 0
  v_mov_b32 v209, 0
  v_mov_b32 v210, 0
  v_mov_b32 v211, 0
  v_mov_b32 v212, 0
  v_mov_b32 v213, 0
  v_mov_b32 v214, 0
  v_mov_b32 v215, 0
  v_mov_b32 v216, 0
  v_mov_b32 v217, 0
  v_mov_b32 v218, 0
  v_mov_b32 v219, 0
  v_mov_b32 v220, 0
  v_mov_b32 v221, 0
  v_mov_b32 v222, 0
  v_mov_b32 v223, 0
  v_mov_b32 v224, 0
  v_mov_b32 v225, 0
  v_mov_b32 v226, 0
  v_mov_b32 v227, 0
  v_mov_b32 v228, 0
  v_mov_b32 v229, 0
  v_mov_b32 v230, 0
  v_mov_b32 v231, 0
  v_mov_b32 v232, 0
  v_mov_b32 v233, 0
  buffer_load_short_d16_hi v198, v1, s[12:15], s5 offen offset:0
  buffer_load_short_d16_hi v199, v1, s[12:15], s5 offen offset:1152
  buffer_load_short_d16_hi v202, v1, s[12:15], s5 offen offset:32
  buffer_load_short_d16_hi v203, v1, s[12:15], s5 offen offset:1184
  buffer_load_short_d16_hi v206, v1, s[12:15], s5 offen offset:64
  buffer_load_short_d16_hi v207, v1, s[12:15], s5 offen offset:1216
  buffer_load_short_d16_hi v210, v1, s[12:15], s5 offen offset:96
  buffer_load_short_d16_hi v211, v1, s[12:15], s5 offen offset:1248
  buffer_load_short_d16_hi v214, v1, s[12:15], s5 offen offset:128
  buffer_load_short_d16_hi v215, v1, s[12:15], s5 offen offset:1280
  buffer_load_short_d16_hi v218, v1, s[12:15], s5 offen offset:160
  buffer_load_short_d16_hi v219, v1, s[12:15], s5 offen offset:1312
  buffer_load_short_d16_hi v222, v1, s[12:15], s5 offen offset:192
  buffer_load_short_d16_hi v223, v1, s[12:15], s5 offen offset:1344
  buffer_load_short_d16_hi v226, v1, s[12:15], s5 offen offset:224
  buffer_load_short_d16_hi v227, v1, s[12:15], s5 offen offset:1376
  buffer_load_short_d16_hi v230, v1, s[12:15], s5 offen offset:256
  buffer_load_short_d16_hi v231, v1, s[12:15], s5 offen offset:1408
  v_mov_b32 v57, 0
  v_mov_b32 v63, 0
  s_mov_b32 s23, s5
  s_mov_b32 s26, s27
  s_mov_b32 s44, 0
K2_SG:
  buffer_load_dword v62, v100, s[8:11], s23 offen offset:32 sc1
  buffer_load_dwordx4 v[58:61], v99, s[8:11], s23 offen sc1
  v_mov_b32 v80, 0xff800000
  s_mov_b32 s20, 2359296
  s_mov_b32 s21, 2433024
  s_mov_b32 s22, 2424832
K2_S1:
  buffer_load_dword v56, v98, s[8:11], s22 offen sc1
  buffer_load_dwordx4 v[32:35], v96, s[8:11], s20 offen offset:0 sc1
  buffer_load_dwordx4 v[36:39], v96, s[8:11], s20 offen offset:1024 sc1
  s_add_u32 s20, s20, 2048
  s_add_u32 s21, s21, 2560
  s_add_u32 s22, s22, 256
  s_waitcnt vmcnt(0)
  v_mfma_f32_32x32x4_2b_bf16 v[0:31], v[56:57], v[62:63], 0
  s_nop 15
  s_nop 1
  v_mfma_f32_32x32x16_bf16 v[0:15], v[32:35], v[58:61], v[0:15]
  v_mfma_f32_32x32x16_bf16 v[16:31], v[36:39], v[58:61], v[16:31]
  s_nop 10
  v_max3_f32 v80, v80, v0, v1
  v_max3_f32 v80, v80, v2, v3
  v_max3_f32 v80, v80, v4, v5
  v_max3_f32 v80, v80, v6, v7
  v_max3_f32 v80, v80, v8, v9
  v_max3_f32 v80, v80, v10, v11
  v_max3_f32 v80, v80, v12, v13
  v_max3_f32 v80, v80, v14, v15
  v_max3_f32 v80, v80, v16, v17
  v_max3_f32 v80, v80, v18, v19
  v_max3_f32 v80, v80, v20, v21
  v_max3_f32 v80, v80, v22, v23
  v_max3_f32 v80, v80, v24, v25
  v_max3_f32 v80, v80, v26, v27
  v_max3_f32 v80, v80, v28, v29
  v_max3_f32 v80, v80, v30, v31
  s_cmp_lt_u32 s22, 2433024
  s_cbranch_scc1 K2_S1
  v_mov_b32 v81, v80
  s_nop 1
  v_permlane32_swap_b32 v80, v81
  v_max_f32 v80, v80, v81
  v_mov_b32 v64, 0
  v_mov_b32 v65, 0
  v_mov_b32 v66, 0
  v_mov_b32 v67, 0
  v_mov_b32 v68, 0
  v_mov_b32 v69, 0
  v_mov_b32 v70, 0
  v_mov_b32 v71, 0
  v_mov_b32 v72, 0
  v_mov_b32 v73, 0
  v_mov_b32 v74, 0
  v_mov_b32 v75, 0
  v_mov_b32 v76, 0
  v_mov_b32 v77, 0
  v_mov_b32 v78, 0
  v_mov_b32 v79, 0
  s_mov_b32 s20, 2359296
  s_mov_b32 s21, 2433024
  s_mov_b32 s22, 2424832
K2_S2:
  buffer_load_dword v56, v98, s[8:11], s22 offen sc1
  buffer_load_dwordx4 v[32:35], v96, s[8:11], s20 offen offset:0 sc1
  buffer_load_dwordx4 v[36:39], v96, s[8:11], s20 offen offset:1024 sc1
  buffer_load_dwordx4 v[40:43], v97, s[8:11], s21 offen offset:0 sc1
  buffer_load_dwordx4 v[44:47], v97, s[8:11], s21 offen offset:640 sc1
  buffer_load_dwordx4 v[48:51], v97, s[8:11], s21 offen offset:1280 sc1
  buffer_load_dwordx4 v[52:55], v97, s[8:11], s21 offen offset:1920 sc1
  s_add_u32 s20, s20, 2048
  s_add_u32 s21, s21, 2560
  s_add_u32 s22, s22, 256
  s_waitcnt vmcnt(0)
  v_mfma_f32_32x32x4_2b_bf16 v[0:31], v[56:57], v[62:63], 0
  s_nop 15
  s_nop 1
  v_mfma_f32_32x32x16_bf16 v[0:15], v[32:35], v[58:61], v[0:15]
  v_mfma_f32_32x32x16_bf16 v[16:31], v[36:39], v[58:61], v[16:31]
  s_nop 10
  v_sub_f32 v0, v0, v80
  v_sub_f32 v1, v1, v80
  v_sub_f32 v2, v2, v80
  v_sub_f32 v3, v3, v80
  v_sub_f32 v4, v4, v80
  v_sub_f32 v5, v5, v80
  v_sub_f32 v6, v6, v80
  v_sub_f32 v7, v7, v80
  v_sub_f32 v8, v8, v80
  v_sub_f32 v9, v9, v80
  v_sub_f32 v10, v10, v80
  v_sub_f32 v11, v11, v80
  v_sub_f32 v12, v12, v80
  v_sub_f32 v13, v13, v80
  v_sub_f32 v14, v14, v80
  v_sub_f32 v15, v15, v80
  v_sub_f32 v16, v16, v80
  v_sub_f32 v17, v17, v80
  v_sub_f32 v18, v18, v80
  v_sub_f32 v19, v19, v80
  v_sub_f32 v20, v20, v80
  v_sub_f32 v21, v21, v80
  v_sub_f32 v22, v22, v80
  v_sub_f32 v23, v23, v80
  v_sub_f32 v24, v24, v80
  v_sub_f32 v25, v25, v80
  v_sub_f32 v26, v26, v80
  v_sub_f32 v27, v27, v80
  v_sub_f32 v28, v28, v80
  v_sub_f32 v29, v29, v80
  v_sub_f32 v30, v30, v80
  v_sub_f32 v31, v31, v80
  v_exp_f32 v0, v0
  v_exp_f32 v1, v1
  v_exp_f32 v2, v2
  v_exp_f32 v3, v3
  v_exp_f32 v4, v4
  v_exp_f32 v5, v5
  v_exp_f32 v6, v6
  v_exp_f32 v7, v7
  v_exp_f32 v8, v8
  v_exp_f32 v9, v9
  v_exp_f32 v10, v10
  v_exp_f32 v11, v11
  v_exp_f32 v12, v12
  v_exp_f32 v13, v13
  v_exp_f32 v14, v14
  v_exp_f32 v15, v15
  v_exp_f32 v16, v16
  v_exp_f32 v17, v17
  v_exp_f32 v18, v18
  v_exp_f32 v19, v19
  v_exp_f32 v20, v20
  v_exp_f32 v21, v21
  v_exp_f32 v22, v22
  v_exp_f32 v23, v23
  v_exp_f32 v24, v24
  v_exp_f32 v25, v25
  v_exp_f32 v26, v26
  v_exp_f32 v27, v27
  v_exp_f32 v28, v28
  v_exp_f32 v29, v29
  v_exp_f32 v30, v30
  v_exp_f32 v31, v31
  v_smfmac_f32_32x32x32_bf16 v[64:79], v[40:43], v[0:7], v185 abid:1
  v_smfmac_f32_32x32x32_bf16 v[64:79], v[44:47], v[8:15], v185 abid:1
  v_smfmac_f32_32x32x32_bf16 v[64:79], v[48:51], v[16:23], v185 abid:1
  v_smfmac_f32_32x32x32_bf16 v[64:79], v[52:55], v[24:31], v185 abid:1
  s_cmp_lt_u32 s22, 2433024
  s_cbranch_scc1 K2_S2
  buffer_load_dwordx4 v[112:115], v187, s[8:11], s26 offen sc1
  buffer_load_dwordx4 v[116:119], v187, s[8:11], s26 offen offset:1024 sc1
  s_add_u32 s26, s26, 2048
  buffer_load_dwordx4 v[120:123], v187, s[8:11], s26 offen sc1
  buffer_load_dwordx4 v[124:127], v187, s[8:11], s26 offen offset:1024 sc1
  s_add_u32 s26, s26, 2048
  buffer_load_dwordx4 v[128:131], v187, s[8:11], s26 offen sc1
  buffer_load_dwordx4 v[132:135], v187, s[8:11], s26 offen offset:1024 sc1
  s_add_u32 s26, s26, 2048
  buffer_load_dwordx4 v[136:139], v187, s[8:11], s26 offen sc1
  buffer_load_dwordx4 v[140:143], v187, s[8:11], s26 offen offset:1024 sc1
  s_add_u32 s26, s26, 2048
  buffer_load_dwordx4 v[144:147], v187, s[8:11], s26 offen sc1
  buffer_load_dwordx4 v[148:151], v187, s[8:11], s26 offen offset:1024 sc1
  s_add_u32 s26, s26, 2048
  buffer_load_dwordx4 v[152:155], v187, s[8:11], s26 offen sc1
  buffer_load_dwordx4 v[156:159], v187, s[8:11], s26 offen offset:1024 sc1
  s_add_u32 s26, s26, 2048
  buffer_load_dwordx4 v[160:163], v187, s[8:11], s26 offen sc1
  buffer_load_dwordx4 v[164:167], v187, s[8:11], s26 offen offset:1024 sc1
  s_add_u32 s26, s26, 2048
  buffer_load_dwordx4 v[168:171], v187, s[8:11], s26 offen sc1
  buffer_load_dwordx4 v[172:175], v187, s[8:11], s26 offen offset:1024 sc1
  s_add_u32 s26, s26, 2048
  buffer_load_dwordx4 v[176:179], v187, s[8:11], s26 offen sc1
  buffer_load_dwordx4 v[180:183], v187, s[8:11], s26 offen offset:1024 sc1
  s_add_u32 s26, s26, 57344
  v_rcp_f32 v80, v73
  v_mov_b32 v84, v85
  v_mov_b32 v85, v86
  v_mov_b32 v86, v87
  v_mov_b32 v87, v88
  v_mov_b32 v88, v89
  v_mov_b32 v89, v90
  v_mov_b32 v90, v91
  v_mul_f32 v64, v64, v80
  v_mul_f32 v65, v65, v80
  v_mul_f32 v66, v66, v80
  v_mul_f32 v67, v67, v80
  v_mul_f32 v68, v68, v80
  v_mul_f32 v69, v69, v80
  v_mul_f32 v70, v70, v80
  v_mul_f32 v71, v71, v80
  v_mul_f32 v91, v72, v80
  v_cvt_pk_bf16_f32 v234, v64, v65
  v_cvt_pk_bf16_f32 v235, v66, v67
  v_cvt_pk_bf16_f32 v236, v68, v69
  v_cvt_pk_bf16_f32 v237, v70, v71
  s_add_u32 s23, s23, 144
  s_add_u32 s44, s44, 1
  s_cmp_eq_u32 s44, 8
  s_waitcnt vmcnt(0)
  s_cbranch_scc1 K2_SD
  v_smfmac_f32_16x16x64_bf16 v[198:201], v[234:237], v[112:119], v185
  v_smfmac_f32_16x16x64_bf16 v[202:205], v[234:237], v[120:127], v185
  v_smfmac_f32_16x16x64_bf16 v[206:209], v[234:237], v[128:135], v185
  v_smfmac_f32_16x16x64_bf16 v[210:213], v[234:237], v[136:143], v185
  v_smfmac_f32_16x16x64_bf16 v[214:217], v[234:237], v[144:151], v185
  v_smfmac_f32_16x16x64_bf16 v[218:221], v[234:237], v[152:159], v185
  v_smfmac_f32_16x16x64_bf16 v[222:225], v[234:237], v[160:167], v185
  v_smfmac_f32_16x16x64_bf16 v[226:229], v[234:237], v[168:175], v185
  v_smfmac_f32_16x16x64_bf16 v[230:233], v[234:237], v[176:183], v185
  s_branch K2_SG
K2_SD:
  v_cvt_pk_bf16_f32 v238, v84, v85
  v_cvt_pk_bf16_f32 v239, v86, v87
  v_cvt_pk_bf16_f32 v240, v88, v89
  v_cvt_pk_bf16_f32 v241, v90, v91
  buffer_load_dwordx4 v[80:83], v187, s[8:11], s26 offen sc1
  buffer_load_dwordx4 v[84:87], v187, s[8:11], s26 offen offset:1024 sc1
  s_add_u32 s26, s26, 2048
  buffer_load_dwordx4 v[88:91], v187, s[8:11], s26 offen sc1
  buffer_load_dwordx4 v[92:95], v187, s[8:11], s26 offen offset:1024 sc1
  s_add_u32 s26, s26, 2048
  buffer_load_dwordx4 v[96:99], v187, s[8:11], s26 offen sc1
  buffer_load_dwordx4 v[100:103], v187, s[8:11], s26 offen offset:1024 sc1
  s_add_u32 s26, s26, 2048
  buffer_load_dwordx4 v[104:107], v187, s[8:11], s26 offen sc1
  buffer_load_dwordx4 v[108:111], v187, s[8:11], s26 offen offset:1024 sc1
  s_add_u32 s26, s26, 2048
  buffer_load_dwordx4 v[0:3], v187, s[8:11], s26 offen sc1
  buffer_load_dwordx4 v[4:7], v187, s[8:11], s26 offen offset:1024 sc1
  s_add_u32 s26, s26, 2048
  buffer_load_dwordx4 v[8:11], v187, s[8:11], s26 offen sc1
  buffer_load_dwordx4 v[12:15], v187, s[8:11], s26 offen offset:1024 sc1
  s_add_u32 s26, s26, 2048
  buffer_load_dwordx4 v[16:19], v187, s[8:11], s26 offen sc1
  buffer_load_dwordx4 v[20:23], v187, s[8:11], s26 offen offset:1024 sc1
  s_add_u32 s26, s26, 2048
  buffer_load_dwordx4 v[24:27], v187, s[8:11], s26 offen sc1
  buffer_load_dwordx4 v[28:31], v187, s[8:11], s26 offen offset:1024 sc1
  s_add_u32 s26, s26, 2048
  buffer_load_dwordx4 v[32:35], v187, s[8:11], s26 offen sc1
  buffer_load_dwordx4 v[36:39], v187, s[8:11], s26 offen offset:1024 sc1
  s_add_u32 s26, s26, 2048
  s_mov_b64 vcc, 0
  s_waitcnt vmcnt(0)
  s_branch K2_OP7
.p2align 6
K2_B:
  s_setprio 0
  s_and_b32 s4, s2, 7
  s_lshl_b32 s4, s4, 5
  s_lshr_b32 s5, s2, 3
  s_add_u32 s4, s4, s5
  s_mul_i32 s5, s4, 9216
  s_and_b32 s6, s3, 3
  s_mul_i32 s7, s6, 2560
  s_mov_b32 s12, s36
  s_and_b32 s13, s37, 0xffff
  s_mov_b32 s14, 2359296
  s_mov_b32 s15, 0x20000
  s_mov_b32 s16, s64
  s_and_b32 s17, s65, 0xffff
  s_mov_b32 s18, 2359296
  s_mov_b32 s19, 0x20000
  s_lshl_b32 s23, s6, 3
  s_add_u32 s23, s23, 3
  s_lshl_b32 s22, s23, 8
  s_add_u32 s22, s22, 2424832
  s_lshl_b32 s20, s23, 11
  s_add_u32 s20, s20, 2359296
  s_mul_i32 s21, s23, 2560
  s_add_u32 s21, s21, 2433024
  s_mul_i32 s64, s6, 144
  s_add_u32 s64, s64, s5
  s_mul_i32 s59, s6, 1280
  s_add_u32 s59, s59, 151680
  s_lshr_b32 s61, s2, 3
  s_mul_i32 s26, s61, 43
  s_lshr_b32 s26, s26, 8
  s_min_u32 s26, s26, 4
  s_cmp_ge_u32 s61, 28
  s_addc_u32 s26, s26, 0
  s_and_b32 s63, s2, 7
  s_mul_i32 s24, s63, 6
  s_add_u32 s26, s26, s24
  s_mul_i32 s26, s26, 9
  s_lshl_b32 s63, s63, 6
  s_sub_u32 s26, s26, s63
  s_add_u32 s26, s26, 464
  v_min_u32 v1, 51, v0
  v_add_u32 v2, s26, v1
  v_cmp_gt_u32 vcc, 48, v0
  s_lshl_b32 s63, s63, 7
  s_add_u32 s63, s63, 3219456
  v_cndmask_b32 v1, v2, v1, vcc
  v_lshlrev_b32 v1, 7, v1
  v_min_u32 v3, 20, v0
  s_sub_u32 s26, s26, 12
  v_add_u32 v2, s26, v3
  v_cmp_gt_u32 vcc, 16, v0
  s_add_u32 s65, s63, 6144
  s_lshl_b32 s61, s61, 2
  v_cndmask_b32 v3, v2, v3, vcc
  v_lshlrev_b32 v246, 7, v3
  s_add_u32 s61, s61, s6
  s_mul_i32 s61, s61, 5184
  s_add_u32 s61, s61, 2555904
  s_mov_b32 s28, s54
  s_and_b32 s29, s55, 0xffff
  s_mov_b32 s30, 5308416
  s_mov_b32 s31, 0x20000
  s_lshl_b32 s68, s3, 10
  s_and_b32 s69, s2, 7
  s_lshl_b32 s69, s69, 2
  s_add_u32 s69, s69, s3
  s_lshl_b32 s69, s69, 11
  s_add_u32 s69, s69, 3350528
  s_lshl_b32 s71, s3, 7
  s_lshl_b32 s49, s3, 5
  s_add_u32 s49, s49, 30208
  s_bfe_i32 s50, s3, 0x10000
  s_mul_i32 s72, s6, 9216
  s_mul_i32 s73, s56, 36864
  s_add_u32 s73, s73, s72
  s_mul_i32 s53, s6, 2304
  s_add_u32 s53, s53, s5
  s_mul_i32 s52, s6, 4736
  s_lshl_b32 s51, s6, 4
  s_add_u32 s51, s51, 19456
  s_mul_i32 s36, s56, 9344
  s_add_u32 s36, s36, 3416064
  s_add_u32 s37, s36, 8192
  s_lshl_b32 s38, s6, 11
  s_add_u32 s36, s36, s38
  s_lshl_b32 s38, s4, 3
  s_sub_u32 s38, 2047, s38
  s_lshl_b32 s39, s4, 5
  s_add_u32 s39, s39, 3350528
  s_lshl_b32 s55, s4, 7
  s_add_u32 s55, s55, 2523136
  v_mov_b32 v4, 1
  v_lshlrev_b32 v5, 13, v0
  s_mov_b32 s70, 0
  s_mov_b32 m0, s59
  s_setprio 3
  s_cmp_lg_u32 s3, 4
  s_cbranch_scc1 K2_R0
  v_mov_b32 v3, 163072
K2_W0:
  ds_read_b32 v2, v3
  s_waitcnt lgkmcnt(0)
  v_cmp_gt_u32 vcc, 4, v2
  s_cbranch_vccnz K2_W0
K2_W1:
  buffer_load_dword v2, v1, s[8:11], s63 offen sc1
  s_add_u32 s70, s70, 1
  s_waitcnt vmcnt(0)
  v_cmp_eq_u32 vcc, 0, v2
  s_cmp_lt_u32 s70, 262144
  s_cselect_b64 vcc, vcc, 0
  s_cbranch_vccnz K2_W1
K2_R0:
  s_cmp_eq_u32 s3, 7
  s_barrier
  s_cbranch_scc1 K2_Q0
  buffer_load_dwordx4 v244, s[8:11], s64 offen sc1 lds
  s_add_u32 m0, s59, 992
  s_nop 0
  buffer_load_dword v245, s[8:11], s64 offen offset:32 sc1 lds
  s_waitcnt vmcnt(0)
K2_Q0:
  s_setprio 1
  s_barrier
  ds_read_b32 v234, v255 offset:1024
  ds_read_b128 v[226:229], v254 offset:0
  ds_read_b32 v236, v255 offset:2304
  ds_read_b128 v[230:233], v254 offset:1280
  s_waitcnt lgkmcnt(0)
  buffer_load_dword v216, v242, s[8:11], s22 offen sc1
  buffer_load_dwordx4 v[96:99], v223, s[8:11], s20 offen offset:0 sc1
  buffer_load_dwordx4 v[100:103], v223, s[8:11], s20 offen offset:1024 sc1
  buffer_load_dwordx4 v[136:139], v225, s[8:11], s21 offen offset:0 sc1
  buffer_load_dwordx4 v[140:143], v225, s[8:11], s21 offen offset:640 sc1
  buffer_load_dwordx4 v[144:147], v225, s[8:11], s21 offen offset:1280 sc1
  buffer_load_dwordx4 v[148:151], v225, s[8:11], s21 offen offset:1920 sc1
  s_add_u32 s22, s22, 256
  s_add_u32 s20, s20, 2048
  s_add_u32 s21, s21, 2560
  buffer_load_dword v218, v242, s[8:11], s22 offen sc1
  buffer_load_dwordx4 v[104:107], v223, s[8:11], s20 offen offset:0 sc1
  buffer_load_dwordx4 v[108:111], v223, s[8:11], s20 offen offset:1024 sc1
  buffer_load_dwordx4 v[152:155], v225, s[8:11], s21 offen offset:0 sc1
  buffer_load_dwordx4 v[156:159], v225, s[8:11], s21 offen offset:640 sc1
  buffer_load_dwordx4 v[160:163], v225, s[8:11], s21 offen offset:1280 sc1
  buffer_load_dwordx4 v[164:167], v225, s[8:11], s21 offen offset:1920 sc1
  s_add_u32 s22, s22, 256
  s_add_u32 s20, s20, 2048
  s_add_u32 s21, s21, 2560
  buffer_load_dword v220, v242, s[8:11], s22 offen sc1
  buffer_load_dwordx4 v[112:115], v223, s[8:11], s20 offen offset:0 sc1
  buffer_load_dwordx4 v[116:119], v223, s[8:11], s20 offen offset:1024 sc1
  buffer_load_dwordx4 v[168:171], v225, s[8:11], s21 offen offset:0 sc1
  buffer_load_dwordx4 v[172:175], v225, s[8:11], s21 offen offset:640 sc1
  buffer_load_dwordx4 v[176:179], v225, s[8:11], s21 offen offset:1280 sc1
  buffer_load_dwordx4 v[180:183], v225, s[8:11], s21 offen offset:1920 sc1
  s_waitcnt vmcnt(18)
  s_waitcnt lgkmcnt(0)
  v_mfma_f32_32x32x4_2b_bf16 v[0:31], v[216:217], v[234:235], 0
  s_nop 15
  s_nop 1
  v_mfma_f32_32x32x16_bf16 v[0:15], v[96:99], v[226:229], v[0:15]
  v_mfma_f32_32x32x16_bf16 v[16:31], v[100:103], v[226:229], v[16:31]
  s_nop 10
  v_exp_f32 v0, v0
  v_exp_f32 v1, v1
  v_exp_f32 v2, v2
  v_exp_f32 v3, v3
  v_exp_f32 v4, v4
  s_waitcnt vmcnt(11)
  v_mfma_f32_32x32x4_2b_bf16 v[32:63], v[218:219], v[234:235], 0
  v_exp_f32 v5, v5
  v_exp_f32 v6, v6
  v_exp_f32 v7, v7
  v_exp_f32 v8, v8
  s_add_u32 s22, s22, 256
  s_add_u32 s20, s20, 2048
  s_add_u32 s21, s21, 2560
  buffer_load_dword v222, v242, s[8:11], s22 offen sc1
  buffer_load_dwordx4 v[120:123], v223, s[8:11], s20 offen offset:0 sc1
  v_exp_f32 v9, v9
  v_exp_f32 v10, v10
  v_exp_f32 v11, v11
  v_exp_f32 v12, v12
  v_smfmac_f32_32x32x32_bf16 v[64:79], v[136:139], v[0:7], v217 abid:1
  v_exp_f32 v13, v13
  v_exp_f32 v14, v14
  v_exp_f32 v15, v15
  buffer_load_dwordx4 v[124:127], v223, s[8:11], s20 offen offset:1024 sc1
  buffer_load_dwordx4 v[184:187], v225, s[8:11], s21 offen offset:0 sc1
  v_exp_f32 v16, v16
  v_exp_f32 v17, v17
  v_smfmac_f32_32x32x32_bf16 v[64:79], v[140:143], v[8:15], v217 abid:1
  v_exp_f32 v18, v18
  v_exp_f32 v19, v19
  v_exp_f32 v20, v20
  buffer_load_dwordx4 v[188:191], v225, s[8:11], s21 offen offset:640 sc1
  buffer_load_dwordx4 v[192:195], v225, s[8:11], s21 offen offset:1280 sc1
  v_mfma_f32_32x32x16_bf16 v[32:47], v[104:107], v[226:229], v[32:47]
  v_exp_f32 v21, v21
  v_exp_f32 v22, v22
  v_exp_f32 v23, v23
  v_mfma_f32_32x32x16_bf16 v[48:63], v[108:111], v[226:229], v[48:63]
  v_exp_f32 v24, v24
  v_exp_f32 v25, v25
  v_exp_f32 v26, v26
  v_smfmac_f32_32x32x32_bf16 v[64:79], v[144:147], v[16:23], v217 abid:1
  v_exp_f32 v27, v27
  v_exp_f32 v28, v28
  v_exp_f32 v29, v29
  buffer_load_dwordx4 v[196:199], v225, s[8:11], s21 offen offset:1920 sc1
  s_add_u32 s22, s22, 256
  s_add_u32 s20, s20, 2048
  s_add_u32 s21, s21, 2560
  buffer_load_dword v224, v242, s[8:11], s22 offen sc1
  v_exp_f32 v30, v30
  v_exp_f32 v31, v31
  v_exp_f32 v32, v32
  v_exp_f32 v33, v33
  v_smfmac_f32_32x32x32_bf16 v[64:79], v[148:151], v[24:31], v217 abid:1
  v_exp_f32 v34, v34
  v_exp_f32 v35, v35
  v_exp_f32 v36, v36
  s_waitcnt vmcnt(12)
  v_mfma_f32_32x32x4_2b_bf16 v[0:31], v[220:221], v[234:235], 0
  v_exp_f32 v37, v37
  v_exp_f32 v38, v38
  v_exp_f32 v39, v39
  v_exp_f32 v40, v40
  buffer_load_dwordx4 v[128:131], v223, s[8:11], s20 offen offset:0 sc1
  buffer_load_dwordx4 v[132:135], v223, s[8:11], s20 offen offset:1024 sc1
  v_exp_f32 v41, v41
  v_exp_f32 v42, v42
  v_exp_f32 v43, v43
  v_exp_f32 v44, v44
  v_smfmac_f32_32x32x32_bf16 v[64:79], v[152:155], v[32:39], v217 abid:1
  v_exp_f32 v45, v45
  v_exp_f32 v46, v46
  v_exp_f32 v47, v47
  buffer_load_dwordx4 v[200:203], v225, s[8:11], s21 offen offset:0 sc1
  buffer_load_dwordx4 v[204:207], v225, s[8:11], s21 offen offset:640 sc1
  v_exp_f32 v48, v48
  v_exp_f32 v49, v49
  v_smfmac_f32_32x32x32_bf16 v[64:79], v[156:159], v[40:47], v217 abid:1
  v_exp_f32 v50, v50
  v_exp_f32 v51, v51
  v_exp_f32 v52, v52
  buffer_load_dwordx4 v[208:211], v225, s[8:11], s21 offen offset:1280 sc1
  buffer_load_dwordx4 v[212:215], v225, s[8:11], s21 offen offset:1920 sc1
  v_mfma_f32_32x32x16_bf16 v[0:15], v[112:115], v[226:229], v[0:15]
  v_exp_f32 v53, v53
  v_exp_f32 v54, v54
  v_exp_f32 v55, v55
  v_mfma_f32_32x32x16_bf16 v[16:31], v[116:119], v[226:229], v[16:31]
  v_exp_f32 v56, v56
  v_exp_f32 v57, v57
  v_exp_f32 v58, v58
  v_smfmac_f32_32x32x32_bf16 v[64:79], v[160:163], v[48:55], v217 abid:1
  v_exp_f32 v59, v59
  v_exp_f32 v60, v60
  v_exp_f32 v61, v61
  buffer_load_dword v247, v246, s[8:11], s65 offen sc1
  v_exp_f32 v62, v62
  v_exp_f32 v63, v63
  v_exp_f32 v0, v0
  v_exp_f32 v1, v1
  v_smfmac_f32_32x32x32_bf16 v[64:79], v[164:167], v[56:63], v217 abid:1
  v_exp_f32 v2, v2
  v_exp_f32 v3, v3
  v_exp_f32 v4, v4
  s_waitcnt vmcnt(12)
  v_mfma_f32_32x32x4_2b_bf16 v[32:63], v[222:223], v[234:235], 0
  v_exp_f32 v5, v5
  v_exp_f32 v6, v6
  v_exp_f32 v7, v7
  v_exp_f32 v8, v8
  v_exp_f32 v9, v9
  v_exp_f32 v10, v10
  v_exp_f32 v11, v11
  v_exp_f32 v12, v12
  v_smfmac_f32_32x32x32_bf16 v[64:79], v[168:171], v[0:7], v217 abid:1
  v_exp_f32 v13, v13
  v_exp_f32 v14, v14
  v_exp_f32 v15, v15
  v_exp_f32 v16, v16
  v_exp_f32 v17, v17
  v_smfmac_f32_32x32x32_bf16 v[64:79], v[172:175], v[8:15], v217 abid:1
  v_exp_f32 v18, v18
  v_exp_f32 v19, v19
  v_exp_f32 v20, v20
  v_mfma_f32_32x32x16_bf16 v[32:47], v[120:123], v[226:229], v[32:47]
  v_exp_f32 v21, v21
  v_exp_f32 v22, v22
  v_exp_f32 v23, v23
  v_mfma_f32_32x32x16_bf16 v[48:63], v[124:127], v[226:229], v[48:63]
  v_exp_f32 v24, v24
  v_exp_f32 v25, v25
  v_exp_f32 v26, v26
  v_smfmac_f32_32x32x32_bf16 v[64:79], v[176:179], v[16:23], v217 abid:1
  v_exp_f32 v27, v27
  v_exp_f32 v28, v28
  v_exp_f32 v29, v29
  s_waitcnt vmcnt(0)
K2_W2:
  v_cmp_eq_u32 vcc, 0, v247
  s_cbranch_vccnz K2_W3
K2_W4:
  s_cmp_lg_u32 s3, 7
  s_cbranch_scc1 K2_Q3
  s_mov_b32 m0, s59
  s_nop 0
  buffer_load_dwordx4 v244, s[8:11], s64 offen sc1 lds
  s_add_u32 m0, s59, 992
  s_nop 0
  buffer_load_dword v245, s[8:11], s64 offen offset:32 sc1 lds
K2_Q3:
  s_add_u32 m0, s59, 4544
  s_nop 0
  buffer_load_dwordx4 v244, s[8:11], s64 offen offset:576 sc1 lds
  s_add_u32 m0, s59, 5536
  s_nop 0
  buffer_load_dword v245, s[8:11], s64 offen offset:608 sc1 lds
  v_exp_f32 v30, v30
  v_exp_f32 v31, v31
  v_exp_f32 v32, v32
  v_exp_f32 v33, v33
  v_smfmac_f32_32x32x32_bf16 v[64:79], v[180:183], v[24:31], v217 abid:1
  v_exp_f32 v34, v34
  v_exp_f32 v35, v35
  v_exp_f32 v36, v36
  v_mfma_f32_32x32x4_2b_bf16 v[0:31], v[224:225], v[234:235], 0
  v_exp_f32 v37, v37
  v_exp_f32 v38, v38
  v_exp_f32 v39, v39
  v_exp_f32 v40, v40
  buffer_load_dword v243, v243, s[8:11], s61 offen sc1
  s_add_u32 m0, s58, 40960
  s_add_u32 s57, s62, 0
  buffer_load_dwordx4 v238, s[32:35], s57 offen lds
  v_exp_f32 v41, v41
  v_exp_f32 v42, v42
  v_exp_f32 v43, v43
  v_exp_f32 v44, v44
  v_smfmac_f32_32x32x32_bf16 v[64:79], v[184:187], v[32:39], v217 abid:1
  v_exp_f32 v45, v45
  v_exp_f32 v46, v46
  v_exp_f32 v47, v47
  s_add_u32 m0, s58, 45056
  s_add_u32 s57, s62, 589824
  buffer_load_dwordx4 v238, s[32:35], s57 offen lds
  s_add_u32 m0, s58, 49152
  s_add_u32 s57, s62, 1179648
  buffer_load_dwordx4 v238, s[32:35], s57 offen lds
  v_exp_f32 v48, v48
  v_exp_f32 v49, v49
  v_smfmac_f32_32x32x32_bf16 v[64:79], v[188:191], v[40:47], v217 abid:1
  v_exp_f32 v50, v50
  v_exp_f32 v51, v51
  v_exp_f32 v52, v52
  v_mfma_f32_32x32x16_bf16 v[0:15], v[128:131], v[226:229], v[0:15]
  v_exp_f32 v53, v53
  v_exp_f32 v54, v54
  v_exp_f32 v55, v55
  v_mfma_f32_32x32x16_bf16 v[16:31], v[132:135], v[226:229], v[16:31]
  v_exp_f32 v56, v56
  v_exp_f32 v57, v57
  v_exp_f32 v58, v58
  v_smfmac_f32_32x32x32_bf16 v[64:79], v[192:195], v[48:55], v217 abid:1
  v_exp_f32 v59, v59
  v_exp_f32 v60, v60
  v_exp_f32 v61, v61
  v_exp_f32 v62, v62
  v_exp_f32 v63, v63
  v_exp_f32 v0, v0
  v_exp_f32 v1, v1
  v_smfmac_f32_32x32x32_bf16 v[64:79], v[196:199], v[56:63], v217 abid:1
  v_exp_f32 v2, v2
  v_exp_f32 v3, v3
  v_exp_f32 v4, v4
  v_mfma_f32_32x32x4_2b_bf16 v[32:63], v[216:217], v[236:237], 0
  v_exp_f32 v5, v5
  v_exp_f32 v6, v6
  v_exp_f32 v7, v7
  v_exp_f32 v8, v8
  s_waitcnt vmcnt(4)
  s_waitcnt lgkmcnt(0)
  s_barrier
  ds_read_b128 v[80:83], v219 offset:10240
  ds_read_b128 v[84:87], v219 offset:11264
  ds_read_b64 v[88:89], v221 offset:12288
  ds_read_b128 v[244:247], v219 offset:30720
  ds_read_b128 v[248:251], v219 offset:31744
  ds_read_b64 v[252:253], v221 offset:32768
  v_exp_f32 v9, v9
  v_exp_f32 v10, v10
  v_exp_f32 v11, v11
  v_exp_f32 v12, v12
  v_smfmac_f32_32x32x32_bf16 v[64:79], v[200:203], v[0:7], v217 abid:1
  v_exp_f32 v13, v13
  v_exp_f32 v14, v14
  v_exp_f32 v15, v15
  v_exp_f32 v16, v16
  v_exp_f32 v17, v17
  v_smfmac_f32_32x32x32_bf16 v[64:79], v[204:207], v[8:15], v217 abid:1
  v_exp_f32 v18, v18
  v_exp_f32 v19, v19
  v_exp_f32 v20, v20
  v_mfma_f32_32x32x16_bf16 v[32:47], v[96:99], v[230:233], v[32:47]
  v_exp_f32 v21, v21
  v_exp_f32 v22, v22
  v_exp_f32 v23, v23
  v_mfma_f32_32x32x16_bf16 v[48:63], v[100:103], v[230:233], v[48:63]
  v_exp_f32 v24, v24
  v_exp_f32 v25, v25
  v_exp_f32 v26, v26
  v_smfmac_f32_32x32x32_bf16 v[64:79], v[208:211], v[16:23], v217 abid:1
  v_exp_f32 v27, v27
  v_exp_f32 v28, v28
  v_exp_f32 v29, v29
  s_waitcnt lgkmcnt(0)
  v_exp_f32 v30, v30
  v_exp_f32 v31, v31
  v_exp_f32 v32, v32
  v_exp_f32 v33, v33
  v_smfmac_f32_32x32x32_bf16 v[64:79], v[212:215], v[24:31], v217 abid:1
  v_exp_f32 v34, v34
  v_exp_f32 v35, v35
  v_exp_f32 v36, v36
  v_mfma_f32_32x32x4_2b_bf16 v[0:31], v[218:219], v[236:237], 0
  v_exp_f32 v37, v37
  v_exp_f32 v38, v38
  v_exp_f32 v39, v39
  v_exp_f32 v40, v40
  v_exp_f32 v41, v41
  v_exp_f32 v42, v42
  v_exp_f32 v43, v43
  v_exp_f32 v44, v44
  v_smfmac_f32_32x32x32_bf16 v[80:95], v[136:139], v[32:39], v217 abid:1
  v_exp_f32 v45, v45
  v_exp_f32 v46, v46
  v_exp_f32 v47, v47
  v_pk_add_f32 v[64:65], v[64:65], v[244:245]
  v_pk_add_f32 v[66:67], v[66:67], v[246:247]
  v_pk_add_f32 v[68:69], v[68:69], v[248:249]
  v_pk_add_f32 v[70:71], v[70:71], v[250:251]
  v_pk_add_f32 v[72:73], v[72:73], v[252:253]
  ds_write_b128 v219, v[64:67] offset:20480
  ds_write_b128 v219, v[68:71] offset:21504
  ds_write_b64 v221, v[72:73] offset:22528
  v_exp_f32 v48, v48
  v_exp_f32 v49, v49
  v_smfmac_f32_32x32x32_bf16 v[80:95], v[140:143], v[40:47], v217 abid:1
  v_exp_f32 v50, v50
  v_exp_f32 v51, v51
  v_exp_f32 v52, v52
  v_mfma_f32_32x32x16_bf16 v[0:15], v[104:107], v[230:233], v[0:15]
  v_exp_f32 v53, v53
  v_exp_f32 v54, v54
  v_exp_f32 v55, v55
  v_mfma_f32_32x32x16_bf16 v[16:31], v[108:111], v[230:233], v[16:31]
  v_exp_f32 v56, v56
  v_exp_f32 v57, v57
  v_exp_f32 v58, v58
  v_smfmac_f32_32x32x32_bf16 v[80:95], v[144:147], v[48:55], v217 abid:1
  v_exp_f32 v59, v59
  v_exp_f32 v60, v60
  v_exp_f32 v61, v61
  s_waitcnt lgkmcnt(0)
  s_barrier
  ds_read_b128 v[64:67], v219 offset:0
  ds_read_b128 v[68:71], v219 offset:1024
  ds_read_b64 v[72:73], v221 offset:2048
  ds_read_b32 v234, v255 offset:3584
  ds_read_b128 v[226:229], v254 offset:2560
  v_exp_f32 v62, v62
  v_exp_f32 v63, v63
  v_exp_f32 v0, v0
  v_exp_f32 v1, v1
  v_smfmac_f32_32x32x32_bf16 v[80:95], v[148:151], v[56:63], v217 abid:1
  v_exp_f32 v2, v2
  v_exp_f32 v3, v3
  v_exp_f32 v4, v4
  v_mfma_f32_32x32x4_2b_bf16 v[32:63], v[220:221], v[236:237], 0
  v_exp_f32 v5, v5
  v_exp_f32 v6, v6
  v_exp_f32 v7, v7
  v_exp_f32 v8, v8
  v_exp_f32 v9, v9
  v_exp_f32 v10, v10
  v_exp_f32 v11, v11
  v_exp_f32 v12, v12
  v_smfmac_f32_32x32x32_bf16 v[80:95], v[152:155], v[0:7], v217 abid:1
  v_exp_f32 v13, v13
  v_exp_f32 v14, v14
  v_exp_f32 v15, v15
  v_exp_f32 v16, v16
  v_exp_f32 v17, v17
  v_smfmac_f32_32x32x32_bf16 v[80:95], v[156:159], v[8:15], v217 abid:1
  v_exp_f32 v18, v18
  v_exp_f32 v19, v19
  v_exp_f32 v20, v20
  v_mfma_f32_32x32x16_bf16 v[32:47], v[112:115], v[230:233], v[32:47]
  v_exp_f32 v21, v21
  v_exp_f32 v22, v22
  v_exp_f32 v23, v23
  v_mfma_f32_32x32x16_bf16 v[48:63], v[116:119], v[230:233], v[48:63]
  v_exp_f32 v24, v24
  v_exp_f32 v25, v25
  v_exp_f32 v26, v26
  v_smfmac_f32_32x32x32_bf16 v[80:95], v[160:163], v[16:23], v217 abid:1
  v_exp_f32 v27, v27
  v_exp_f32 v28, v28
  v_exp_f32 v29, v29
  v_exp_f32 v30, v30
  v_exp_f32 v31, v31
  v_exp_f32 v32, v32
  v_exp_f32 v33, v33
  v_smfmac_f32_32x32x32_bf16 v[80:95], v[164:167], v[24:31], v217 abid:1
  v_exp_f32 v34, v34
  v_exp_f32 v35, v35
  v_exp_f32 v36, v36
  v_mfma_f32_32x32x4_2b_bf16 v[0:31], v[222:223], v[236:237], 0
  v_exp_f32 v37, v37
  v_exp_f32 v38, v38
  v_exp_f32 v39, v39
  v_exp_f32 v40, v40
  v_exp_f32 v41, v41
  v_exp_f32 v42, v42
  v_exp_f32 v43, v43
  v_exp_f32 v44, v44
  v_smfmac_f32_32x32x32_bf16 v[80:95], v[168:171], v[32:39], v217 abid:1
  v_exp_f32 v45, v45
  v_exp_f32 v46, v46
  v_exp_f32 v47, v47
  v_exp_f32 v48, v48
  v_exp_f32 v49, v49
  v_smfmac_f32_32x32x32_bf16 v[80:95], v[172:175], v[40:47], v217 abid:1
  v_exp_f32 v50, v50
  v_exp_f32 v51, v51
  v_exp_f32 v52, v52
  v_mfma_f32_32x32x16_bf16 v[0:15], v[120:123], v[230:233], v[0:15]
  v_exp_f32 v53, v53
  v_exp_f32 v54, v54
  v_exp_f32 v55, v55
  v_mfma_f32_32x32x16_bf16 v[16:31], v[124:127], v[230:233], v[16:31]
  v_exp_f32 v56, v56
  v_exp_f32 v57, v57
  v_exp_f32 v58, v58
  v_smfmac_f32_32x32x32_bf16 v[80:95], v[176:179], v[48:55], v217 abid:1
  v_exp_f32 v59, v59
  v_exp_f32 v60, v60
  v_exp_f32 v61, v61
  v_exp_f32 v62, v62
  v_exp_f32 v63, v63
  v_exp_f32 v0, v0
  v_exp_f32 v1, v1
  v_smfmac_f32_32x32x32_bf16 v[80:95], v[180:183], v[56:63], v217 abid:1
  v_exp_f32 v2, v2
  v_exp_f32 v3, v3
  v_exp_f32 v4, v4
  v_mfma_f32_32x32x4_2b_bf16 v[32:63], v[224:225], v[236:237], 0
  v_exp_f32 v5, v5
  v_exp_f32 v6, v6
  v_exp_f32 v7, v7
  v_exp_f32 v8, v8
  v_exp_f32 v9, v9
  v_exp_f32 v10, v10
  v_exp_f32 v11, v11
  v_exp_f32 v12, v12
  v_smfmac_f32_32x32x32_bf16 v[80:95], v[184:187], v[0:7], v217 abid:1
  v_exp_f32 v13, v13
  v_exp_f32 v14, v14
  v_exp_f32 v15, v15
  v_exp_f32 v16, v16
  v_exp_f32 v17, v17
  v_smfmac_f32_32x32x32_bf16 v[80:95], v[188:191], v[8:15], v217 abid:1
  v_exp_f32 v18, v18
  v_exp_f32 v19, v19
  v_exp_f32 v20, v20
  v_mfma_f32_32x32x16_bf16 v[32:47], v[128:131], v[230:233], v[32:47]
  v_exp_f32 v21, v21
  v_exp_f32 v22, v22
  v_exp_f32 v23, v23
  v_mfma_f32_32x32x16_bf16 v[48:63], v[132:135], v[230:233], v[48:63]
  v_exp_f32 v24, v24
  v_exp_f32 v25, v25
  v_exp_f32 v26, v26
  v_smfmac_f32_32x32x32_bf16 v[80:95], v[192:195], v[16:23], v217 abid:1
  v_exp_f32 v27, v27
  v_exp_f32 v28, v28
  v_exp_f32 v29, v29
  s_waitcnt lgkmcnt(0)
  v_exp_f32 v30, v30
  v_exp_f32 v31, v31
  v_exp_f32 v32, v32
  v_exp_f32 v33, v33
  v_smfmac_f32_32x32x32_bf16 v[80:95], v[196:199], v[24:31], v217 abid:1
  v_exp_f32 v34, v34
  v_exp_f32 v35, v35
  v_exp_f32 v36, v36
  v_mfma_f32_32x32x4_2b_bf16 v[0:31], v[216:217], v[234:235], 0
  v_exp_f32 v37, v37
  v_exp_f32 v38, v38
  v_exp_f32 v39, v39
  v_exp_f32 v40, v40
  v_exp_f32 v41, v41
  v_exp_f32 v42, v42
  v_exp_f32 v43, v43
  v_exp_f32 v44, v44
  v_smfmac_f32_32x32x32_bf16 v[80:95], v[200:203], v[32:39], v217 abid:1
  v_exp_f32 v45, v45
  v_exp_f32 v46, v46
  v_exp_f32 v47, v47
  v_exp_f32 v48, v48
  v_exp_f32 v49, v49
  v_smfmac_f32_32x32x32_bf16 v[80:95], v[204:207], v[40:47], v217 abid:1
  v_exp_f32 v50, v50
  v_exp_f32 v51, v51
  v_exp_f32 v52, v52
  v_mfma_f32_32x32x16_bf16 v[0:15], v[96:99], v[226:229], v[0:15]
  v_exp_f32 v53, v53
  v_exp_f32 v54, v54
  v_exp_f32 v55, v55
  v_mfma_f32_32x32x16_bf16 v[16:31], v[100:103], v[226:229], v[16:31]
  v_exp_f32 v56, v56
  v_exp_f32 v57, v57
  v_exp_f32 v58, v58
  v_smfmac_f32_32x32x32_bf16 v[80:95], v[208:211], v[48:55], v217 abid:1
  v_exp_f32 v59, v59
  v_exp_f32 v60, v60
  v_exp_f32 v61, v61
  v_exp_f32 v62, v62
  v_exp_f32 v63, v63
  v_exp_f32 v0, v0
  v_exp_f32 v1, v1
  v_smfmac_f32_32x32x32_bf16 v[80:95], v[212:215], v[56:63], v217 abid:1
  v_exp_f32 v2, v2
  v_exp_f32 v3, v3
  v_exp_f32 v4, v4
  v_mfma_f32_32x32x4_2b_bf16 v[32:63], v[218:219], v[234:235], 0
  v_exp_f32 v5, v5
  v_exp_f32 v6, v6
  v_exp_f32 v7, v7
  v_exp_f32 v8, v8
  v_exp_f32 v9, v9
  v_exp_f32 v10, v10
  v_exp_f32 v11, v11
  v_exp_f32 v12, v12
  v_smfmac_f32_32x32x32_bf16 v[64:79], v[136:139], v[0:7], v217 abid:1
  v_exp_f32 v13, v13
  v_exp_f32 v14, v14
  v_exp_f32 v15, v15
  ds_write_b128 v219, v[80:83] offset:30720
  ds_write_b128 v219, v[84:87] offset:31744
  ds_write_b64 v221, v[88:89] offset:32768
  v_exp_f32 v16, v16
  v_exp_f32 v17, v17
  v_smfmac_f32_32x32x32_bf16 v[64:79], v[140:143], v[8:15], v217 abid:1
  v_exp_f32 v18, v18
  v_exp_f32 v19, v19
  v_exp_f32 v20, v20
  v_mfma_f32_32x32x16_bf16 v[32:47], v[104:107], v[226:229], v[32:47]
  v_exp_f32 v21, v21
  v_exp_f32 v22, v22
  v_exp_f32 v23, v23
  v_mfma_f32_32x32x16_bf16 v[48:63], v[108:111], v[226:229], v[48:63]
  v_exp_f32 v24, v24
  v_exp_f32 v25, v25
  v_exp_f32 v26, v26
  v_smfmac_f32_32x32x32_bf16 v[64:79], v[144:147], v[16:23], v217 abid:1
  v_exp_f32 v27, v27
  v_exp_f32 v28, v28
  v_exp_f32 v29, v29
  s_waitcnt lgkmcnt(0)
  s_barrier
  ds_read_b128 v[80:83], v219 offset:10240
  ds_read_b128 v[84:87], v219 offset:11264
  ds_read_b64 v[88:89], v221 offset:12288
  ds_read_b32 v236, v255 offset:4864
  ds_read_b128 v[230:233], v254 offset:3840
  v_exp_f32 v30, v30
  v_exp_f32 v31, v31
  v_exp_f32 v32, v32
  v_exp_f32 v33, v33
  v_smfmac_f32_32x32x32_bf16 v[64:79], v[148:151], v[24:31], v217 abid:1
  v_exp_f32 v34, v34
  v_exp_f32 v35, v35
  v_exp_f32 v36, v36
  v_mfma_f32_32x32x4_2b_bf16 v[0:31], v[220:221], v[234:235], 0
  v_exp_f32 v37, v37
  v_exp_f32 v38, v38
  v_exp_f32 v39, v39
  v_exp_f32 v40, v40
  v_exp_f32 v41, v41
  v_exp_f32 v42, v42
  v_exp_f32 v43, v43
  v_exp_f32 v44, v44
  v_smfmac_f32_32x32x32_bf16 v[64:79], v[152:155], v[32:39], v217 abid:1
  v_exp_f32 v45, v45
  v_exp_f32 v46, v46
  v_exp_f32 v47, v47
  v_exp_f32 v48, v48
  v_exp_f32 v49, v49
  v_smfmac_f32_32x32x32_bf16 v[64:79], v[156:159], v[40:47], v217 abid:1
  v_exp_f32 v50, v50
  v_exp_f32 v51, v51
  v_exp_f32 v52, v52
  v_mfma_f32_32x32x16_bf16 v[0:15], v[112:115], v[226:229], v[0:15]
  v_exp_f32 v53, v53
  v_exp_f32 v54, v54
  v_exp_f32 v55, v55
  v_mfma_f32_32x32x16_bf16 v[16:31], v[116:119], v[226:229], v[16:31]
  v_exp_f32 v56, v56
  v_exp_f32 v57, v57
  v_exp_f32 v58, v58
  v_smfmac_f32_32x32x32_bf16 v[64:79], v[160:163], v[48:55], v217 abid:1
  v_exp_f32 v59, v59
  v_exp_f32 v60, v60
  v_exp_f32 v61, v61
  v_exp_f32 v62, v62
  v_exp_f32 v63, v63
  v_exp_f32 v0, v0
  v_exp_f32 v1, v1
  v_smfmac_f32_32x32x32_bf16 v[64:79], v[164:167], v[56:63], v217 abid:1
  v_exp_f32 v2, v2
  v_exp_f32 v3, v3
  v_exp_f32 v4, v4
  v_mfma_f32_32x32x4_2b_bf16 v[32:63], v[222:223], v[234:235], 0
  v_exp_f32 v5, v5
  v_exp_f32 v6, v6
  v_exp_f32 v7, v7
  v_exp_f32 v8, v8
  v_exp_f32 v9, v9
  v_exp_f32 v10, v10
  v_exp_f32 v11, v11
  v_exp_f32 v12, v12
  v_smfmac_f32_32x32x32_bf16 v[64:79], v[168:171], v[0:7], v217 abid:1
  v_exp_f32 v13, v13
  v_exp_f32 v14, v14
  v_exp_f32 v15, v15
  v_exp_f32 v16, v16
  v_exp_f32 v17, v17
  v_smfmac_f32_32x32x32_bf16 v[64:79], v[172:175], v[8:15], v217 abid:1
  v_exp_f32 v18, v18
  v_exp_f32 v19, v19
  v_exp_f32 v20, v20
  v_mfma_f32_32x32x16_bf16 v[32:47], v[120:123], v[226:229], v[32:47]
  v_exp_f32 v21, v21
  v_exp_f32 v22, v22
  v_exp_f32 v23, v23
  v_mfma_f32_32x32x16_bf16 v[48:63], v[124:127], v[226:229], v[48:63]
  v_exp_f32 v24, v24
  v_exp_f32 v25, v25
  v_exp_f32 v26, v26
  v_smfmac_f32_32x32x32_bf16 v[64:79], v[176:179], v[16:23], v217 abid:1
  v_exp_f32 v27, v27
  v_exp_f32 v28, v28
  v_exp_f32 v29, v29
  v_exp_f32 v30, v30
  v_exp_f32 v31, v31
  v_exp_f32 v32, v32
  v_exp_f32 v33, v33
  v_smfmac_f32_32x32x32_bf16 v[64:79], v[180:183], v[24:31], v217 abid:1
  v_exp_f32 v34, v34
  v_exp_f32 v35, v35
  v_exp_f32 v36, v36
  v_mfma_f32_32x32x4_2b_bf16 v[0:31], v[224:225], v[234:235], 0
  v_exp_f32 v37, v37
  v_exp_f32 v38, v38
  v_exp_f32 v39, v39
  v_exp_f32 v40, v40
  v_exp_f32 v41, v41
  v_exp_f32 v42, v42
  v_exp_f32 v43, v43
  v_exp_f32 v44, v44
  v_smfmac_f32_32x32x32_bf16 v[64:79], v[184:187], v[32:39], v217 abid:1
  v_exp_f32 v45, v45
  v_exp_f32 v46, v46
  v_exp_f32 v47, v47
  v_exp_f32 v48, v48
  v_exp_f32 v49, v49
  v_smfmac_f32_32x32x32_bf16 v[64:79], v[188:191], v[40:47], v217 abid:1
  v_exp_f32 v50, v50
  v_exp_f32 v51, v51
  v_exp_f32 v52, v52
  v_mfma_f32_32x32x16_bf16 v[0:15], v[128:131], v[226:229], v[0:15]
  v_exp_f32 v53, v53
  v_exp_f32 v54, v54
  v_exp_f32 v55, v55
  v_mfma_f32_32x32x16_bf16 v[16:31], v[132:135], v[226:229], v[16:31]
  v_exp_f32 v56, v56
  v_exp_f32 v57, v57
  v_exp_f32 v58, v58
  v_smfmac_f32_32x32x32_bf16 v[64:79], v[192:195], v[48:55], v217 abid:1
  v_exp_f32 v59, v59
  v_exp_f32 v60, v60
  v_exp_f32 v61, v61
  s_waitcnt lgkmcnt(0)
  v_exp_f32 v62, v62
  v_exp_f32 v63, v63
  v_exp_f32 v0, v0
  v_exp_f32 v1, v1
  v_smfmac_f32_32x32x32_bf16 v[64:79], v[196:199], v[56:63], v217 abid:1
  v_exp_f32 v2, v2
  v_exp_f32 v3, v3
  v_exp_f32 v4, v4
  v_mfma_f32_32x32x4_2b_bf16 v[32:63], v[216:217], v[236:237], 0
  v_exp_f32 v5, v5
  v_exp_f32 v6, v6
  v_exp_f32 v7, v7
  v_exp_f32 v8, v8
  v_exp_f32 v9, v9
  v_exp_f32 v10, v10
  v_exp_f32 v11, v11
  v_exp_f32 v12, v12
  v_smfmac_f32_32x32x32_bf16 v[64:79], v[200:203], v[0:7], v217 abid:1
  v_exp_f32 v13, v13
  v_exp_f32 v14, v14
  v_exp_f32 v15, v15
  v_exp_f32 v16, v16
  v_exp_f32 v17, v17
  v_smfmac_f32_32x32x32_bf16 v[64:79], v[204:207], v[8:15], v217 abid:1
  v_exp_f32 v18, v18
  v_exp_f32 v19, v19
  v_exp_f32 v20, v20
  v_mfma_f32_32x32x16_bf16 v[32:47], v[96:99], v[230:233], v[32:47]
  v_exp_f32 v21, v21
  v_exp_f32 v22, v22
  v_exp_f32 v23, v23
  v_mfma_f32_32x32x16_bf16 v[48:63], v[100:103], v[230:233], v[48:63]
  v_exp_f32 v24, v24
  v_exp_f32 v25, v25
  v_exp_f32 v26, v26
  v_smfmac_f32_32x32x32_bf16 v[64:79], v[208:211], v[16:23], v217 abid:1
  v_exp_f32 v27, v27
  v_exp_f32 v28, v28
  v_exp_f32 v29, v29
  v_exp_f32 v30, v30
  v_exp_f32 v31, v31
  v_exp_f32 v32, v32
  v_exp_f32 v33, v33
  v_smfmac_f32_32x32x32_bf16 v[64:79], v[212:215], v[24:31], v217 abid:1
  v_exp_f32 v34, v34
  v_exp_f32 v35, v35
  v_exp_f32 v36, v36
  v_mfma_f32_32x32x4_2b_bf16 v[0:31], v[218:219], v[236:237], 0
  v_exp_f32 v37, v37
  v_exp_f32 v38, v38
  v_exp_f32 v39, v39
  v_exp_f32 v40, v40
  v_exp_f32 v41, v41
  v_exp_f32 v42, v42
  v_exp_f32 v43, v43
  v_exp_f32 v44, v44
  v_smfmac_f32_32x32x32_bf16 v[80:95], v[136:139], v[32:39], v217 abid:1
  v_exp_f32 v45, v45
  v_exp_f32 v46, v46
  v_exp_f32 v47, v47
  ds_write_b128 v219, v[64:67] offset:20480
  ds_write_b128 v219, v[68:71] offset:21504
  ds_write_b64 v221, v[72:73] offset:22528
  v_exp_f32 v48, v48
  v_exp_f32 v49, v49
  v_smfmac_f32_32x32x32_bf16 v[80:95], v[140:143], v[40:47], v217 abid:1
  v_exp_f32 v50, v50
  v_exp_f32 v51, v51
  v_exp_f32 v52, v52
  v_mfma_f32_32x32x16_bf16 v[0:15], v[104:107], v[230:233], v[0:15]
  v_exp_f32 v53, v53
  v_exp_f32 v54, v54
  v_exp_f32 v55, v55
  v_mfma_f32_32x32x16_bf16 v[16:31], v[108:111], v[230:233], v[16:31]
  v_exp_f32 v56, v56
  v_exp_f32 v57, v57
  v_exp_f32 v58, v58
  v_smfmac_f32_32x32x32_bf16 v[80:95], v[144:147], v[48:55], v217 abid:1
  v_exp_f32 v59, v59
  v_exp_f32 v60, v60
  v_exp_f32 v61, v61
  s_waitcnt lgkmcnt(0)
  s_barrier
  ds_read_b128 v[64:67], v219 offset:0
  ds_read_b128 v[68:71], v219 offset:1024
  ds_read_b64 v[72:73], v221 offset:2048
  ds_read_b32 v234, v255 offset:6144
  ds_read_b128 v[226:229], v254 offset:5120
  v_exp_f32 v62, v62
  v_exp_f32 v63, v63
  v_exp_f32 v0, v0
  v_exp_f32 v1, v1
  v_smfmac_f32_32x32x32_bf16 v[80:95], v[148:151], v[56:63], v217 abid:1
  v_exp_f32 v2, v2
  v_exp_f32 v3, v3
  v_exp_f32 v4, v4
  v_mfma_f32_32x32x4_2b_bf16 v[32:63], v[220:221], v[236:237], 0
  v_exp_f32 v5, v5
  v_exp_f32 v6, v6
  v_exp_f32 v7, v7
  v_exp_f32 v8, v8
  v_exp_f32 v9, v9
  v_exp_f32 v10, v10
  v_exp_f32 v11, v11
  v_exp_f32 v12, v12
  v_smfmac_f32_32x32x32_bf16 v[80:95], v[152:155], v[0:7], v217 abid:1
  v_exp_f32 v13, v13
  v_exp_f32 v14, v14
  v_exp_f32 v15, v15
  v_exp_f32 v16, v16
  v_exp_f32 v17, v17
  v_smfmac_f32_32x32x32_bf16 v[80:95], v[156:159], v[8:15], v217 abid:1
  v_exp_f32 v18, v18
  v_exp_f32 v19, v19
  v_exp_f32 v20, v20
  v_mfma_f32_32x32x16_bf16 v[32:47], v[112:115], v[230:233], v[32:47]
  v_exp_f32 v21, v21
  v_exp_f32 v22, v22
  v_exp_f32 v23, v23
  v_mfma_f32_32x32x16_bf16 v[48:63], v[116:119], v[230:233], v[48:63]
  v_exp_f32 v24, v24
  v_exp_f32 v25, v25
  v_exp_f32 v26, v26
  v_smfmac_f32_32x32x32_bf16 v[80:95], v[160:163], v[16:23], v217 abid:1
  v_exp_f32 v27, v27
  v_exp_f32 v28, v28
  v_exp_f32 v29, v29
  v_exp_f32 v30, v30
  v_exp_f32 v31, v31
  v_exp_f32 v32, v32
  v_exp_f32 v33, v33
  v_smfmac_f32_32x32x32_bf16 v[80:95], v[164:167], v[24:31], v217 abid:1
  v_exp_f32 v34, v34
  v_exp_f32 v35, v35
  v_exp_f32 v36, v36
  v_mfma_f32_32x32x4_2b_bf16 v[0:31], v[222:223], v[236:237], 0
  v_exp_f32 v37, v37
  v_exp_f32 v38, v38
  v_exp_f32 v39, v39
  v_exp_f32 v40, v40
  v_exp_f32 v41, v41
  v_exp_f32 v42, v42
  v_exp_f32 v43, v43
  v_exp_f32 v44, v44
  v_smfmac_f32_32x32x32_bf16 v[80:95], v[168:171], v[32:39], v217 abid:1
  v_exp_f32 v45, v45
  v_exp_f32 v46, v46
  v_exp_f32 v47, v47
  v_exp_f32 v48, v48
  v_exp_f32 v49, v49
  v_smfmac_f32_32x32x32_bf16 v[80:95], v[172:175], v[40:47], v217 abid:1
  v_exp_f32 v50, v50
  v_exp_f32 v51, v51
  v_exp_f32 v52, v52
  v_mfma_f32_32x32x16_bf16 v[0:15], v[120:123], v[230:233], v[0:15]
  v_exp_f32 v53, v53
  v_exp_f32 v54, v54
  v_exp_f32 v55, v55
  v_mfma_f32_32x32x16_bf16 v[16:31], v[124:127], v[230:233], v[16:31]
  v_exp_f32 v56, v56
  v_exp_f32 v57, v57
  v_exp_f32 v58, v58
  v_smfmac_f32_32x32x32_bf16 v[80:95], v[176:179], v[48:55], v217 abid:1
  v_exp_f32 v59, v59
  v_exp_f32 v60, v60
  v_exp_f32 v61, v61
  v_exp_f32 v62, v62
  v_exp_f32 v63, v63
  v_exp_f32 v0, v0
  v_exp_f32 v1, v1
  v_smfmac_f32_32x32x32_bf16 v[80:95], v[180:183], v[56:63], v217 abid:1
  v_exp_f32 v2, v2
  v_exp_f32 v3, v3
  v_exp_f32 v4, v4
  v_mfma_f32_32x32x4_2b_bf16 v[32:63], v[224:225], v[236:237], 0
  v_exp_f32 v5, v5
  v_exp_f32 v6, v6
  v_exp_f32 v7, v7
  v_exp_f32 v8, v8
  v_exp_f32 v9, v9
  v_exp_f32 v10, v10
  v_exp_f32 v11, v11
  v_exp_f32 v12, v12
  v_smfmac_f32_32x32x32_bf16 v[80:95], v[184:187], v[0:7], v217 abid:1
  v_exp_f32 v13, v13
  v_exp_f32 v14, v14
  v_exp_f32 v15, v15
  v_exp_f32 v16, v16
  v_exp_f32 v17, v17
  v_smfmac_f32_32x32x32_bf16 v[80:95], v[188:191], v[8:15], v217 abid:1
  v_exp_f32 v18, v18
  v_exp_f32 v19, v19
  v_exp_f32 v20, v20
  v_mfma_f32_32x32x16_bf16 v[32:47], v[128:131], v[230:233], v[32:47]
  v_exp_f32 v21, v21
  v_exp_f32 v22, v22
  v_exp_f32 v23, v23
  v_mfma_f32_32x32x16_bf16 v[48:63], v[132:135], v[230:233], v[48:63]
  v_exp_f32 v24, v24
  v_exp_f32 v25, v25
  v_exp_f32 v26, v26
  v_smfmac_f32_32x32x32_bf16 v[80:95], v[192:195], v[16:23], v217 abid:1
  v_exp_f32 v27, v27
  v_exp_f32 v28, v28
  v_exp_f32 v29, v29
  s_waitcnt lgkmcnt(0)
  v_exp_f32 v30, v30
  v_exp_f32 v31, v31
  v_exp_f32 v32, v32
  v_exp_f32 v33, v33
  v_smfmac_f32_32x32x32_bf16 v[80:95], v[196:199], v[24:31], v217 abid:1
  v_exp_f32 v34, v34
  v_exp_f32 v35, v35
  v_exp_f32 v36, v36
  v_mfma_f32_32x32x4_2b_bf16 v[0:31], v[216:217], v[234:235], 0
  v_exp_f32 v37, v37
  v_exp_f32 v38, v38
  v_exp_f32 v39, v39
  v_exp_f32 v40, v40
  v_exp_f32 v41, v41
  v_exp_f32 v42, v42
  v_exp_f32 v43, v43
  v_exp_f32 v44, v44
  v_smfmac_f32_32x32x32_bf16 v[80:95], v[200:203], v[32:39], v217 abid:1
  v_exp_f32 v45, v45
  v_exp_f32 v46, v46
  v_exp_f32 v47, v47
  v_exp_f32 v48, v48
  v_exp_f32 v49, v49
  v_smfmac_f32_32x32x32_bf16 v[80:95], v[204:207], v[40:47], v217 abid:1
  v_exp_f32 v50, v50
  v_exp_f32 v51, v51
  v_exp_f32 v52, v52
  v_mfma_f32_32x32x16_bf16 v[0:15], v[96:99], v[226:229], v[0:15]
  v_exp_f32 v53, v53
  v_exp_f32 v54, v54
  v_exp_f32 v55, v55
  v_mfma_f32_32x32x16_bf16 v[16:31], v[100:103], v[226:229], v[16:31]
  v_exp_f32 v56, v56
  v_exp_f32 v57, v57
  v_exp_f32 v58, v58
  v_smfmac_f32_32x32x32_bf16 v[80:95], v[208:211], v[48:55], v217 abid:1
  v_exp_f32 v59, v59
  v_exp_f32 v60, v60
  v_exp_f32 v61, v61
  v_exp_f32 v62, v62
  v_exp_f32 v63, v63
  v_exp_f32 v0, v0
  v_exp_f32 v1, v1
  v_smfmac_f32_32x32x32_bf16 v[80:95], v[212:215], v[56:63], v217 abid:1
  v_exp_f32 v2, v2
  v_exp_f32 v3, v3
  v_exp_f32 v4, v4
  v_mfma_f32_32x32x4_2b_bf16 v[32:63], v[218:219], v[234:235], 0
  v_exp_f32 v5, v5
  v_exp_f32 v6, v6
  v_exp_f32 v7, v7
  v_exp_f32 v8, v8
  v_exp_f32 v9, v9
  v_exp_f32 v10, v10
  v_exp_f32 v11, v11
  v_exp_f32 v12, v12
  v_smfmac_f32_32x32x32_bf16 v[64:79], v[136:139], v[0:7], v217 abid:1
  v_exp_f32 v13, v13
  v_exp_f32 v14, v14
  v_exp_f32 v15, v15
  ds_write_b128 v219, v[80:83] offset:30720
  ds_write_b128 v219, v[84:87] offset:31744
  ds_write_b64 v221, v[88:89] offset:32768
  v_exp_f32 v16, v16
  v_exp_f32 v17, v17
  v_smfmac_f32_32x32x32_bf16 v[64:79], v[140:143], v[8:15], v217 abid:1
  v_exp_f32 v18, v18
  v_exp_f32 v19, v19
  v_exp_f32 v20, v20
  v_mfma_f32_32x32x16_bf16 v[32:47], v[104:107], v[226:229], v[32:47]
  v_exp_f32 v21, v21
  v_exp_f32 v22, v22
  v_exp_f32 v23, v23
  v_mfma_f32_32x32x16_bf16 v[48:63], v[108:111], v[226:229], v[48:63]
  v_exp_f32 v24, v24
  v_exp_f32 v25, v25
  v_exp_f32 v26, v26
  v_smfmac_f32_32x32x32_bf16 v[64:79], v[144:147], v[16:23], v217 abid:1
  v_exp_f32 v27, v27
  v_exp_f32 v28, v28
  v_exp_f32 v29, v29
  s_waitcnt vmcnt(0)
  s_waitcnt lgkmcnt(0)
  s_barrier
  ds_read_b128 v[80:83], v219 offset:10240
  ds_read_b128 v[84:87], v219 offset:11264
  ds_read_b64 v[88:89], v221 offset:12288
  ds_read_b32 v236, v255 offset:7424
  ds_read_b128 v[230:233], v254 offset:6400
  v_exp_f32 v30, v30
  v_exp_f32 v31, v31
  v_exp_f32 v32, v32
  v_exp_f32 v33, v33
  v_smfmac_f32_32x32x32_bf16 v[64:79], v[148:151], v[24:31], v217 abid:1
  v_exp_f32 v34, v34
  v_exp_f32 v35, v35
  v_exp_f32 v36, v36
  v_mfma_f32_32x32x4_2b_bf16 v[0:31], v[220:221], v[234:235], 0
  v_exp_f32 v37, v37
  v_exp_f32 v38, v38
  v_exp_f32 v39, v39
  v_exp_f32 v40, v40
  v_exp_f32 v41, v41
  v_exp_f32 v42, v42
  v_exp_f32 v43, v43
  v_exp_f32 v44, v44
  v_smfmac_f32_32x32x32_bf16 v[64:79], v[152:155], v[32:39], v217 abid:1
  v_exp_f32 v45, v45
  v_exp_f32 v46, v46
  v_exp_f32 v47, v47
  v_exp_f32 v48, v48
  v_exp_f32 v49, v49
  v_smfmac_f32_32x32x32_bf16 v[64:79], v[156:159], v[40:47], v217 abid:1
  v_exp_f32 v50, v50
  v_exp_f32 v51, v51
  v_exp_f32 v52, v52
  v_mfma_f32_32x32x16_bf16 v[0:15], v[112:115], v[226:229], v[0:15]
  v_exp_f32 v53, v53
  v_exp_f32 v54, v54
  v_exp_f32 v55, v55
  v_mfma_f32_32x32x16_bf16 v[16:31], v[116:119], v[226:229], v[16:31]
  v_exp_f32 v56, v56
  v_exp_f32 v57, v57
  v_exp_f32 v58, v58
  v_smfmac_f32_32x32x32_bf16 v[64:79], v[160:163], v[48:55], v217 abid:1
  v_exp_f32 v59, v59
  v_exp_f32 v60, v60
  v_exp_f32 v61, v61
  v_exp_f32 v62, v62
  v_exp_f32 v63, v63
  v_exp_f32 v0, v0
  v_exp_f32 v1, v1
  v_smfmac_f32_32x32x32_bf16 v[64:79], v[164:167], v[56:63], v217 abid:1
  v_exp_f32 v2, v2
  v_exp_f32 v3, v3
  v_exp_f32 v4, v4
  v_mfma_f32_32x32x4_2b_bf16 v[32:63], v[222:223], v[234:235], 0
  v_exp_f32 v5, v5
  v_exp_f32 v6, v6
  v_exp_f32 v7, v7
  v_exp_f32 v8, v8
  v_exp_f32 v9, v9
  v_exp_f32 v10, v10
  v_exp_f32 v11, v11
  v_exp_f32 v12, v12
  v_smfmac_f32_32x32x32_bf16 v[64:79], v[168:171], v[0:7], v217 abid:1
  v_exp_f32 v13, v13
  v_exp_f32 v14, v14
  v_exp_f32 v15, v15
  v_exp_f32 v16, v16
  v_exp_f32 v17, v17
  v_smfmac_f32_32x32x32_bf16 v[64:79], v[172:175], v[8:15], v217 abid:1
  v_exp_f32 v18, v18
  v_exp_f32 v19, v19
  v_exp_f32 v20, v20
  v_mfma_f32_32x32x16_bf16 v[32:47], v[120:123], v[226:229], v[32:47]
  v_exp_f32 v21, v21
  v_exp_f32 v22, v22
  v_exp_f32 v23, v23
  v_mfma_f32_32x32x16_bf16 v[48:63], v[124:127], v[226:229], v[48:63]
  v_exp_f32 v24, v24
  v_exp_f32 v25, v25
  v_exp_f32 v26, v26
  v_smfmac_f32_32x32x32_bf16 v[64:79], v[176:179], v[16:23], v217 abid:1
  v_exp_f32 v27, v27
  v_exp_f32 v28, v28
  v_exp_f32 v29, v29
  v_exp_f32 v30, v30
  v_exp_f32 v31, v31
  v_exp_f32 v32, v32
  v_exp_f32 v33, v33
  v_smfmac_f32_32x32x32_bf16 v[64:79], v[180:183], v[24:31], v217 abid:1
  v_exp_f32 v34, v34
  v_exp_f32 v35, v35
  v_exp_f32 v36, v36
  v_mfma_f32_32x32x4_2b_bf16 v[0:31], v[224:225], v[234:235], 0
  v_exp_f32 v37, v37
  v_exp_f32 v38, v38
  v_exp_f32 v39, v39
  v_exp_f32 v40, v40
  v_exp_f32 v41, v41
  v_exp_f32 v42, v42
  v_exp_f32 v43, v43
  v_exp_f32 v44, v44
  v_smfmac_f32_32x32x32_bf16 v[64:79], v[184:187], v[32:39], v217 abid:1
  v_exp_f32 v45, v45
  v_exp_f32 v46, v46
  v_exp_f32 v47, v47
  v_exp_f32 v48, v48
  v_exp_f32 v49, v49
  v_smfmac_f32_32x32x32_bf16 v[64:79], v[188:191], v[40:47], v217 abid:1
  v_exp_f32 v50, v50
  v_exp_f32 v51, v51
  v_exp_f32 v52, v52
  v_mfma_f32_32x32x16_bf16 v[0:15], v[128:131], v[226:229], v[0:15]
  v_exp_f32 v53, v53
  v_exp_f32 v54, v54
  v_exp_f32 v55, v55
  v_mfma_f32_32x32x16_bf16 v[16:31], v[132:135], v[226:229], v[16:31]
  v_exp_f32 v56, v56
  v_exp_f32 v57, v57
  v_exp_f32 v58, v58
  v_smfmac_f32_32x32x32_bf16 v[64:79], v[192:195], v[48:55], v217 abid:1
  v_exp_f32 v59, v59
  v_exp_f32 v60, v60
  v_exp_f32 v61, v61
  s_waitcnt lgkmcnt(0)
  v_exp_f32 v62, v62
  v_exp_f32 v63, v63
  v_exp_f32 v0, v0
  v_exp_f32 v1, v1
  v_smfmac_f32_32x32x32_bf16 v[64:79], v[196:199], v[56:63], v217 abid:1
  v_exp_f32 v2, v2
  v_exp_f32 v3, v3
  v_exp_f32 v4, v4
  v_mfma_f32_32x32x4_2b_bf16 v[32:63], v[216:217], v[236:237], 0
  v_exp_f32 v5, v5
  v_exp_f32 v6, v6
  v_exp_f32 v7, v7
  v_exp_f32 v8, v8
  v_exp_f32 v9, v9
  v_exp_f32 v10, v10
  v_exp_f32 v11, v11
  v_exp_f32 v12, v12
  v_smfmac_f32_32x32x32_bf16 v[64:79], v[200:203], v[0:7], v217 abid:1
  v_exp_f32 v13, v13
  v_exp_f32 v14, v14
  v_exp_f32 v15, v15
  v_exp_f32 v16, v16
  v_exp_f32 v17, v17
  v_smfmac_f32_32x32x32_bf16 v[64:79], v[204:207], v[8:15], v217 abid:1
  v_exp_f32 v18, v18
  v_exp_f32 v19, v19
  v_exp_f32 v20, v20
  v_mfma_f32_32x32x16_bf16 v[32:47], v[96:99], v[230:233], v[32:47]
  v_exp_f32 v21, v21
  v_exp_f32 v22, v22
  v_exp_f32 v23, v23
  v_mfma_f32_32x32x16_bf16 v[48:63], v[100:103], v[230:233], v[48:63]
  v_exp_f32 v24, v24
  v_exp_f32 v25, v25
  v_exp_f32 v26, v26
  v_smfmac_f32_32x32x32_bf16 v[64:79], v[208:211], v[16:23], v217 abid:1
  v_exp_f32 v27, v27
  v_exp_f32 v28, v28
  v_exp_f32 v29, v29
  v_exp_f32 v30, v30
  v_exp_f32 v31, v31
  v_exp_f32 v32, v32
  v_exp_f32 v33, v33
  v_smfmac_f32_32x32x32_bf16 v[64:79], v[212:215], v[24:31], v217 abid:1
  v_exp_f32 v34, v34
  v_exp_f32 v35, v35
  v_exp_f32 v36, v36
  v_mfma_f32_32x32x4_2b_bf16 v[0:31], v[218:219], v[236:237], 0
  v_exp_f32 v37, v37
  v_exp_f32 v38, v38
  v_exp_f32 v39, v39
  v_exp_f32 v40, v40
  v_exp_f32 v41, v41
  v_exp_f32 v42, v42
  v_exp_f32 v43, v43
  v_exp_f32 v44, v44
  v_smfmac_f32_32x32x32_bf16 v[80:95], v[136:139], v[32:39], v217 abid:1
  v_exp_f32 v45, v45
  v_exp_f32 v46, v46
  v_exp_f32 v47, v47
  ds_write_b128 v219, v[64:67] offset:20480
  ds_write_b128 v219, v[68:71] offset:21504
  ds_write_b64 v221, v[72:73] offset:22528
  v_exp_f32 v48, v48
  v_exp_f32 v49, v49
  v_smfmac_f32_32x32x32_bf16 v[80:95], v[140:143], v[40:47], v217 abid:1
  v_exp_f32 v50, v50
  v_exp_f32 v51, v51
  v_exp_f32 v52, v52
  v_mfma_f32_32x32x16_bf16 v[0:15], v[104:107], v[230:233], v[0:15]
  v_exp_f32 v53, v53
  v_exp_f32 v54, v54
  v_exp_f32 v55, v55
  v_mfma_f32_32x32x16_bf16 v[16:31], v[108:111], v[230:233], v[16:31]
  v_exp_f32 v56, v56
  v_exp_f32 v57, v57
  v_exp_f32 v58, v58
  v_smfmac_f32_32x32x32_bf16 v[80:95], v[144:147], v[48:55], v217 abid:1
  v_exp_f32 v59, v59
  v_exp_f32 v60, v60
  v_exp_f32 v61, v61
  s_waitcnt lgkmcnt(0)
  s_barrier
  ds_read_b128 v[64:67], v219 offset:0
  ds_read_b128 v[68:71], v219 offset:1024
  ds_read_b64 v[72:73], v221 offset:2048
  ds_read_b32 v234, v255 offset:8704
  ds_read_b128 v[226:229], v254 offset:7680
  v_exp_f32 v62, v62
  v_exp_f32 v63, v63
  v_exp_f32 v0, v0
  v_exp_f32 v1, v1
  v_smfmac_f32_32x32x32_bf16 v[80:95], v[148:151], v[56:63], v217 abid:1
  v_exp_f32 v2, v2
  v_exp_f32 v3, v3
  v_exp_f32 v4, v4
  v_mfma_f32_32x32x4_2b_bf16 v[32:63], v[220:221], v[236:237], 0
  v_exp_f32 v5, v5
  v_exp_f32 v6, v6
  v_exp_f32 v7, v7
  v_exp_f32 v8, v8
  v_exp_f32 v9, v9
  v_exp_f32 v10, v10
  v_exp_f32 v11, v11
  v_exp_f32 v12, v12
  v_smfmac_f32_32x32x32_bf16 v[80:95], v[152:155], v[0:7], v217 abid:1
  v_exp_f32 v13, v13
  v_exp_f32 v14, v14
  v_exp_f32 v15, v15
  v_exp_f32 v16, v16
  v_exp_f32 v17, v17
  v_smfmac_f32_32x32x32_bf16 v[80:95], v[156:159], v[8:15], v217 abid:1
  v_exp_f32 v18, v18
  v_exp_f32 v19, v19
  v_exp_f32 v20, v20
  v_mfma_f32_32x32x16_bf16 v[32:47], v[112:115], v[230:233], v[32:47]
  v_exp_f32 v21, v21
  v_exp_f32 v22, v22
  v_exp_f32 v23, v23
  v_mfma_f32_32x32x16_bf16 v[48:63], v[116:119], v[230:233], v[48:63]
  v_exp_f32 v24, v24
  v_exp_f32 v25, v25
  v_exp_f32 v26, v26
  v_smfmac_f32_32x32x32_bf16 v[80:95], v[160:163], v[16:23], v217 abid:1
  v_exp_f32 v27, v27
  v_exp_f32 v28, v28
  v_exp_f32 v29, v29
  v_exp_f32 v30, v30
  v_exp_f32 v31, v31
  v_exp_f32 v32, v32
  v_exp_f32 v33, v33
  v_smfmac_f32_32x32x32_bf16 v[80:95], v[164:167], v[24:31], v217 abid:1
  v_exp_f32 v34, v34
  v_exp_f32 v35, v35
  v_exp_f32 v36, v36
  v_mfma_f32_32x32x4_2b_bf16 v[0:31], v[222:223], v[236:237], 0
  v_exp_f32 v37, v37
  v_exp_f32 v38, v38
  v_exp_f32 v39, v39
  v_exp_f32 v40, v40
  v_exp_f32 v41, v41
  v_exp_f32 v42, v42
  v_exp_f32 v43, v43
  v_exp_f32 v44, v44
  v_smfmac_f32_32x32x32_bf16 v[80:95], v[168:171], v[32:39], v217 abid:1
  v_exp_f32 v45, v45
  v_exp_f32 v46, v46
  v_exp_f32 v47, v47
  v_exp_f32 v48, v48
  v_exp_f32 v49, v49
  v_smfmac_f32_32x32x32_bf16 v[80:95], v[172:175], v[40:47], v217 abid:1
  v_exp_f32 v50, v50
  v_exp_f32 v51, v51
  v_exp_f32 v52, v52
  v_mfma_f32_32x32x16_bf16 v[0:15], v[120:123], v[230:233], v[0:15]
  v_exp_f32 v53, v53
  v_exp_f32 v54, v54
  v_exp_f32 v55, v55
  v_mfma_f32_32x32x16_bf16 v[16:31], v[124:127], v[230:233], v[16:31]
  v_exp_f32 v56, v56
  v_exp_f32 v57, v57
  v_exp_f32 v58, v58
  v_smfmac_f32_32x32x32_bf16 v[80:95], v[176:179], v[48:55], v217 abid:1
  v_exp_f32 v59, v59
  v_exp_f32 v60, v60
  v_exp_f32 v61, v61
  v_exp_f32 v62, v62
  v_exp_f32 v63, v63
  v_exp_f32 v0, v0
  v_exp_f32 v1, v1
  v_smfmac_f32_32x32x32_bf16 v[80:95], v[180:183], v[56:63], v217 abid:1
  v_exp_f32 v2, v2
  v_exp_f32 v3, v3
  v_exp_f32 v4, v4
  v_mfma_f32_32x32x4_2b_bf16 v[32:63], v[224:225], v[236:237], 0
  v_exp_f32 v5, v5
  v_exp_f32 v6, v6
  v_exp_f32 v7, v7
  v_exp_f32 v8, v8
  v_exp_f32 v9, v9
  v_exp_f32 v10, v10
  v_exp_f32 v11, v11
  v_exp_f32 v12, v12
  v_smfmac_f32_32x32x32_bf16 v[80:95], v[184:187], v[0:7], v217 abid:1
  v_exp_f32 v13, v13
  v_exp_f32 v14, v14
  v_exp_f32 v15, v15
  v_exp_f32 v16, v16
  v_exp_f32 v17, v17
  v_smfmac_f32_32x32x32_bf16 v[80:95], v[188:191], v[8:15], v217 abid:1
  v_exp_f32 v18, v18
  v_exp_f32 v19, v19
  v_exp_f32 v20, v20
  v_mfma_f32_32x32x16_bf16 v[32:47], v[128:131], v[230:233], v[32:47]
  v_exp_f32 v21, v21
  v_exp_f32 v22, v22
  v_exp_f32 v23, v23
  v_mfma_f32_32x32x16_bf16 v[48:63], v[132:135], v[230:233], v[48:63]
  v_exp_f32 v24, v24
  v_exp_f32 v25, v25
  v_exp_f32 v26, v26
  v_smfmac_f32_32x32x32_bf16 v[80:95], v[192:195], v[16:23], v217 abid:1
  v_exp_f32 v27, v27
  v_exp_f32 v28, v28
  v_exp_f32 v29, v29
  s_waitcnt lgkmcnt(0)
  v_exp_f32 v30, v30
  v_exp_f32 v31, v31
  v_exp_f32 v32, v32
  v_exp_f32 v33, v33
  v_smfmac_f32_32x32x32_bf16 v[80:95], v[196:199], v[24:31], v217 abid:1
  v_exp_f32 v34, v34
  v_exp_f32 v35, v35
  v_exp_f32 v36, v36
  v_mfma_f32_32x32x4_2b_bf16 v[0:31], v[216:217], v[234:235], 0
  v_exp_f32 v37, v37
  v_exp_f32 v38, v38
  v_exp_f32 v39, v39
  v_exp_f32 v40, v40
  v_exp_f32 v41, v41
  v_exp_f32 v42, v42
  v_exp_f32 v43, v43
  v_exp_f32 v44, v44
  v_smfmac_f32_32x32x32_bf16 v[80:95], v[200:203], v[32:39], v217 abid:1
  v_exp_f32 v45, v45
  v_exp_f32 v46, v46
  v_exp_f32 v47, v47
  v_exp_f32 v48, v48
  v_exp_f32 v49, v49
  v_smfmac_f32_32x32x32_bf16 v[80:95], v[204:207], v[40:47], v217 abid:1
  v_exp_f32 v50, v50
  v_exp_f32 v51, v51
  v_exp_f32 v52, v52
  v_mfma_f32_32x32x16_bf16 v[0:15], v[96:99], v[226:229], v[0:15]
  v_exp_f32 v53, v53
  v_exp_f32 v54, v54
  v_exp_f32 v55, v55
  v_mfma_f32_32x32x16_bf16 v[16:31], v[100:103], v[226:229], v[16:31]
  v_exp_f32 v56, v56
  v_exp_f32 v57, v57
  v_exp_f32 v58, v58
  v_smfmac_f32_32x32x32_bf16 v[80:95], v[208:211], v[48:55], v217 abid:1
  v_exp_f32 v59, v59
  v_exp_f32 v60, v60
  v_exp_f32 v61, v61
  v_exp_f32 v62, v62
  v_exp_f32 v63, v63
  v_exp_f32 v0, v0
  v_exp_f32 v1, v1
  v_smfmac_f32_32x32x32_bf16 v[80:95], v[212:215], v[56:63], v217 abid:1
  v_exp_f32 v2, v2
  v_exp_f32 v3, v3
  v_exp_f32 v4, v4
  v_mfma_f32_32x32x4_2b_bf16 v[32:63], v[218:219], v[234:235], 0
  v_exp_f32 v5, v5
  v_exp_f32 v6, v6
  v_exp_f32 v7, v7
  v_exp_f32 v8, v8
  v_exp_f32 v9, v9
  v_exp_f32 v10, v10
  v_exp_f32 v11, v11
  v_exp_f32 v12, v12
  v_smfmac_f32_32x32x32_bf16 v[64:79], v[136:139], v[0:7], v217 abid:1
  v_exp_f32 v13, v13
  v_exp_f32 v14, v14
  v_exp_f32 v15, v15
  ds_write_b128 v219, v[80:83] offset:30720
  ds_write_b128 v219, v[84:87] offset:31744
  ds_write_b64 v221, v[88:89] offset:32768
  v_exp_f32 v16, v16
  v_exp_f32 v17, v17
  v_smfmac_f32_32x32x32_bf16 v[64:79], v[140:143], v[8:15], v217 abid:1
  v_exp_f32 v18, v18
  v_exp_f32 v19, v19
  v_exp_f32 v20, v20
  v_mfma_f32_32x32x16_bf16 v[32:47], v[104:107], v[226:229], v[32:47]
  v_exp_f32 v21, v21
  v_exp_f32 v22, v22
  v_exp_f32 v23, v23
  v_mfma_f32_32x32x16_bf16 v[48:63], v[108:111], v[226:229], v[48:63]
  v_exp_f32 v24, v24
  v_exp_f32 v25, v25
  v_exp_f32 v26, v26
  v_smfmac_f32_32x32x32_bf16 v[64:79], v[144:147], v[16:23], v217 abid:1
  v_exp_f32 v27, v27
  v_exp_f32 v28, v28
  v_exp_f32 v29, v29
  s_waitcnt lgkmcnt(0)
  s_barrier
  v_exp_f32 v30, v30
  v_exp_f32 v31, v31
  v_exp_f32 v32, v32
  v_exp_f32 v33, v33
  v_smfmac_f32_32x32x32_bf16 v[64:79], v[148:151], v[24:31], v217 abid:1
  v_exp_f32 v34, v34
  v_exp_f32 v35, v35
  v_exp_f32 v36, v36
  v_mfma_f32_32x32x4_2b_bf16 v[0:31], v[220:221], v[234:235], 0
  v_exp_f32 v37, v37
  v_exp_f32 v38, v38
  v_exp_f32 v39, v39
  v_exp_f32 v40, v40
  v_exp_f32 v41, v41
  v_exp_f32 v42, v42
  v_exp_f32 v43, v43
  v_exp_f32 v44, v44
  v_smfmac_f32_32x32x32_bf16 v[64:79], v[152:155], v[32:39], v217 abid:1
  v_exp_f32 v45, v45
  v_exp_f32 v46, v46
  v_exp_f32 v47, v47
  v_exp_f32 v48, v48
  v_exp_f32 v49, v49
  v_smfmac_f32_32x32x32_bf16 v[64:79], v[156:159], v[40:47], v217 abid:1
  v_exp_f32 v50, v50
  v_exp_f32 v51, v51
  v_exp_f32 v52, v52
  v_mfma_f32_32x32x16_bf16 v[0:15], v[112:115], v[226:229], v[0:15]
  v_exp_f32 v53, v53
  v_exp_f32 v54, v54
  v_exp_f32 v55, v55
  v_mfma_f32_32x32x16_bf16 v[16:31], v[116:119], v[226:229], v[16:31]
  v_exp_f32 v56, v56
  v_exp_f32 v57, v57
  v_exp_f32 v58, v58
  v_smfmac_f32_32x32x32_bf16 v[64:79], v[160:163], v[48:55], v217 abid:1
  v_exp_f32 v59, v59
  v_exp_f32 v60, v60
  v_exp_f32 v61, v61
  ds_read_b128 v[80:83], v219 offset:10240
  ds_read_b128 v[84:87], v219 offset:11264
  ds_read_b64 v[88:89], v221 offset:12288
  ds_read_b32 v236, v255 offset:9984
  ds_read_b128 v[230:233], v254 offset:8960
  v_exp_f32 v62, v62
  v_exp_f32 v63, v63
  v_exp_f32 v0, v0
  v_exp_f32 v1, v1
  v_smfmac_f32_32x32x32_bf16 v[64:79], v[164:167], v[56:63], v217 abid:1
  v_exp_f32 v2, v2
  v_exp_f32 v3, v3
  v_exp_f32 v4, v4
  v_mfma_f32_32x32x4_2b_bf16 v[32:63], v[222:223], v[234:235], 0
  v_exp_f32 v5, v5
  v_exp_f32 v6, v6
  v_exp_f32 v7, v7
  v_exp_f32 v8, v8
  v_exp_f32 v9, v9
  v_exp_f32 v10, v10
  v_exp_f32 v11, v11
  v_exp_f32 v12, v12
  v_smfmac_f32_32x32x32_bf16 v[64:79], v[168:171], v[0:7], v217 abid:1
  v_exp_f32 v13, v13
  v_exp_f32 v14, v14
  v_exp_f32 v15, v15
  v_exp_f32 v16, v16
  v_exp_f32 v17, v17
  v_smfmac_f32_32x32x32_bf16 v[64:79], v[172:175], v[8:15], v217 abid:1
  v_exp_f32 v18, v18
  v_exp_f32 v19, v19
  v_exp_f32 v20, v20
  v_mfma_f32_32x32x16_bf16 v[32:47], v[120:123], v[226:229], v[32:47]
  v_exp_f32 v21, v21
  v_exp_f32 v22, v22
  v_exp_f32 v23, v23
  v_mfma_f32_32x32x16_bf16 v[48:63], v[124:127], v[226:229], v[48:63]
  v_exp_f32 v24, v24
  v_exp_f32 v25, v25
  v_exp_f32 v26, v26
  v_smfmac_f32_32x32x32_bf16 v[64:79], v[176:179], v[16:23], v217 abid:1
  v_exp_f32 v27, v27
  v_exp_f32 v28, v28
  v_exp_f32 v29, v29
  v_exp_f32 v30, v30
  v_exp_f32 v31, v31
  v_exp_f32 v32, v32
  v_exp_f32 v33, v33
  v_smfmac_f32_32x32x32_bf16 v[64:79], v[180:183], v[24:31], v217 abid:1
  v_exp_f32 v34, v34
  v_exp_f32 v35, v35
  v_exp_f32 v36, v36
  v_mfma_f32_32x32x4_2b_bf16 v[0:31], v[224:225], v[234:235], 0
  v_exp_f32 v37, v37
  v_exp_f32 v38, v38
  v_exp_f32 v39, v39
  v_exp_f32 v40, v40
  v_exp_f32 v41, v41
  v_exp_f32 v42, v42
  v_exp_f32 v43, v43
  v_exp_f32 v44, v44
  v_smfmac_f32_32x32x32_bf16 v[64:79], v[184:187], v[32:39], v217 abid:1
  v_exp_f32 v45, v45
  v_exp_f32 v46, v46
  v_exp_f32 v47, v47
  v_exp_f32 v48, v48
  v_exp_f32 v49, v49
  v_smfmac_f32_32x32x32_bf16 v[64:79], v[188:191], v[40:47], v217 abid:1
  v_exp_f32 v50, v50
  v_exp_f32 v51, v51
  v_exp_f32 v52, v52
  v_mfma_f32_32x32x16_bf16 v[0:15], v[128:131], v[226:229], v[0:15]
  v_exp_f32 v53, v53
  v_exp_f32 v54, v54
  v_exp_f32 v55, v55
  v_mfma_f32_32x32x16_bf16 v[16:31], v[132:135], v[226:229], v[16:31]
  v_exp_f32 v56, v56
  v_exp_f32 v57, v57
  v_exp_f32 v58, v58
  v_smfmac_f32_32x32x32_bf16 v[64:79], v[192:195], v[48:55], v217 abid:1
  v_exp_f32 v59, v59
  v_exp_f32 v60, v60
  v_exp_f32 v61, v61
  s_waitcnt lgkmcnt(0)
  v_exp_f32 v62, v62
  v_exp_f32 v63, v63
  v_exp_f32 v0, v0
  v_exp_f32 v1, v1
  v_smfmac_f32_32x32x32_bf16 v[64:79], v[196:199], v[56:63], v217 abid:1
  v_exp_f32 v2, v2
  v_exp_f32 v3, v3
  v_exp_f32 v4, v4
  v_mfma_f32_32x32x4_2b_bf16 v[32:63], v[216:217], v[236:237], 0
  v_exp_f32 v5, v5
  v_exp_f32 v6, v6
  v_exp_f32 v7, v7
  v_exp_f32 v8, v8
  v_exp_f32 v9, v9
  v_exp_f32 v10, v10
  v_exp_f32 v11, v11
  v_exp_f32 v12, v12
  v_smfmac_f32_32x32x32_bf16 v[64:79], v[200:203], v[0:7], v217 abid:1
  v_exp_f32 v13, v13
  v_exp_f32 v14, v14
  v_exp_f32 v15, v15
  v_exp_f32 v16, v16
  v_exp_f32 v17, v17
  v_smfmac_f32_32x32x32_bf16 v[64:79], v[204:207], v[8:15], v217 abid:1
  v_exp_f32 v18, v18
  v_exp_f32 v19, v19
  v_exp_f32 v20, v20
  v_mfma_f32_32x32x16_bf16 v[32:47], v[96:99], v[230:233], v[32:47]
  v_exp_f32 v21, v21
  v_exp_f32 v22, v22
  v_exp_f32 v23, v23
  v_mfma_f32_32x32x16_bf16 v[48:63], v[100:103], v[230:233], v[48:63]
  v_exp_f32 v24, v24
  v_exp_f32 v25, v25
  v_exp_f32 v26, v26
  v_smfmac_f32_32x32x32_bf16 v[64:79], v[208:211], v[16:23], v217 abid:1
  v_exp_f32 v27, v27
  v_exp_f32 v28, v28
  v_exp_f32 v29, v29
  v_exp_f32 v30, v30
  v_exp_f32 v31, v31
  v_exp_f32 v32, v32
  v_exp_f32 v33, v33
  v_smfmac_f32_32x32x32_bf16 v[64:79], v[212:215], v[24:31], v217 abid:1
  v_exp_f32 v34, v34
  v_exp_f32 v35, v35
  v_exp_f32 v36, v36
  v_mfma_f32_32x32x4_2b_bf16 v[0:31], v[218:219], v[236:237], 0
  v_exp_f32 v37, v37
  v_exp_f32 v38, v38
  v_exp_f32 v39, v39
  v_exp_f32 v40, v40
  v_exp_f32 v41, v41
  v_exp_f32 v42, v42
  v_exp_f32 v43, v43
  v_exp_f32 v44, v44
  v_smfmac_f32_32x32x32_bf16 v[80:95], v[136:139], v[32:39], v217 abid:1
  v_exp_f32 v45, v45
  v_exp_f32 v46, v46
  v_exp_f32 v47, v47
  ds_write_b128 v219, v[64:67] offset:20480
  ds_write_b128 v219, v[68:71] offset:21504
  ds_write_b64 v221, v[72:73] offset:22528
  v_exp_f32 v48, v48
  v_exp_f32 v49, v49
  v_smfmac_f32_32x32x32_bf16 v[80:95], v[140:143], v[40:47], v217 abid:1
  v_exp_f32 v50, v50
  v_exp_f32 v51, v51
  v_exp_f32 v52, v52
  v_mfma_f32_32x32x16_bf16 v[0:15], v[104:107], v[230:233], v[0:15]
  v_exp_f32 v53, v53
  v_exp_f32 v54, v54
  v_exp_f32 v55, v55
  v_mfma_f32_32x32x16_bf16 v[16:31], v[108:111], v[230:233], v[16:31]
  v_exp_f32 v56, v56
  v_exp_f32 v57, v57
  v_exp_f32 v58, v58
  v_smfmac_f32_32x32x32_bf16 v[80:95], v[144:147], v[48:55], v217 abid:1
  v_exp_f32 v59, v59
  v_exp_f32 v60, v60
  v_exp_f32 v61, v61
  s_waitcnt lgkmcnt(0)
  s_barrier
  v_exp_f32 v62, v62
  v_exp_f32 v63, v63
  v_exp_f32 v0, v0
  v_exp_f32 v1, v1
  v_smfmac_f32_32x32x32_bf16 v[80:95], v[148:151], v[56:63], v217 abid:1
  v_exp_f32 v2, v2
  v_exp_f32 v3, v3
  v_exp_f32 v4, v4
  v_mfma_f32_32x32x4_2b_bf16 v[32:63], v[220:221], v[236:237], 0
  v_exp_f32 v5, v5
  v_exp_f32 v6, v6
  v_exp_f32 v7, v7
  v_exp_f32 v8, v8
  v_exp_f32 v9, v9
  v_exp_f32 v10, v10
  v_exp_f32 v11, v11
  v_exp_f32 v12, v12
  v_smfmac_f32_32x32x32_bf16 v[80:95], v[152:155], v[0:7], v217 abid:1
  v_exp_f32 v13, v13
  v_exp_f32 v14, v14
  v_exp_f32 v15, v15
  v_exp_f32 v16, v16
  v_exp_f32 v17, v17
  v_smfmac_f32_32x32x32_bf16 v[80:95], v[156:159], v[8:15], v217 abid:1
  v_exp_f32 v18, v18
  v_exp_f32 v19, v19
  v_exp_f32 v20, v20
  v_mfma_f32_32x32x16_bf16 v[32:47], v[112:115], v[230:233], v[32:47]
  v_exp_f32 v21, v21
  v_exp_f32 v22, v22
  v_exp_f32 v23, v23
  v_mfma_f32_32x32x16_bf16 v[48:63], v[116:119], v[230:233], v[48:63]
  v_exp_f32 v24, v24
  v_exp_f32 v25, v25
  v_exp_f32 v26, v26
  v_smfmac_f32_32x32x32_bf16 v[80:95], v[160:163], v[16:23], v217 abid:1
  v_exp_f32 v27, v27
  v_exp_f32 v28, v28
  v_exp_f32 v29, v29
  v_exp_f32 v30, v30
  v_exp_f32 v31, v31
  v_exp_f32 v32, v32
  v_exp_f32 v33, v33
  v_smfmac_f32_32x32x32_bf16 v[80:95], v[164:167], v[24:31], v217 abid:1
  v_exp_f32 v34, v34
  v_exp_f32 v35, v35
  v_exp_f32 v36, v36
  v_mfma_f32_32x32x4_2b_bf16 v[0:31], v[222:223], v[236:237], 0
  v_exp_f32 v37, v37
  v_exp_f32 v38, v38
  v_exp_f32 v39, v39
  v_exp_f32 v40, v40
  v_exp_f32 v41, v41
  v_exp_f32 v42, v42
  v_exp_f32 v43, v43
  v_exp_f32 v44, v44
  v_smfmac_f32_32x32x32_bf16 v[80:95], v[168:171], v[32:39], v217 abid:1
  v_exp_f32 v45, v45
  v_exp_f32 v46, v46
  v_exp_f32 v47, v47
  v_exp_f32 v48, v48
  v_exp_f32 v49, v49
  v_smfmac_f32_32x32x32_bf16 v[80:95], v[172:175], v[40:47], v217 abid:1
  v_exp_f32 v50, v50
  v_exp_f32 v51, v51
  v_exp_f32 v52, v52
  v_mfma_f32_32x32x16_bf16 v[0:15], v[120:123], v[230:233], v[0:15]
  v_exp_f32 v53, v53
  v_exp_f32 v54, v54
  v_exp_f32 v55, v55
  v_mfma_f32_32x32x16_bf16 v[16:31], v[124:127], v[230:233], v[16:31]
  v_exp_f32 v56, v56
  v_exp_f32 v57, v57
  v_exp_f32 v58, v58
  v_smfmac_f32_32x32x32_bf16 v[80:95], v[176:179], v[48:55], v217 abid:1
  v_exp_f32 v59, v59
  v_exp_f32 v60, v60
  v_exp_f32 v61, v61
  v_exp_f32 v62, v62
  v_exp_f32 v63, v63
  v_exp_f32 v0, v0
  v_exp_f32 v1, v1
  v_smfmac_f32_32x32x32_bf16 v[80:95], v[180:183], v[56:63], v217 abid:1
  v_exp_f32 v2, v2
  v_exp_f32 v3, v3
  v_exp_f32 v4, v4
  v_mfma_f32_32x32x4_2b_bf16 v[32:63], v[224:225], v[236:237], 0
  v_exp_f32 v5, v5
  v_exp_f32 v6, v6
  v_exp_f32 v7, v7
  v_exp_f32 v8, v8
  v_exp_f32 v9, v9
  v_exp_f32 v10, v10
  v_exp_f32 v11, v11
  v_exp_f32 v12, v12
  v_smfmac_f32_32x32x32_bf16 v[80:95], v[184:187], v[0:7], v217 abid:1
  v_exp_f32 v13, v13
  v_exp_f32 v14, v14
  v_exp_f32 v15, v15
  v_exp_f32 v16, v16
  v_exp_f32 v17, v17
  v_smfmac_f32_32x32x32_bf16 v[80:95], v[188:191], v[8:15], v217 abid:1
  v_exp_f32 v18, v18
  v_exp_f32 v19, v19
  v_exp_f32 v20, v20
  v_mfma_f32_32x32x16_bf16 v[32:47], v[128:131], v[230:233], v[32:47]
  v_exp_f32 v21, v21
  v_exp_f32 v22, v22
  v_exp_f32 v23, v23
  v_mfma_f32_32x32x16_bf16 v[48:63], v[132:135], v[230:233], v[48:63]
  v_exp_f32 v24, v24
  v_exp_f32 v25, v25
  v_exp_f32 v26, v26
  v_smfmac_f32_32x32x32_bf16 v[80:95], v[192:195], v[16:23], v217 abid:1
  v_exp_f32 v27, v27
  v_exp_f32 v28, v28
  v_exp_f32 v29, v29
  v_exp_f32 v30, v30
  v_exp_f32 v31, v31
  v_exp_f32 v32, v32
  v_exp_f32 v33, v33
  v_smfmac_f32_32x32x32_bf16 v[80:95], v[196:199], v[24:31], v217 abid:1
  v_exp_f32 v34, v34
  v_exp_f32 v35, v35
  v_exp_f32 v36, v36
  v_exp_f32 v37, v37
  v_exp_f32 v38, v38
  v_exp_f32 v39, v39
  v_exp_f32 v40, v40
  v_exp_f32 v41, v41
  v_exp_f32 v42, v42
  v_exp_f32 v43, v43
  v_exp_f32 v44, v44
  v_smfmac_f32_32x32x32_bf16 v[80:95], v[200:203], v[32:39], v217 abid:1
  v_exp_f32 v45, v45
  v_exp_f32 v46, v46
  v_exp_f32 v47, v47
  v_exp_f32 v48, v48
  v_exp_f32 v49, v49
  v_smfmac_f32_32x32x32_bf16 v[80:95], v[204:207], v[40:47], v217 abid:1
  v_exp_f32 v50, v50
  v_exp_f32 v51, v51
  v_exp_f32 v52, v52
  v_exp_f32 v53, v53
  v_exp_f32 v54, v54
  v_exp_f32 v55, v55
  v_exp_f32 v56, v56
  v_exp_f32 v57, v57
  v_exp_f32 v58, v58
  v_smfmac_f32_32x32x32_bf16 v[80:95], v[208:211], v[48:55], v217 abid:1
  v_exp_f32 v59, v59
  v_exp_f32 v60, v60
  v_exp_f32 v61, v61
  v_exp_f32 v62, v62
  v_exp_f32 v63, v63
  s_nop 1
  v_smfmac_f32_32x32x32_bf16 v[80:95], v[212:215], v[56:63], v217 abid:1
  s_nop 11
  ds_write_b128 v219, v[80:83] offset:30720
  ds_write_b128 v219, v[84:87] offset:31744
  ds_write_b64 v221, v[88:89] offset:32768
  s_waitcnt lgkmcnt(0)
  s_barrier
  v_lshrrev_b32 v0, 4, v239
  s_cmp_ge_u32 s2, 144
  s_cbranch_scc1 K2_NOPREP
  v_lshrrev_b32 v1, 4, v0
  v_bfe_u32 v3, v0, 1, 1
  v_and_b32 v7, 7, v0
  v_lshrrev_b32 v2, 3, v0
  v_mul_u32_u24 v4, 1152, v2
  v_and_b32 v5, 4, v2
  v_xor_b32 v5, v5, v7
  v_lshl_add_u32 v4, v5, 4, v4
  s_add_u32 m0, s72, 114816
  s_nop 0
  buffer_load_dwordx4 v4, s[28:31], s73 offen offset:0 lds
  s_add_u32 m0, s72, 115712
  s_nop 0
  buffer_load_dwordx4 v4, s[28:31], s73 offen offset:128 lds
  s_add_u32 m0, s72, 116608
  s_nop 0
  buffer_load_dwordx4 v4, s[28:31], s73 offen offset:256 lds
  s_add_u32 m0, s72, 117504
  s_nop 0
  buffer_load_dwordx4 v4, s[28:31], s73 offen offset:384 lds
  s_add_u32 m0, s72, 118400
  s_nop 0
  buffer_load_dwordx4 v4, s[28:31], s73 offen offset:512 lds
  s_add_u32 m0, s72, 119296
  s_nop 0
  buffer_load_dwordx4 v4, s[28:31], s73 offen offset:640 lds
  s_add_u32 m0, s72, 120192
  s_nop 0
  buffer_load_dwordx4 v4, s[28:31], s73 offen offset:768 lds
  s_add_u32 m0, s72, 121088
  s_nop 0
  buffer_load_dwordx4 v4, s[28:31], s73 offen offset:896 lds
  s_add_u32 m0, s72, 121984
  s_nop 0
  buffer_load_dwordx4 v4, s[28:31], s73 offen offset:1024 lds
  v_mul_u32_u24 v5, 0xaaaa, v3
  v_mul_u32_u24 v6, 0x5555, v3
  v_lshl_or_b32 v5, v6, 16, v5
  v_add_u32 v73, 0x88884444, v5
  v_and_b32 v6, 1, v2
  v_lshl_add_u32 v5, v1, 2, v6
  v_lshlrev_b32 v82, 4, v5
  v_lshlrev_b32 v5, 6, v2
  v_lshl_add_u32 v5, v7, 1, v5
  v_lshl_add_u32 v83, s6, 4, v5
  v_bfe_u32 v5, v0, 2, 2
  v_and_b32 v6, 1, v0
  v_lshl_add_u32 v5, v5, 1, v6
  v_lshlrev_b32 v5, 6, v5
  v_lshl_add_u32 v84, v1, 4, v5
  v_bfe_i32 v51, v0, 2, 1
  v_bfe_i32 v52, v0, 1, 1
  v_bfe_i32 v53, v0, 0, 1
  v_xor_b32 v52, v52, v51
  v_xor_b32 v53, v53, v51
  v_not_b32 v48, v51
  v_not_b32 v49, v52
  v_not_b32 v50, v53
  v_bfe_i32 v5, v0, 4, 1
  v_xor_b32 v57, v5, v48
  v_xor_b32 v58, v5, v49
  v_xor_b32 v59, v5, v50
  v_lshlrev_b32 v69, 2, v0
  v_and_b32 v87, 0x7c, v69
  v_lshlrev_b32 v70, 4, v0
  v_lshlrev_b32 v71, 5, v1
  v_lshl_add_u32 v71, v3, 4, v71
  v_add_u32 v72, s68, v70
K2_NOPREP:
  s_cmp_lg_u32 s3, 4
  s_cbranch_scc1 K2_T1B
  v_add_u32 v1, 161920, v239
  v_mov_b32 v20, 0
  v_mov_b32 v21, 0
  v_mov_b32 v22, 0
  v_mov_b32 v23, 0
  ds_read_b128 v[16:19], v1
  s_mov_b64 exec, 0xff
  ds_read_b128 v[20:23], v1 offset:1024
  s_mov_b64 exec, -1
  v_mov_b32 v24, 0x3f803f80
  v_mov_b32 v25, 0x3f803f80
  v_mov_b32 v26, 0x3f803f80
  v_mov_b32 v27, 0x3f803f80
  v_lshrrev_b32 v1, 3, v0
  v_and_b32 v2, 7, v0
  s_waitcnt lgkmcnt(0)
  v_mfma_f32_16x16x32_bf16 v[12:15], v[24:27], v[16:19], 0
  v_mfma_f32_16x16x32_bf16 v[12:15], v[24:27], v[20:23], v[12:15]
  v_lshlrev_b32 v3, 4, v1
  v_lshlrev_b32 v4, 4, v2
  v_sub_u32 v5, s38, v1
  v_sub_u32 v6, s38, v2
  v_and_b32 v10, 0x30, v0
  v_and_b32 v11, 1, v1
  v_lshl_add_u32 v10, v11, 2, v10
  v_add_u32 v10, 19456, v10
  v_lshlrev_b32 v11, 11, v1
  v_add_f32_dpp v12, v12, v12 row_ror:8 row_mask:0xf bank_mask:0xf
  s_nop 1
  v_add_f32_dpp v12, v12, v12 row_ror:4 row_mask:0xf bank_mask:0xf
  s_nop 1
  v_add_f32_dpp v12, v12, v12 row_ror:2 row_mask:0xf bank_mask:0xf
  s_nop 1
  v_add_f32_dpp v12, v12, v12 row_ror:1 row_mask:0xf bank_mask:0xf
  v_mov_b32 v14, 0x3ae38e39
  s_movk_i32 s25, 0x7ff
  s_brev_b32 s26, 1
  s_setprio 3
  s_barrier
  ds_read_b128 v[16:19], v3 offset:18944
  ds_read_b128 v[32:35], v4 offset:18944
  ds_read_b128 v[20:23], v3 offset:19072
  ds_read_b128 v[36:39], v4 offset:19072
  ds_read_b128 v[24:27], v3 offset:19200
  ds_read_b128 v[40:43], v4 offset:19200
  ds_read_b128 v[28:31], v3 offset:19328
  ds_read_b128 v[44:47], v4 offset:19328
  s_waitcnt lgkmcnt(4)
  v_pk_add_f32 v[16:17], v[16:17], v[20:21]
  v_add_f32 v18, v18, v22
  v_pk_add_f32 v[32:33], v[32:33], v[36:37]
  v_add_f32 v34, v34, v38
  s_waitcnt lgkmcnt(0)
  v_pk_add_f32 v[24:25], v[24:25], v[28:29]
  v_pk_add_f32 v[40:41], v[40:41], v[44:45]
  v_pk_add_f32 v[16:17], v[16:17], v[24:25]
  v_pk_add_f32 v[32:33], v[32:33], v[40:41]
  v_pk_mul_f32 v[16:17], v[16:17], v[14:15] op_sel_hi:[1,0]
  v_pk_mul_f32 v[32:33], v[32:33], v[14:15] op_sel_hi:[1,0]
  v_fma_f32 v17, -v16, v16, v17
  v_fma_f32 v33, -v32, v32, v33
  v_max_f32 v17, 0, v17
  v_max_f32 v33, 0, v33
  v_add_f32 v17, 0x3727c5ac, v17
  v_add_f32 v33, 0x3727c5ac, v33
  v_rsq_f32 v17, v17
  v_rsq_f32 v33, v33
  v_add_f32 v26, v26, v30
  v_add_f32 v42, v42, v46
  v_add_f32 v18, v18, v26
  v_add_f32 v34, v34, v42
  v_fma_f32 v18, -v16, v12, v18
  v_fma_f32 v34, -v32, v12, v34
  v_mul_f32 v18, v18, v17
  v_mul_f32 v34, v34, v33
  v_ashrrev_i32 v20, 31, v18
  v_ashrrev_i32 v36, 31, v34
  v_bitop3_b32 v20, v20, s26, v18 bitop3:0x56
  v_bitop3_b32 v36, v36, s26, v34 bitop3:0x56
  v_bfi_b32 v20, s25, v5, v20
  v_bfi_b32 v36, s25, v6, v36
  v_cmp_gt_u32 vcc, v20, v36
  v_max_u32 v36, 1, v36
  v_add_f32 v21, 1.0, v17
  v_lshrrev_b64 v[8:9], v2, vcc
  v_and_b32 v8, 0x01010101, v8
  v_and_b32 v9, 0x01010101, v9
  v_bcnt_u32_b32 v8, v8, v11
  v_bcnt_u32_b32 v8, v9, v8
  v_lshlrev_b32 v8, 2, v8
  buffer_store_dword v36, v8, s[8:11], s39 offen sc1
  s_mov_b32 exec_lo, 0x01010101
  s_mov_b32 exec_hi, 0x01010101
  v_mul_f32 v22, -v16, v17
  ds_write2_b32 v10, v21, v22 offset0:0 offset1:2
  v_rcp_f32 v21, v21
  v_mul_f32 v19, 0xbfb8aa3b, v18
  v_exp_f32 v19, v19
  v_mul_f32 v17, v17, v21
  v_add_f32 v19, 1.0, v19
  v_rcp_f32 v19, v19
  s_nop 0
  buffer_store_dwordx4 v[16:19], v3, s[8:11], s55 offen sc1
  s_mov_b64 exec, -1
  s_branch K2_T2
K2_W3:
  s_add_u32 s70, s70, 1
  s_cmp_ge_u32 s70, 262144
  s_cbranch_scc1 K2_W4
  buffer_load_dword v247, v246, s[8:11], s65 offen sc1
  s_waitcnt vmcnt(0)
  s_branch K2_W2
K2_T1B:
  s_barrier
K2_T2:
  v_add_u32 v1, s52, v239
  v_mov_b32 v2, s51
  s_waitcnt lgkmcnt(0)
  s_barrier
  s_mov_b32 exec_hi, 0xf
  ds_read_b128 v[4:7], v2
  ds_read_b128 v[8:11], v1 offset:0
  ds_read_b128 v[12:15], v1 offset:1184
  ds_read_b128 v[16:19], v1 offset:2368
  ds_read_b128 v[20:23], v1 offset:3552
  ds_read_b128 v[24:27], v1 offset:576
  ds_read_b128 v[28:31], v1 offset:1760
  ds_read_b128 v[32:35], v1 offset:2944
  ds_read_b128 v[36:39], v1 offset:4128
  s_waitcnt lgkmcnt(7)
  v_pk_fma_f32 v[8:9], v[8:9], v[4:5], v[6:7]
  v_pk_fma_f32 v[10:11], v[10:11], v[4:5], v[6:7]
  v_cvt_pk_bf16_f32 v40, v8, v10
  v_cvt_pk_bf16_f32 v44, v9, v11
  s_waitcnt lgkmcnt(6)
  v_pk_fma_f32 v[12:13], v[12:13], v[4:5], v[6:7]
  v_pk_fma_f32 v[14:15], v[14:15], v[4:5], v[6:7]
  v_cvt_pk_bf16_f32 v41, v12, v14
  v_cvt_pk_bf16_f32 v45, v13, v15
  s_waitcnt lgkmcnt(5)
  v_pk_fma_f32 v[16:17], v[16:17], v[4:5], v[6:7]
  v_pk_fma_f32 v[18:19], v[18:19], v[4:5], v[6:7]
  v_cvt_pk_bf16_f32 v42, v16, v18
  v_cvt_pk_bf16_f32 v46, v17, v19
  s_waitcnt lgkmcnt(4)
  v_pk_fma_f32 v[20:21], v[20:21], v[4:5], v[6:7]
  v_pk_fma_f32 v[22:23], v[22:23], v[4:5], v[6:7]
  v_cvt_pk_bf16_f32 v43, v20, v22
  v_cvt_pk_bf16_f32 v47, v21, v23
  buffer_store_dwordx4 v[40:43], v239, s[16:19], s53 offen offset:0 sc1
  buffer_store_dwordx4 v[44:47], v239, s[16:19], s53 offen offset:1152 sc1
  s_waitcnt lgkmcnt(3)
  v_pk_fma_f32 v[24:25], v[24:25], v[4:5], v[6:7]
  v_pk_fma_f32 v[26:27], v[26:27], v[4:5], v[6:7]
  v_cvt_pk_bf16_f32 v8, v24, v26
  v_cvt_pk_bf16_f32 v12, v25, v27
  s_waitcnt lgkmcnt(2)
  v_pk_fma_f32 v[28:29], v[28:29], v[4:5], v[6:7]
  v_pk_fma_f32 v[30:31], v[30:31], v[4:5], v[6:7]
  v_cvt_pk_bf16_f32 v9, v28, v30
  v_cvt_pk_bf16_f32 v13, v29, v31
  s_waitcnt lgkmcnt(1)
  v_pk_fma_f32 v[32:33], v[32:33], v[4:5], v[6:7]
  v_pk_fma_f32 v[34:35], v[34:35], v[4:5], v[6:7]
  v_cvt_pk_bf16_f32 v10, v32, v34
  v_cvt_pk_bf16_f32 v14, v33, v35
  s_waitcnt lgkmcnt(0)
  v_pk_fma_f32 v[36:37], v[36:37], v[4:5], v[6:7]
  v_pk_fma_f32 v[38:39], v[38:39], v[4:5], v[6:7]
  v_cvt_pk_bf16_f32 v11, v36, v38
  v_cvt_pk_bf16_f32 v15, v37, v39
  buffer_store_dwordx4 v[8:11], v239, s[16:19], s53 offen offset:576 sc1
  buffer_store_dwordx4 v[12:15], v239, s[16:19], s53 offen offset:1728 sc1
  s_mov_b64 exec, -1
  s_cmp_ge_u32 s2, 144
  s_cbranch_scc1 K2_END
  s_setprio 0
  ds_read_b64_tr_b16 v[88:89], v241 offset:0
  v_mov_b32 v248, 0x3f803f80
  ds_read_b64_tr_b16 v[90:91], v241 offset:128
  v_mov_b32 v249, 0x3f803f80
  ds_read_b64_tr_b16 v[92:93], v241 offset:2048
  v_mov_b32 v250, 0x3f803f80
  ds_read_b64_tr_b16 v[94:95], v241 offset:2176
  v_mov_b32 v251, 0x3f803f80
  ds_read_b64_tr_b16 v[96:97], v241 offset:4096
  v_mov_b32 v244, 0
  ds_read_b64_tr_b16 v[98:99], v241 offset:4224
  v_mov_b32 v245, 0
  ds_read_b64_tr_b16 v[100:101], v241 offset:6144
  v_mov_b32 v246, 0
  ds_read_b64_tr_b16 v[102:103], v241 offset:6272
  v_mov_b32 v247, 0
  ds_read_b64_tr_b16 v[104:105], v241 offset:8192
  v_mov_b32 v208, 0
  ds_read_b64_tr_b16 v[106:107], v241 offset:8320
  v_mov_b32 v209, 0
  ds_read_b64_tr_b16 v[108:109], v241 offset:10240
  v_mov_b32 v210, 0
  ds_read_b64_tr_b16 v[110:111], v241 offset:10368
  v_mov_b32 v211, 0
  s_waitcnt lgkmcnt(8)
  v_smfmac_f32_16x16x64_bf16 v[244:247], v[248:251], v[88:95], v73
  ds_read_b64_tr_b16 v[112:113], v241 offset:12288
  v_mov_b32 v212, 0
  ds_read_b64_tr_b16 v[114:115], v241 offset:12416
  v_mov_b32 v213, 0
  ds_read_b64_tr_b16 v[116:117], v241 offset:14336
  v_mov_b32 v214, 0
  ds_read_b64_tr_b16 v[118:119], v241 offset:14464
  v_mov_b32 v215, 0
  s_cmp_lg_u32 s3, 4
  s_cbranch_scc1 K2_NOACK
  v_mov_b32 v1, 163072
  v_mov_b32 v2, 9
  s_waitcnt vmcnt(5) lgkmcnt(0)
  ds_write_b32 v1, v2
K2_NOACK:
  s_waitcnt lgkmcnt(8)
  v_smfmac_f32_16x16x64_bf16 v[244:247], v[248:251], v[96:103], v73
  ds_read_b64_tr_b16 v[120:121], v241 offset:16384
  v_mov_b32 v216, 0
  ds_read_b64_tr_b16 v[122:123], v241 offset:16512
  v_mov_b32 v217, 0
  ds_read_b64_tr_b16 v[124:125], v241 offset:18432
  v_mov_b32 v218, 0
  ds_read_b64_tr_b16 v[126:127], v241 offset:18560
  v_mov_b32 v219, 0
  s_waitcnt lgkmcnt(8)
  v_smfmac_f32_16x16x64_bf16 v[244:247], v[248:251], v[104:111], v73
  ds_read_b64_tr_b16 v[128:129], v241 offset:20480
  v_mov_b32 v220, 0
  ds_read_b64_tr_b16 v[130:131], v241 offset:20608
  v_mov_b32 v221, 0
  ds_read_b64_tr_b16 v[132:133], v241 offset:22528
  v_mov_b32 v222, 0
  ds_read_b64_tr_b16 v[134:135], v241 offset:22656
  v_mov_b32 v223, 0
  s_waitcnt lgkmcnt(8)
  v_smfmac_f32_16x16x64_bf16 v[244:247], v[248:251], v[112:119], v73
  ds_read_b64_tr_b16 v[136:137], v241 offset:24576
  v_mov_b32 v224, 0
  ds_read_b64_tr_b16 v[138:139], v241 offset:24704
  v_mov_b32 v225, 0
  ds_read_b64_tr_b16 v[140:141], v241 offset:26624
  v_mov_b32 v226, 0
  ds_read_b64_tr_b16 v[142:143], v241 offset:26752
  v_mov_b32 v227, 0
  s_waitcnt lgkmcnt(8)
  v_smfmac_f32_16x16x64_bf16 v[244:247], v[248:251], v[120:127], v73
  ds_read_b64_tr_b16 v[144:145], v241 offset:28672
  v_mov_b32 v228, 0
  ds_read_b64_tr_b16 v[146:147], v241 offset:28800
  v_mov_b32 v229, 0
  ds_read_b64_tr_b16 v[148:149], v241 offset:30720
  v_mov_b32 v230, 0
  ds_read_b64_tr_b16 v[150:151], v241 offset:30848
  v_mov_b32 v231, 0
  s_waitcnt lgkmcnt(8)
  v_smfmac_f32_16x16x64_bf16 v[244:247], v[248:251], v[128:135], v73
  ds_read_b64_tr_b16 v[152:153], v241 offset:32768
  v_mov_b32 v232, 0
  ds_read_b64_tr_b16 v[154:155], v241 offset:32896
  v_mov_b32 v233, 0
  ds_read_b64_tr_b16 v[156:157], v241 offset:34816
  v_mov_b32 v234, 0
  ds_read_b64_tr_b16 v[158:159], v241 offset:34944
  v_mov_b32 v235, 0
  s_waitcnt lgkmcnt(8)
  v_smfmac_f32_16x16x64_bf16 v[244:247], v[248:251], v[136:143], v73
  s_waitcnt lgkmcnt(4)
  v_smfmac_f32_16x16x64_bf16 v[244:247], v[248:251], v[144:151], v73
  s_waitcnt lgkmcnt(0)
  v_smfmac_f32_16x16x64_bf16 v[244:247], v[248:251], v[152:159], v73
  v_lshl_add_u32 v85, s6, 11, v240
  v_add_u32 v86, 8192, v240
  s_nop 5
  v_add_f32 v80, v244, v246
  v_mov_b32 v81, v80
  s_nop 1
  v_mov_b32_dpp v81, v80 row_ror:8 row_mask:0xf bank_mask:0x3
  v_mov_b32_dpp v80, v80 row_ror:8 row_mask:0xf bank_mask:0xc
  s_waitcnt vmcnt(4)
K2_TOP:
  s_movk_i32 s24, 1152
  s_waitcnt lgkmcnt(0)
  s_barrier
  ds_read_b32 v16, v87 offset:30208
  s_mov_b32 s70, 0
  s_waitcnt lgkmcnt(0)
  v_max_u32_dpp v16, v16, v16 row_ror:8 row_mask:0xf bank_mask:0xf bound_ctrl:1
  s_nop 1
  v_mov_b32_dpp v17, v16 row_half_mirror row_mask:0xf bank_mask:0xf bound_ctrl:1
  v_med3_u32 v16, v16, v17, v57
  s_nop 1
  v_mov_b32_dpp v17, v16 quad_perm:[2,3,0,1] row_mask:0xf bank_mask:0xf bound_ctrl:1
  v_med3_u32 v16, v16, v17, v58
  s_nop 1
  v_mov_b32_dpp v17, v16 quad_perm:[1,0,3,2] row_mask:0xf bank_mask:0xf bound_ctrl:1
  v_med3_u32 v16, v16, v17, v59
  v_mov_b32 v17, v16
  s_nop 1
  v_permlane16_swap_b32 v16, v17
  v_max_u32 v16, v16, v17
  s_nop 1
  v_not_b32_dpp v17, v16 quad_perm:[0,1,0,1] row_mask:0xf bank_mask:0x3
  s_nop 1
  v_not_b32_dpp v17, v16 quad_perm:[2,3,2,3] row_mask:0xf bank_mask:0xc
  v_and_b32 v17, 0x7ff, v17
  v_mad_u32_u24 v18, v17, s24, v71
  s_cmp_ge_u32 s3, 2
  s_cbranch_scc1 K2_ROW1
  s_cmp_eq_u32 s3, 1
  s_cbranch_scc1 K2_ROWS
K2_ROW2:
  buffer_load_dwordx4 v[20:23], v18, s[16:19], 0 offen sc1
  buffer_load_dwordx4 v[24:27], v18, s[16:19], 0 offen offset:1024 sc1
  s_add_u32 s70, s70, 1
  s_waitcnt vmcnt(0)
  v_max3_u32 v28, v20, v23, v24
  v_max_u32 v28, v28, v27
  v_cmp_eq_u32 vcc, -1, v28
  s_cmp_lt_u32 s70, 262144
  s_cselect_b64 vcc, vcc, 0
  s_cbranch_vccnz K2_ROW2
  ds_write_b128 v70, v[24:27] offset:28672
  s_branch K2_ROWD
K2_ROWS:
  v_lshlrev_b32 v19, 4, v17
  s_mov_b32 s26, 2523136
K2_ROWS1:
  buffer_load_dwordx4 v[20:23], v18, s[16:19], s71 offen sc1
  buffer_load_dwordx4 v[24:27], v19, s[8:11], s26 offen sc1
  ds_write_b32 v69, v17 offset:29952
  s_add_u32 s70, s70, 1
  s_waitcnt vmcnt(0)
  v_max3_u32 v28, v20, v23, v24
  v_max_u32 v28, v28, v27
  v_cmp_eq_u32 vcc, -1, v28
  s_cmp_lt_u32 s70, 262144
  s_cselect_b64 vcc, vcc, 0
  s_cbranch_vccnz K2_ROWS1
  s_mov_b64 exec, 0xffff
  ds_write_b128 v70, v[24:27] offset:29696
  s_mov_b64 exec, -1
  s_branch K2_ROWD
K2_ROW1:
  buffer_load_dwordx4 v[20:23], v18, s[16:19], s71 offen sc1
  s_cmp_lt_u32 s3, 4
  s_cbranch_scc1 K2_ROW1W
  v_xor_b32 v1, 0, v85
  v_add_u32 v2, 18432, v1
  ds_read2_b32 v[160:161], v1 offset0:0 offset1:32
  ds_read2_b32 v[162:163], v1 offset0:64 offset1:96
  ds_read2_b32 v[164:165], v2 offset0:0 offset1:32
  ds_read2_b32 v[166:167], v2 offset0:64 offset1:96
  v_xor_b32 v1, 64, v85
  v_add_u32 v2, 18432, v1
  ds_read2_b32 v[168:169], v1 offset0:0 offset1:32
  ds_read2_b32 v[170:171], v1 offset0:64 offset1:96
  ds_read2_b32 v[172:173], v2 offset0:0 offset1:32
  ds_read2_b32 v[174:175], v2 offset0:64 offset1:96
  v_xor_b32 v1, 0, v85
  v_add_u32 v1, 1024, v1
  v_add_u32 v2, 18432, v1
  ds_read2_b32 v[176:177], v1 offset0:0 offset1:32
  ds_read2_b32 v[178:179], v1 offset0:64 offset1:96
  ds_read2_b32 v[180:181], v2 offset0:0 offset1:32
  ds_read2_b32 v[182:183], v2 offset0:64 offset1:96
  s_waitcnt lgkmcnt(8)
  v_xor_b32 v1, 64, v85
  v_add_u32 v1, 1024, v1
  v_add_u32 v2, 18432, v1
  ds_read2_b32 v[184:185], v1 offset0:0 offset1:32
  ds_read2_b32 v[186:187], v1 offset0:64 offset1:96
  ds_read2_b32 v[188:189], v2 offset0:0 offset1:32
  ds_read2_b32 v[190:191], v2 offset0:64 offset1:96
  s_waitcnt lgkmcnt(8)
  s_cmp_lg_u32 s3, 4
  s_cbranch_scc1 K2_ROW1V
  v_xor_b32 v1, 0, v86
  v_add_u32 v2, 18432, v1
  ds_read2_b32 v[192:193], v1 offset0:0 offset1:32
  ds_read2_b32 v[194:195], v1 offset0:64 offset1:96
  ds_read2_b32 v[196:197], v2 offset0:0 offset1:32
  ds_read2_b32 v[198:199], v2 offset0:64 offset1:96
  s_waitcnt lgkmcnt(8)
  v_xor_b32 v1, 64, v86
  v_add_u32 v2, 18432, v1
  ds_read2_b32 v[200:201], v1 offset0:0 offset1:32
  ds_read2_b32 v[202:203], v1 offset0:64 offset1:96
  ds_read2_b32 v[204:205], v2 offset0:0 offset1:32
  ds_read2_b32 v[206:207], v2 offset0:64 offset1:96
  s_waitcnt lgkmcnt(8)
K2_ROW1V:
  s_waitcnt lgkmcnt(0)
K2_ROW1W:
  s_add_u32 s70, s70, 1
  s_waitcnt vmcnt(0)
  v_max3_u32 v28, v20, v21, v23
  v_cmp_eq_u32 vcc, -1, v28
  s_cmp_lt_u32 s70, 262144
  s_cselect_b64 vcc, vcc, 0
  s_cbranch_vccnz K2_ROW1
K2_ROWD:
  ds_write_b128 v72, v[20:23] offset:20480
  s_mov_b32 s70, 0
  s_cmp_ge_u32 s3, 4
  s_waitcnt lgkmcnt(0)
  s_barrier
  s_cbranch_scc1 K2_GU
  s_cmp_lg_u32 s3, 0
  s_cbranch_scc1 K2_END
  v_mov_b32 v1, s36
  ds_read_b64 v[2:3], v1 offset:29952
  v_and_b32 v4, 12, v69
  v_bfe_u32 v5, v0, 4, 1
  v_lshl_add_u32 v6, v5, 9, v4
  v_add_u32 v6, s38, v6
  ds_read_b32 v8, v6 offset:20480
  ds_read_b32 v10, v6 offset:20496
  v_lshl_add_u32 v4, v5, 6, v4
  v_lshrrev_b32 v5, 2, v0
  v_mul_u32_u24 v5, 9344, v5
  v_and_b32 v6, 48, v70
  v_add_u32 v74, v5, v6
  v_and_b32 v5, 1, v0
  v_lshlrev_b32 v5, 4, v5
  v_mov_b32 v6, 0x3f80
  v_lshlrev_b32 v5, v5, v6
  v_bfe_u32 v6, v0, 1, 3
  v_cmp_eq_u32 vcc, 0, v6
  s_nop 1
  v_cndmask_b32 v12, 0, v5, vcc
  v_cmp_eq_u32 vcc, 1, v6
  s_nop 1
  v_cndmask_b32 v13, 0, v5, vcc
  v_cmp_eq_u32 vcc, 2, v6
  s_nop 1
  v_cndmask_b32 v14, 0, v5, vcc
  v_cmp_eq_u32 vcc, 3, v6
  s_nop 1
  v_cndmask_b32 v15, 0, v5, vcc
  s_waitcnt lgkmcnt(0)
  v_mad_u32_u24 v2, v2, s24, v4
  v_mad_u32_u24 v3, v3, s24, v4
  v_and_b32 v9, 0xffff0000, v8
  v_lshlrev_b32 v8, 16, v8
  v_and_b32 v11, 0xffff0000, v10
  v_lshlrev_b32 v10, 16, v10
  s_barrier
  s_barrier
K2_RED:
  s_mov_b32 s47, s46
  buffer_load_dwordx4 v[112:115], v74, s[8:11], s47 offen sc1
  s_add_u32 s47, s47, 149504
  buffer_load_dwordx4 v[116:119], v74, s[8:11], s47 offen sc1
  s_add_u32 s47, s47, 149504
  buffer_load_dwordx4 v[120:123], v74, s[8:11], s47 offen sc1
  s_add_u32 s47, s47, 149504
  buffer_load_dwordx4 v[124:127], v74, s[8:11], s47 offen sc1
  s_add_u32 s47, s47, 149504
  buffer_load_dwordx4 v[128:131], v74, s[8:11], s47 offen sc1
  s_add_u32 s47, s47, 149504
  buffer_load_dwordx4 v[132:135], v74, s[8:11], s47 offen sc1
  s_add_u32 s47, s47, 149504
  buffer_load_dwordx4 v[136:139], v74, s[8:11], s47 offen sc1
  s_add_u32 s47, s47, 149504
  buffer_load_dwordx4 v[140:143], v74, s[8:11], s47 offen sc1
  s_add_u32 s47, s47, 149504
  buffer_load_dwordx4 v[144:147], v74, s[8:11], s47 offen sc1
  s_add_u32 s70, s70, 1
  v_mov_b32 v28, 0
  s_waitcnt vmcnt(8)
  v_mfma_f32_16x16x32_bf16 v[16:19], v[12:15], v[112:115], 0
  v_max3_u32 v28, v28, v112, v115
  s_waitcnt vmcnt(7)
  v_mfma_f32_16x16x32_bf16 v[16:19], v[12:15], v[116:119], v[16:19]
  v_max3_u32 v28, v28, v116, v119
  s_waitcnt vmcnt(6)
  v_mfma_f32_16x16x32_bf16 v[16:19], v[12:15], v[120:123], v[16:19]
  v_max3_u32 v28, v28, v120, v123
  s_waitcnt vmcnt(5)
  v_mfma_f32_16x16x32_bf16 v[16:19], v[12:15], v[124:127], v[16:19]
  v_max3_u32 v28, v28, v124, v127
  s_waitcnt vmcnt(4)
  v_mfma_f32_16x16x32_bf16 v[16:19], v[12:15], v[128:131], v[16:19]
  v_max3_u32 v28, v28, v128, v131
  s_waitcnt vmcnt(3)
  v_mfma_f32_16x16x32_bf16 v[16:19], v[12:15], v[132:135], v[16:19]
  v_max3_u32 v28, v28, v132, v135
  s_waitcnt vmcnt(2)
  v_mfma_f32_16x16x32_bf16 v[16:19], v[12:15], v[136:139], v[16:19]
  v_max3_u32 v28, v28, v136, v139
  s_waitcnt vmcnt(1)
  v_mfma_f32_16x16x32_bf16 v[16:19], v[12:15], v[140:143], v[16:19]
  v_max3_u32 v28, v28, v140, v143
  s_waitcnt vmcnt(0)
  v_mfma_f32_16x16x32_bf16 v[16:19], v[12:15], v[144:147], v[16:19]
  v_max3_u32 v28, v28, v144, v147
  v_cmp_eq_u32 vcc, -1, v28
  s_cmp_lt_u32 s70, 262144
  s_cselect_b64 vcc, vcc, 0
  s_cbranch_vccnz K2_RED
  s_nop 2
  v_add_f32_dpp v16, v16, v16 row_ror:8 row_mask:0xf bank_mask:0xf bound_ctrl:1
  v_add_f32_dpp v17, v17, v17 row_ror:8 row_mask:0xf bank_mask:0xf bound_ctrl:1
  v_add_f32_dpp v18, v18, v18 row_ror:8 row_mask:0xf bank_mask:0xf bound_ctrl:1
  v_add_f32_dpp v19, v19, v19 row_ror:8 row_mask:0xf bank_mask:0xf bound_ctrl:1
  v_add_f32_dpp v16, v16, v16 row_ror:4 row_mask:0xf bank_mask:0xf bound_ctrl:1
  v_add_f32_dpp v17, v17, v17 row_ror:4 row_mask:0xf bank_mask:0xf bound_ctrl:1
  v_add_f32_dpp v18, v18, v18 row_ror:4 row_mask:0xf bank_mask:0xf bound_ctrl:1
  v_add_f32_dpp v19, v19, v19 row_ror:4 row_mask:0xf bank_mask:0xf bound_ctrl:1
  s_mov_b64 exec, 0x000f000f
  v_pk_add_f32 v[8:9], v[8:9], v[16:17]
  v_pk_add_f32 v[10:11], v[10:11], v[18:19]
  v_cvt_pk_bf16_f32 v8, v8, v9
  v_cvt_pk_bf16_f32 v10, v10, v11
  buffer_store_dword v8, v2, s[16:19], s37 offen sc1
  buffer_store_dword v10, v3, s[16:19], s37 offen sc1
  s_branch K2_END
K2_GU:
  ds_read_b128 v[8:11], v70 offset:20480
  ds_read_b128 v[12:15], v70 offset:21504
  ds_read_b128 v[16:19], v70 offset:22528
  ds_read_b128 v[20:23], v70 offset:23552
  ds_read_b128 v[24:27], v70 offset:24576
  ds_read_b128 v[28:31], v70 offset:25600
  ds_read_b128 v[32:35], v70 offset:26624
  ds_read_b128 v[36:39], v70 offset:27648
  ds_read_b128 v[40:43], v70 offset:28672
  ds_read_b128 v[4:7], v82 offset:29696
  s_waitcnt lgkmcnt(9)
  v_smfmac_f32_16x16x64_bf16 v[232:235], v[8:11], v[88:95], v73
  s_waitcnt lgkmcnt(8)
  v_smfmac_f32_16x16x64_bf16 v[232:235], v[12:15], v[96:103], v73
  s_waitcnt lgkmcnt(7)
  v_smfmac_f32_16x16x64_bf16 v[232:235], v[16:19], v[104:111], v73
  s_waitcnt lgkmcnt(6)
  v_smfmac_f32_16x16x64_bf16 v[232:235], v[20:23], v[112:119], v73
  s_waitcnt lgkmcnt(5)
  v_smfmac_f32_16x16x64_bf16 v[232:235], v[24:27], v[120:127], v73
  s_waitcnt lgkmcnt(4)
  v_smfmac_f32_16x16x64_bf16 v[232:235], v[28:31], v[128:135], v73
  s_waitcnt lgkmcnt(3)
  v_smfmac_f32_16x16x64_bf16 v[232:235], v[32:35], v[136:143], v73
  s_waitcnt lgkmcnt(2)
  v_smfmac_f32_16x16x64_bf16 v[232:235], v[36:39], v[144:151], v73
  s_waitcnt lgkmcnt(1)
  v_smfmac_f32_16x16x64_bf16 v[232:235], v[40:43], v[152:159], v73
  s_waitcnt lgkmcnt(0)
  v_mul_f32 v7, v7, v5
  v_mul_f32 v80, v80, v4
  v_mul_f32 v81, v81, v4
  v_mul_f32 v6, 0xbfb8aa3b, v5
  s_nop 2
  v_pk_add_f32 v[232:233], v[232:233], v[234:235]
  v_sub_f32 v2, v232, v80
  v_sub_f32 v3, v233, v81
  s_nop 0
  v_sub_f32_dpp v2, v233, v80 row_ror:8 row_mask:0xf bank_mask:0xc
  v_sub_f32_dpp v3, v232, v81 row_ror:8 row_mask:0xf bank_mask:0x3
  v_mul_f32 v1, v2, v6
  v_exp_f32 v1, v1
  v_mul_f32 v2, v2, v5
  v_add_f32 v1, 1.0, v1
  v_rcp_f32 v1, v1
  v_mul_f32 v3, v3, v7
  v_mul_f32 v2, v2, v1
  v_mul_f32 v2, v2, v3
  v_cvt_pk_bf16_f32 v2, v2, v2
  ds_write_b16 v83, v2 offset:30464
  s_cmp_lg_u32 s3, 4
  s_waitcnt lgkmcnt(0)
  s_barrier
  ds_read_b128 v[8:11], v84 offset:30464
  s_waitcnt lgkmcnt(0)
  v_smfmac_f32_16x16x64_bf16 v[208:211], v[8:11], v[160:167], v73 abid:1
  v_smfmac_f32_16x16x64_bf16 v[212:215], v[8:11], v[168:175], v73 abid:1
  v_smfmac_f32_16x16x64_bf16 v[216:219], v[8:11], v[176:183], v73 abid:1
  v_smfmac_f32_16x16x64_bf16 v[220:223], v[8:11], v[184:191], v73 abid:1
  s_cbranch_scc1 K2_D2
  v_smfmac_f32_16x16x64_bf16 v[224:227], v[8:11], v[192:199], v73 abid:1
  v_smfmac_f32_16x16x64_bf16 v[228:231], v[8:11], v[200:207], v73 abid:1
K2_D2:
  s_nop 3
  v_cvt_pk_bf16_f32 v12, v208, v210
  v_cvt_pk_bf16_f32 v13, v209, v211
  v_cvt_pk_bf16_f32 v14, v212, v214
  v_cvt_pk_bf16_f32 v15, v213, v215
  buffer_store_dwordx4 v[12:15], v70, s[8:11], s36 offen offset:0 sc1
  v_cvt_pk_bf16_f32 v16, v216, v218
  v_cvt_pk_bf16_f32 v17, v217, v219
  v_cvt_pk_bf16_f32 v18, v220, v222
  v_cvt_pk_bf16_f32 v19, v221, v223
  buffer_store_dwordx4 v[16:19], v70, s[8:11], s36 offen offset:1024 sc1
  s_cbranch_scc1 K2_D3
  v_cvt_pk_bf16_f32 v20, v224, v226
  v_cvt_pk_bf16_f32 v21, v225, v227
  v_cvt_pk_bf16_f32 v22, v228, v230
  v_cvt_pk_bf16_f32 v23, v229, v231
  buffer_store_dwordx4 v[20:23], v70, s[8:11], s37 offen offset:0 sc1
K2_D3:
  s_waitcnt vmcnt(0)
  s_barrier
K2_END:
K2_EXIT:
  s_endpgm
K2_LAST:
.section .rodata,"a"
.p2align 6
.amdhsa_kernel sequential_preLN__grouped_kv_mqa__moe_arch_mod__prompt_kernel
  .amdhsa_next_free_vgpr 256
  .amdhsa_next_free_sgpr 96
  .amdhsa_accum_offset 256
  .amdhsa_group_segment_fixed_size 0
  .amdhsa_kernarg_size 104
  .amdhsa_user_sgpr_count 2
  .amdhsa_user_sgpr_kernarg_segment_ptr 1
  .amdhsa_system_sgpr_workgroup_id_x 1
.end_amdhsa_kernel
```
